```python
import torch

def _softmax(x, axis=-1):
    return torch.softmax(x, dim=axis)

def _gelu(x):
    return torch.nn.functional.gelu(x, approximate='tanh')

def _silu(x):
    return torch.nn.functional.silu(x)

def _sigmoid(x):
    return torch.sigmoid(x)

def _layernorm(x, axis=-1, eps=1e-05):
    m = x.mean(dim=axis, keepdim=True)
    v = x.var(dim=axis, keepdim=True, unbiased=False)
    return (x - m) / torch.sqrt(v + eps)

def _scatter_add(tgt, idx, src, axis=0):
    return tgt.clone().index_add_(axis, idx, src)

def _segment_sum(src, seg, n):
    out = torch.zeros((n,) + src.shape[1:], dtype=src.dtype)
    return out.index_add_(0, seg, src)

def _pad(x, pw):
    flat = tuple((v for pair in reversed(pw) for v in pair))
    return torch.nn.functional.pad(x, flat)
kernel_name = 'adaLN_cond__sliding_local_dilated__glu_gated_bilinear__prompt'

def setup_inputs():

    _w = lambda a: (lambda t: t.to(torch.bfloat16) if t.is_floating_point() else t)(torch.as_tensor(a))

    def _A_setup():
        B, S, D = (1, 2048, 512)
        return {'x': _w((lambda *s: torch.randn(*s, dtype=torch.bfloat16) * 0.05)(B, S, D)), 'wqkv': _w((lambda *s: torch.randn(*s, dtype=torch.bfloat16) * 0.05)(D, 3 * D)), 'wo': _w((lambda *s: torch.randn(*s, dtype=torch.bfloat16) * 0.05)(D, D))}
    _A_in = _A_setup()

    def _B_setup():
        B, S, D, F = (1, 2048, 512, 1792)
        return {'x': _w((lambda *s: torch.randn(*s, dtype=torch.bfloat16) * 0.05)(B, S, D)), 'w_gate': _w((lambda *s: torch.randn(*s, dtype=torch.bfloat16) * 0.8)(D, F) * D ** (-0.5)), 'w_up': _w((lambda *s: torch.randn(*s, dtype=torch.bfloat16) * 0.8)(D, F) * D ** (-0.5)), 'w_down': _w((lambda *s: torch.randn(*s, dtype=torch.bfloat16) * 0.8)(F, D) * F ** (-0.5))}
    _B_in = _B_setup()
    return {'A_x': _A_in['x'], 'A_wqkv': _A_in['wqkv'], 'A_wo': _A_in['wo'], 'B_x': _B_in['x'], 'B_w_gate': _B_in['w_gate'], 'B_w_up': _B_in['w_up'], 'B_w_down': _B_in['w_down'], 'c': _w((lambda *s: torch.randn(*s, dtype=torch.bfloat16) * 0.1)(1, 512) * 8.0), 'w_mod': _w((lambda *s: torch.randn(*s, dtype=torch.bfloat16) * 0.1)(512, 6 * 512) * 512 ** (-0.5) * 8.0)}

def reference(A_x, A_wqkv, A_wo, B_x, B_w_gate, B_w_up, B_w_down, c, w_mod):

    def _A_ref(x, wqkv, wo):
        B, S, D = x.shape
        H = 32
        Dh = D // H
        W, dil = (8, 2)
        qkv = (lambda x, *d: x.permute(*d))((x @ wqkv).reshape(B, S, 3, H, Dh), 2, 0, 3, 1, 4)
        q, k, v = (qkv[0], qkv[1], qkv[2])
        scale = Dh ** (-0.5)
        pos = torch.arange(S)
        off = torch.arange(W) * dil
        idx = pos[:, None] - off[None, :]
        mask = idx >= 0
        idx_c = torch.where(mask, idx, 0).reshape(-1)
        kg = k[:, :, idx_c, :].reshape(B, H, S, W, Dh)
        vg = v[:, :, idx_c, :].reshape(B, H, S, W, Dh)
        logits = torch.einsum('bhsd,bhswd->bhsw', q, kg) * scale
        logits = torch.where(mask[None, None, :, :], logits, -1000000000.0)
        attn = _softmax(logits, axis=-1)
        o = torch.einsum('bhsw,bhswd->bhsd', attn, vg)
        return (lambda x, *d: x.permute(*d))(o, 0, 2, 1, 3).reshape(B, S, D) @ wo

    def _B_ref(x, w_gate, w_up, w_down):
        g = torch.einsum('bsd,df->bsf', x, w_gate)
        u = torch.einsum('bsd,df->bsf', x, w_up)
        h = g * u
        return torch.einsum('bsf,fd->bsd', h, w_down)
    x = A_x
    mod = (_silu(c) @ w_mod).reshape(c.shape[0], 6, 1, -1)
    sa, ca, ga, sb, cb, gb = (mod[:, 0].clone(), mod[:, 1].clone(), mod[:, 2].clone(), mod[:, 3].clone(), mod[:, 4].clone(), mod[:, 5].clone())
    h = _layernorm(x, axis=-1) * (1 + ca) + sa
    x = x + ga * _A_ref(h, A_wqkv, A_wo)
    h = _layernorm(x, axis=-1) * (1 + cb) + sb
    x = x + gb * _B_ref(h, B_w_gate, B_w_up, B_w_down)
    return x
```

```asm
; @launch grid=(256,1,1) block=(256,1,1) lds=163840
.amdgcn_target "amdgcn-amd-amdhsa--gfx950"
.text
.globl adaLN_cond__sliding_local_dilated__glu_gated_bilinear__prompt_kernel
.p2align 8
.type adaLN_cond__sliding_local_dilated__glu_gated_bilinear__prompt_kernel,@function
adaLN_cond__sliding_local_dilated__glu_gated_bilinear__prompt_kernel:
    s_cmp_ge_u32 s2, 256
    s_cbranch_scc1 Lexit
    s_load_dwordx2 s[4:5], s[0:1], 0
    s_load_dwordx2 s[28:29], s[0:1], 64
    s_load_dwordx2 s[40:41], s[0:1], 56
    s_load_dwordx2 s[36:37], s[0:1], 88
    s_and_b32 s60, s2, 7
    s_lshr_b32 s61, s2, 3
    s_lshr_b32 s57, s61, 3
    s_lshl_b32 s57, s57, 6
    s_lshl_b32 s58, s60, 8
    s_add_u32 s57, s57, s58
    s_sub_u32 s57, s57, 16
    v_lshrrev_b32 v9, 6, v0
    v_mul_u32_u24 v7, 20, v9
    v_bfe_u32 v8, v0, 4, 2
    v_add3_u32 v7, v7, v8, s57
    v_and_b32 v8, 15, v0
    v_lshlrev_b32 v7, 10, v7
    v_lshl_add_u32 v20, v8, 4, v7
    s_mov_b32 s6, 2097152
    s_mov_b32 s7, 0x20000
    s_waitcnt lgkmcnt(0)
    s_mov_b32 s30, 3145728
    s_mov_b32 s31, 0x20000
    v_and_b32 v8, 63, v0
    v_mul_u32_u24 v7, 20, v9
    v_add3_u32 v7, v7, v8, s57
    v_lshlrev_b32 v7, 10, v7
    s_and_b32 s58, s61, 7
    s_lshl_b32 s58, s58, 7
    v_cmp_lt_u32 vcc, 19, v8
    v_add_u32 v7, s58, v7
    s_min_u32 s57, s61, 23
    v_cndmask_b32 v7, v7, -1, vcc
    buffer_load_dword a252, v7, s[4:7], 0 offen
    s_getpc_b64 vcc
    v_and_b32 v8, 63, v0
    v_lshlrev_b32 v8, 6, v8
    global_load_dword a252, v8, vcc
    buffer_load_dwordx4 v[196:199], v20, s[4:7], 0 offen offset:0
    buffer_load_dwordx4 v[76:79], v20, s[4:7], 0 offen offset:256
    buffer_load_dwordx4 v[116:119], v20, s[4:7], 0 offen offset:512
    buffer_load_dwordx4 v[156:159], v20, s[4:7], 0 offen offset:768
    v_add_u32 v20, 4096, v20
    s_mov_b32 s30, 3145728
    s_mov_b32 s31, 0x20000
    s_mov_b32 s42, 1024
    s_mov_b32 s43, 0x20000
    s_min_u32 s57, s61, 23
    s_lshr_b32 s58, s57, 2
    s_lshl_b32 s58, s58, 3
    s_add_u32 s62, s58, s60
    s_and_b32 s57, s57, 3
    s_lshl_b32 s57, s57, 7
    v_lshrrev_b32 v7, 3, v0
    v_add_u32 v7, s57, v7
    v_lshlrev_b32 v18, 1, v7
    v_mul_u32_u24 v19, 6144, v7
    v_and_b32 v8, 7, v0
    v_lshlrev_b32 v8, 4, v8
    s_lshl_b32 s57, s62, 7
    v_add3_u32 v19, v19, v8, s57
    buffer_load_ushort v24, v18, s[40:43], 0 offen offset:0
    buffer_load_ushort v25, v18, s[40:43], 0 offen offset:64
    buffer_load_ushort v26, v18, s[40:43], 0 offen offset:128
    buffer_load_ushort v27, v18, s[40:43], 0 offen offset:192
    s_cmp_ge_u32 s61, 24
    s_cselect_b32 s30, 0, s30
    buffer_load_dwordx4 v[28:31], v19, s[28:31], 0 offen
    s_mov_b32 s52, 196608
    buffer_load_dwordx4 v[32:35], v19, s[28:31], s52 offen
    s_mov_b32 s52, 393216
    buffer_load_dwordx4 v[36:39], v19, s[28:31], s52 offen
    s_mov_b32 s52, 589824
    buffer_load_dwordx4 v[40:43], v19, s[28:31], s52 offen
    s_load_dword s54, s[36:37], 0
    s_load_dwordx2 s[8:9], s[0:1], 8
    s_load_dwordx2 s[12:13], s[0:1], 16
    s_load_dwordx2 s[16:17], s[0:1], 32
    s_load_dwordx2 s[20:21], s[0:1], 40
    s_load_dwordx2 s[24:25], s[0:1], 48
    s_load_dwordx2 s[32:33], s[0:1], 72
    s_mov_b32 s38, 13631488
    s_mov_b32 s39, 0x20000
    s_mov_b32 s10, 1572864
    s_mov_b32 s11, 0x20000
    s_mov_b32 s14, 524288
    s_mov_b32 s15, 0x20000
    s_mov_b32 s18, 1835008
    s_mov_b32 s19, 0x20000
    s_mov_b32 s22, 1835008
    s_mov_b32 s23, 0x20000
    s_mov_b32 s26, 1835008
    s_mov_b32 s27, 0x20000
    s_mov_b32 s34, 2097152
    s_mov_b32 s35, 0x20000
    v_readfirstlane_b32 s44, v9
    v_and_b32 v1, 63, v0
    v_and_b32 v2, 31, v0
    v_lshrrev_b32 v3, 5, v1
    s_lshr_b32 s57, s61, 4
    s_lshl_b32 s47, s60, 1
    s_add_u32 s47, s47, s57
    s_and_b32 s48, s61, 15
    s_and_b32 s49, s48, 7
    s_and_b32 s45, s44, 1
    s_lshr_b32 s46, s44, 1
    s_lshl_b32 s51, s44, 10
    s_lshl_b32 s50, s47, 2
    s_lshr_b32 s57, s48, 3
    s_lshl_b32 s57, s57, 1
    s_add_u32 s50, s50, s57
    s_add_u32 s50, s50, s45
    s_lshl_b32 s57, s50, 1
    s_add_u32 s57, s57, s46
    s_lshl_b32 s57, s57, 10
    s_and_b32 s58, s49, 3
    s_lshl_b32 s58, s58, 2
    s_add_u32 s57, s57, s58
    s_add_u32 s70, s57, 524288
    v_lshlrev_b32 v16, 4, v1
    s_lshl_b32 s58, s49, 2
    v_xor_b32 v7, s58, v1
    v_lshlrev_b32 v7, 27, v7
    v_and_b32 v7, 0x80000000, v7
    v_or_b32 v7, v7, v16
    v_mov_b32 v10, -1
    v_accvgpr_write_b32 a0, v7
    buffer_store_dword v10, v7, s[36:39], s70 offen sc1
    s_getpc_b64 s[0:1]
    s_lshl_b32 s57, s61, 2
    s_add_u32 s57, s57, s44
    s_mul_i32 s57, s57, 320
    v_mul_u32_u24 v7, 5, v1
    v_add_u32 v7, s57, v7
    v_and_b32 v7, -4, v7
    v_min_u32 v7, Lcode_end-Lcode_pf-4, v7
Lcode_pf:
    global_load_dword a252, v7, s[0:1]
    v_lshlrev_b32 v22, 2, v3
    v_bfe_u32 v7, v1, 2, 2
    v_add_u32 v22, v22, v7
    v_bfe_u32 v7, v1, 4, 1
    v_lshlrev_b32 v7, 6, v7
    v_and_b32 v8, 3, v1
    v_lshlrev_b32 v8, 4, v8
    v_add_u32 v23, v7, v8
    s_lshl_b32 s57, s44, 3
    v_add_u32 v7, s57, v22
    v_mul_u32_u24 v8, 3072, v7
    s_lshl_b32 s59, s49, 7
    s_lshl_b32 s58, s45, 5
    v_xor_b32 v9, s58, v23
    v_add3_u32 v11, v8, v9, s59
    v_mul_u32_u24 v14, 3584, v7
    s_lshl_b32 s57, s46, 8
    s_lshl_b32 s58, s45, 3
    s_add_u32 s57, s57, s58
    v_add_u32 v7, s57, v22
    v_lshlrev_b32 v7, 10, v7
    v_lshlrev_b32 v8, 5, v3
    v_xor_b32 v8, v8, v23
    v_add3_u32 v12, v7, v8, s59
    s_mul_i32 s57, s46, 896
    s_add_u32 s57, s57, s58
    v_add_u32 v7, s57, v22
    v_lshlrev_b32 v7, 10, v7
    v_add3_u32 v13, v7, v8, s59
    s_lshl_b32 s60, s48, 8
    v_add3_u32 v14, v14, v8, s60
    s_lshr_b32 s60, s61, 4
    s_mul_i32 s60, s60, 458752
    s_sub_u32 s59, 458752, s60
    v_add_u32 v21, s59, v14
    v_add_u32 v14, s60, v14
    s_mul_i32 s71, s44, 3072
    v_and_b32 v7, 3, v1
    v_lshlrev_b32 v7, 3, v7
    v_bfe_u32 v8, v1, 2, 2
    v_lshlrev_b32 v8, 6, v8
    v_add_u32 v7, v7, v8
    v_bfe_u32 v8, v1, 4, 1
    v_lshlrev_b32 v8, 5, v8
    v_add_u32 v17, v7, v8
    s_lshl_b32 s57, s47, 11
    s_and_b32 s58, s50, 3
    s_lshl_b32 s58, s58, 7
    s_add_u32 s57, s57, s58
    s_add_u32 s63, s57, 4096
    s_lshl_b32 s58, s49, 3
    s_lshl_b32 s59, s46, 2
    s_add_u32 s58, s58, s59
    s_add_u32 s58, s58, s63
    v_mov_b32 v15, s58
    s_lshr_b32 s66, s61, 3
    s_lshl_b32 s66, s66, 14
    s_xor_b32 s67, s66, 16384
    s_xor_b32 s68, s66, 32768
    s_xor_b32 s69, s66, 49152
    s_lshl_b32 s72, s66, 1
    s_lshl_b32 s57, s2, 2
    s_add_u32 s57, s57, s44
    s_mul_i32 s57, s57, 512
    v_mul_u32_u24 v7, 128, v1
    v_cmp_le_u32 vcc, 4, v1
    v_add_u32 v7, s57, v7
    s_nop 0
    v_cndmask_b32 v7, v7, -1, vcc
    v_accvgpr_write_b32 a1, v7
    s_lshl_b32 s57, s2, 2
    s_add_u32 s57, s57, s44
    s_mul_i32 s57, s57, 1792
    v_mul_u32_u24 v7, 128, v1
    v_cmp_le_u32 vcc, 14, v1
    v_add_u32 v7, s57, v7
    s_nop 0
    v_cndmask_b32 v7, v7, -1, vcc
    v_accvgpr_write_b32 a2, v7
    s_lshl_b32 s57, s61, 2
    s_add_u32 s57, s57, s44
    s_mul_i32 s57, s57, 12288
    s_add_u32 s57, s57, 384
    v_mul_u32_u24 v7, 1024, v1
    v_cmp_le_u32 vcc, 12, v1
    v_add_u32 v7, s57, v7
    s_nop 0
    v_cndmask_b32 v7, v7, -1, vcc
    v_accvgpr_write_b32 a3, v7
    s_mul_i32 s57, s45, 8704
    s_add_u32 s57, s57, 4352
    v_and_b32 v8, 15, v1
    v_mul_u32_u24 v9, 272, v8
    v_add_u32 v7, 4, v8
    v_and_b32 v7, 8, v7
    v_lshlrev_b32 v7, 1, v7
    v_and_b32 v10, 48, v1
    v_xor_b32 v7, v7, v10
    v_add_u32 v23, v7, v9
    v_add_u32 v22, s57, v23
    v_accvgpr_write_b32 a4, v22
    v_accvgpr_write_b32 a5, v23
    v_lshlrev_b32 v22, 5, v8
    v_lshrrev_b32 v9, 4, v1
    s_mul_i32 s57, s44, 20
    v_add_u32 v9, s57, v9
    v_mul_u32_u24 v9, 272, v9
    s_lshr_b32 s57, s66, 12
    v_xor_b32 v10, s57, v8
    v_accvgpr_write_b32 a6, v22
    v_accvgpr_write_b32 a7, v9
    v_accvgpr_write_b32 a8, v10
    v_lshrrev_b32 v7, 4, v1
    v_mul_u32_u24 v7, 3072, v7
    s_lshl_b32 s58, s45, 5
    v_xor_b32 v9, s58, v17
    s_lshl_b32 s57, s46, 8
    v_add3_u32 v22, v9, v7, s57
    s_and_b32 s57, s2, 3
    s_mul_i32 s57, s57, 49152
    s_add_u32 s57, s57, 65536
    v_lshl_add_u32 v23, v0, 4, s57
    v_accvgpr_write_b32 a9, v22
    v_accvgpr_write_b32 a10, v23
    buffer_load_dwordx4 v[204:207], v20, s[4:7], 0 offen offset:0
    buffer_load_dwordx4 v[84:87], v20, s[4:7], 0 offen offset:256
    buffer_load_dwordx4 v[124:127], v20, s[4:7], 0 offen offset:512
    buffer_load_dwordx4 v[164:167], v20, s[4:7], 0 offen offset:768
    v_add_u32 v20, 4096, v20
    s_waitcnt vmcnt(17)
    v_lshlrev_b32 v192, 16, v196
    v_and_b32 v193, 0xffff0000, v196
    v_lshlrev_b32 v194, 16, v197
    v_and_b32 v195, 0xffff0000, v197
    v_lshlrev_b32 v196, 16, v198
    v_and_b32 v197, 0xffff0000, v198
    v_lshlrev_b32 v198, 16, v199
    v_and_b32 v199, 0xffff0000, v199
    v_pk_add_f32 v[44:45], v[192:193], v[196:197]
    v_pk_mul_f32 v[48:49], v[192:193], v[192:193]
    v_pk_add_f32 v[46:47], v[194:195], v[198:199]
    v_pk_mul_f32 v[50:51], v[194:195], v[194:195]
    v_pk_fma_f32 v[48:49], v[196:197], v[196:197], v[48:49]
    v_pk_fma_f32 v[50:51], v[198:199], v[198:199], v[50:51]
    s_waitcnt vmcnt(16)
    v_lshlrev_b32 v72, 16, v76
    v_and_b32 v73, 0xffff0000, v76
    v_lshlrev_b32 v74, 16, v77
    v_and_b32 v75, 0xffff0000, v77
    buffer_load_dwordx4 v[212:215], v20, s[4:7], 0 offen offset:0
    v_lshlrev_b32 v76, 16, v78
    v_and_b32 v77, 0xffff0000, v78
    v_lshlrev_b32 v78, 16, v79
    v_and_b32 v79, 0xffff0000, v79
    v_pk_add_f32 v[44:45], v[44:45], v[72:73]
    v_pk_fma_f32 v[48:49], v[72:73], v[72:73], v[48:49]
    v_pk_add_f32 v[46:47], v[46:47], v[74:75]
    v_pk_fma_f32 v[50:51], v[74:75], v[74:75], v[50:51]
    v_pk_add_f32 v[44:45], v[44:45], v[76:77]
    v_pk_fma_f32 v[48:49], v[76:77], v[76:77], v[48:49]
    v_pk_add_f32 v[46:47], v[46:47], v[78:79]
    v_pk_fma_f32 v[50:51], v[78:79], v[78:79], v[50:51]
    s_waitcnt vmcnt(16)
    v_lshlrev_b32 v112, 16, v116
    v_and_b32 v113, 0xffff0000, v116
    v_lshlrev_b32 v114, 16, v117
    v_and_b32 v115, 0xffff0000, v117
    v_lshlrev_b32 v116, 16, v118
    buffer_load_dwordx4 v[92:95], v20, s[4:7], 0 offen offset:256
    v_and_b32 v117, 0xffff0000, v118
    v_lshlrev_b32 v118, 16, v119
    v_and_b32 v119, 0xffff0000, v119
    v_pk_add_f32 v[44:45], v[44:45], v[112:113]
    v_pk_fma_f32 v[48:49], v[112:113], v[112:113], v[48:49]
    v_pk_add_f32 v[46:47], v[46:47], v[114:115]
    v_pk_fma_f32 v[50:51], v[114:115], v[114:115], v[50:51]
    v_pk_add_f32 v[44:45], v[44:45], v[116:117]
    v_pk_fma_f32 v[48:49], v[116:117], v[116:117], v[48:49]
    v_pk_add_f32 v[46:47], v[46:47], v[118:119]
    v_pk_fma_f32 v[50:51], v[118:119], v[118:119], v[50:51]
    s_waitcnt vmcnt(16)
    v_lshlrev_b32 v152, 16, v156
    v_and_b32 v153, 0xffff0000, v156
    v_lshlrev_b32 v154, 16, v157
    v_and_b32 v155, 0xffff0000, v157
    v_lshlrev_b32 v156, 16, v158
    buffer_load_dwordx4 v[132:135], v20, s[4:7], 0 offen offset:512
    v_and_b32 v157, 0xffff0000, v158
    v_lshlrev_b32 v158, 16, v159
    v_and_b32 v159, 0xffff0000, v159
    v_pk_add_f32 v[44:45], v[44:45], v[152:153]
    v_pk_fma_f32 v[48:49], v[152:153], v[152:153], v[48:49]
    v_pk_add_f32 v[46:47], v[46:47], v[154:155]
    v_pk_fma_f32 v[50:51], v[154:155], v[154:155], v[50:51]
    v_pk_add_f32 v[44:45], v[44:45], v[156:157]
    v_pk_fma_f32 v[48:49], v[156:157], v[156:157], v[48:49]
    v_pk_add_f32 v[46:47], v[46:47], v[158:159]
    v_pk_fma_f32 v[50:51], v[158:159], v[158:159], v[50:51]
    s_waitcnt vmcnt(16)
    v_lshlrev_b32 v24, 16, v24
    s_waitcnt vmcnt(15)
    v_lshlrev_b32 v25, 16, v25
    s_waitcnt vmcnt(14)
    v_lshlrev_b32 v26, 16, v26
    s_waitcnt vmcnt(13)
    v_lshlrev_b32 v27, 16, v27
    v_mul_f32 v232, 0xbfb8aa3b, v24
    v_mul_f32 v234, 0xbfb8aa3b, v25
    v_mul_f32 v236, 0xbfb8aa3b, v26
    v_mul_f32 v238, 0xbfb8aa3b, v27
    v_exp_f32 v232, v232
    v_exp_f32 v234, v234
    v_exp_f32 v236, v236
    v_exp_f32 v238, v238
    buffer_load_dwordx4 v[172:175], v20, s[4:7], 0 offen offset:768
    v_add_u32 v20, 4096, v20
    v_add_f32 v232, 1.0, v232
    v_add_f32 v234, 1.0, v234
    v_add_f32 v236, 1.0, v236
    v_add_f32 v238, 1.0, v238
    v_rcp_f32 v232, v232
    v_rcp_f32 v234, v234
    v_rcp_f32 v236, v236
    v_rcp_f32 v238, v238
    v_mul_f32 v232, v24, v232
    v_mul_f32 v234, v25, v234
    v_mul_f32 v236, v26, v236
    v_mul_f32 v238, v27, v238
    buffer_load_dwordx4 v[220:223], v20, s[4:7], 0 offen offset:0
    v_cvt_pk_bf16_f32 v232, v232, v232
    v_cvt_pk_bf16_f32 v234, v234, v234
    v_cvt_pk_bf16_f32 v236, v236, v236
    v_cvt_pk_bf16_f32 v238, v238, v238
    v_and_b32 v232, 0xffff0000, v232
    v_and_b32 v234, 0xffff0000, v234
    v_and_b32 v236, 0xffff0000, v236
    v_and_b32 v238, 0xffff0000, v238
    s_waitcnt vmcnt(14)
    v_lshlrev_b32 v248, 16, v28
    v_and_b32 v249, 0xffff0000, v28
    v_lshlrev_b32 v250, 16, v29
    buffer_load_dwordx4 v[100:103], v20, s[4:7], 0 offen offset:256
    v_and_b32 v251, 0xffff0000, v29
    v_lshlrev_b32 v252, 16, v30
    v_and_b32 v253, 0xffff0000, v30
    v_lshlrev_b32 v254, 16, v31
    v_and_b32 v255, 0xffff0000, v31
    v_pk_mul_f32 v[240:241], v[248:249], v[232:233] op_sel_hi:[1,0]
    v_pk_mul_f32 v[242:243], v[250:251], v[232:233] op_sel_hi:[1,0]
    v_pk_mul_f32 v[244:245], v[252:253], v[232:233] op_sel_hi:[1,0]
    v_pk_mul_f32 v[246:247], v[254:255], v[232:233] op_sel_hi:[1,0]
    s_waitcnt vmcnt(14)
    v_lshlrev_b32 v248, 16, v32
    v_and_b32 v249, 0xffff0000, v32
    buffer_load_dwordx4 v[140:143], v20, s[4:7], 0 offen offset:512
    v_lshlrev_b32 v250, 16, v33
    v_and_b32 v251, 0xffff0000, v33
    v_lshlrev_b32 v252, 16, v34
    v_and_b32 v253, 0xffff0000, v34
    v_lshlrev_b32 v254, 16, v35
    v_and_b32 v255, 0xffff0000, v35
    v_pk_fma_f32 v[240:241], v[248:249], v[234:235], v[240:241] op_sel_hi:[1,0,1]
    v_pk_fma_f32 v[242:243], v[250:251], v[234:235], v[242:243] op_sel_hi:[1,0,1]
    v_pk_fma_f32 v[244:245], v[252:253], v[234:235], v[244:245] op_sel_hi:[1,0,1]
    v_pk_fma_f32 v[246:247], v[254:255], v[234:235], v[246:247] op_sel_hi:[1,0,1]
    s_waitcnt vmcnt(14)
    v_lshlrev_b32 v248, 16, v36
    v_and_b32 v249, 0xffff0000, v36
    buffer_load_dwordx4 v[180:183], v20, s[4:7], 0 offen offset:768
    v_add_u32 v20, 4096, v20
    v_lshlrev_b32 v250, 16, v37
    v_and_b32 v251, 0xffff0000, v37
    v_lshlrev_b32 v252, 16, v38
    v_and_b32 v253, 0xffff0000, v38
    v_lshlrev_b32 v254, 16, v39
    v_and_b32 v255, 0xffff0000, v39
    v_pk_fma_f32 v[240:241], v[248:249], v[236:237], v[240:241] op_sel_hi:[1,0,1]
    v_pk_fma_f32 v[242:243], v[250:251], v[236:237], v[242:243] op_sel_hi:[1,0,1]
    v_pk_fma_f32 v[244:245], v[252:253], v[236:237], v[244:245] op_sel_hi:[1,0,1]
    v_pk_fma_f32 v[246:247], v[254:255], v[236:237], v[246:247] op_sel_hi:[1,0,1]
    s_waitcnt vmcnt(14)
    v_lshlrev_b32 v248, 16, v40
    v_and_b32 v249, 0xffff0000, v40
    buffer_load_dwordx4 v[228:231], v20, s[4:7], 0 offen offset:0
    v_lshlrev_b32 v250, 16, v41
    v_and_b32 v251, 0xffff0000, v41
    v_lshlrev_b32 v252, 16, v42
    v_and_b32 v253, 0xffff0000, v42
    v_lshlrev_b32 v254, 16, v43
    v_and_b32 v255, 0xffff0000, v43
    v_pk_fma_f32 v[240:241], v[248:249], v[238:239], v[240:241] op_sel_hi:[1,0,1]
    v_pk_fma_f32 v[242:243], v[250:251], v[238:239], v[242:243] op_sel_hi:[1,0,1]
    v_pk_fma_f32 v[244:245], v[252:253], v[238:239], v[244:245] op_sel_hi:[1,0,1]
    v_pk_fma_f32 v[246:247], v[254:255], v[238:239], v[246:247] op_sel_hi:[1,0,1]
    v_and_b32 v7, 7, v1
    buffer_load_dwordx4 v[108:111], v20, s[4:7], 0 offen offset:256
    v_lshlrev_b32 v7, 5, v7
    v_permlane32_swap_b32 v240, v244
    v_permlane32_swap_b32 v241, v245
    v_permlane32_swap_b32 v242, v246
    v_permlane32_swap_b32 v243, v247
    v_add_f32 v240, v240, v244
    v_add_f32 v241, v241, v245
    v_add_f32 v242, v242, v246
    v_add_f32 v243, v243, v247
    v_lshrrev_b32 v8, 4, v1
    v_permlane16_swap_b32 v240, v242
    v_permlane16_swap_b32 v241, v243
    buffer_load_dwordx4 v[148:151], v20, s[4:7], 0 offen offset:512
    v_add_f32 v240, v240, v242
    v_add_f32 v241, v241, v243
    v_lshl_add_u32 v7, v8, 3, v7
    s_lshl_b32 s57, s44, 8
    v_add_f32_dpp v240, v240, v240 row_ror:8 row_mask:0xf bank_mask:0xf
    v_add_f32_dpp v241, v241, v241 row_ror:8 row_mask:0xf bank_mask:0xf
    v_add_u32 v7, s57, v7
    ds_write_b64 v7, v[240:241] offset:1024
    s_waitcnt lgkmcnt(0)
    s_mul_i32 s54, s54, 0x9E3779B1
    s_add_u32 s54, s54, 0x7F4A7C18
    s_and_b32 s54, s54, 0xFFFFFFF8
    v_mov_b32 v6, s54
    s_lshr_b32 s73, s54, 3
    s_lshr_b32 s74, s54, 10
    s_lshr_b32 s75, s54, 17
    s_lshr_b32 s76, s54, 24
    s_waitcnt vmcnt(16)
    s_barrier
    s_cmp_lg_u32 s44, 0
    s_cbranch_scc1 Lnot0_1
    v_and_b32 v7, 15, v1
    v_lshlrev_b32 v8, 4, v7
    ds_read_b128 v[28:31], v8 offset:1024
    ds_read_b128 v[32:35], v8 offset:1280
    ds_read_b128 v[36:39], v8 offset:1536
    ds_read_b128 v[40:43], v8 offset:1792
    v_lshrrev_b32 v9, 4, v1
    v_mul_u32_u24 v9, 49152, v9
    s_lshl_b32 s57, s62, 8
    s_and_b32 s58, s61, 3
    s_mul_i32 s58, s58, 12288
    s_add_u32 s57, s57, s58
    s_add_u32 s57, s57, 65536
    v_add3_u32 v9, v9, v8, s57
    v_mov_b32 v7, 0xff
    s_waitcnt lgkmcnt(2)
    v_pk_add_f32 v[28:29], v[28:29], v[32:33]
    s_waitcnt lgkmcnt(0)
    v_pk_add_f32 v[36:37], v[36:37], v[40:41]
    v_pk_add_f32 v[30:31], v[30:31], v[34:35]
    v_pk_add_f32 v[38:39], v[38:39], v[42:43]
    v_pk_add_f32 v[28:29], v[28:29], v[36:37]
    v_pk_add_f32 v[30:31], v[30:31], v[38:39]
    v_bfi_b32 v28, v7, s73, v28
    v_bfi_b32 v29, v7, s74, v29
    v_bfi_b32 v30, v7, s75, v30
    v_bfi_b32 v31, v7, s76, v31
    s_cmp_ge_u32 s61, 24
    s_cbranch_scc1 Lnopub_2
    buffer_store_dwordx4 v[28:31], v9, s[36:39], 0 offen sc1
Lnopub_2:
    s_getreg_b32 s57, hwreg(HW_REG_XCC_ID)
    s_and_b32 s57, s57, 7
    s_or_b32 s57, s57, s54
    v_mov_b32 v7, s57
    s_lshl_b32 s58, s47, 4
    s_add_u32 s58, s58, s48
    s_lshl_b32 s58, s58, 2
    v_mov_b32 v8, s58
    s_mov_b64 exec, 1
    buffer_store_dword v7, v8, s[36:39], 0 offen offset:1024 sc1
    s_mov_b64 exec, -1
Lnot0_1:
    buffer_load_dwordx4 v[188:191], v20, s[4:7], 0 offen offset:768
    s_waitcnt vmcnt(15)
    v_lshlrev_b32 v200, 16, v204
    v_and_b32 v201, 0xffff0000, v204
    v_pk_add_f32 v[44:45], v[44:45], v[46:47]
    v_lshlrev_b32 v202, 16, v205
    v_and_b32 v203, 0xffff0000, v205
    v_pk_add_f32 v[48:49], v[48:49], v[50:51]
    v_lshlrev_b32 v204, 16, v206
    v_and_b32 v205, 0xffff0000, v206
    v_add_f32 v44, v44, v45
    v_lshlrev_b32 v206, 16, v207
    v_and_b32 v207, 0xffff0000, v207
    v_add_f32 v48, v48, v49
    v_pk_add_f32 v[52:53], v[200:201], v[204:205]
    v_pk_mul_f32 v[56:57], v[200:201], v[200:201]
    v_add_f32_dpp v44, v44, v44 row_ror:8 row_mask:0xf bank_mask:0xf
    v_pk_add_f32 v[54:55], v[202:203], v[206:207]
    s_lshl_b32 s57, s2, 2
    s_add_u32 s57, s57, s44
    s_mul_i32 s57, s57, 1536
    v_mul_u32_u24 v7, 128, v1
    v_cmp_le_u32 vcc, 12, v1
    v_add_u32 v7, s57, v7
    s_nop 0
    v_cndmask_b32 v7, v7, -1, vcc
    buffer_load_dword a252, v7, s[8:11], 0 offen
    v_pk_mul_f32 v[58:59], v[202:203], v[202:203]
    v_add_f32_dpp v48, v48, v48 row_ror:8 row_mask:0xf bank_mask:0xf
    v_pk_fma_f32 v[56:57], v[204:205], v[204:205], v[56:57]
    v_pk_fma_f32 v[58:59], v[206:207], v[206:207], v[58:59]
    v_add_f32_dpp v44, v44, v44 row_ror:4 row_mask:0xf bank_mask:0xf
    s_waitcnt vmcnt(15)
    v_lshlrev_b32 v80, 16, v84
    v_and_b32 v81, 0xffff0000, v84
    v_add_f32_dpp v48, v48, v48 row_ror:4 row_mask:0xf bank_mask:0xf
    v_lshlrev_b32 v82, 16, v85
    v_and_b32 v83, 0xffff0000, v85
    v_add_f32_dpp v44, v44, v44 row_ror:2 row_mask:0xf bank_mask:0xf
    v_lshlrev_b32 v84, 16, v86
    v_and_b32 v85, 0xffff0000, v86
    v_add_f32_dpp v48, v48, v48 row_ror:2 row_mask:0xf bank_mask:0xf
    v_accvgpr_read_b32 v7, a3
    buffer_load_dword a252, v7, s[8:11], 0 offen
    v_lshlrev_b32 v86, 16, v87
    v_and_b32 v87, 0xffff0000, v87
    v_add_f32_dpp v44, v44, v44 row_ror:1 row_mask:0xf bank_mask:0xf
    v_pk_add_f32 v[52:53], v[52:53], v[80:81]
    v_pk_fma_f32 v[56:57], v[80:81], v[80:81], v[56:57]
    v_add_f32_dpp v48, v48, v48 row_ror:1 row_mask:0xf bank_mask:0xf
    v_pk_add_f32 v[54:55], v[54:55], v[82:83]
    v_pk_fma_f32 v[58:59], v[82:83], v[82:83], v[58:59]
    v_mul_f32 v44, 0x3b000000, v44
    v_pk_add_f32 v[52:53], v[52:53], v[84:85]
    v_pk_fma_f32 v[56:57], v[84:85], v[84:85], v[56:57]
    v_mul_f32 v48, 0x3b000000, v48
    v_pk_add_f32 v[54:55], v[54:55], v[86:87]
    v_pk_fma_f32 v[58:59], v[86:87], v[86:87], v[58:59]
    s_add_u32 m0, s71, 93184
    s_mul_i32 s52, s66, 6
    s_waitcnt lgkmcnt(0)
    buffer_load_dwordx4 v11, s[8:11], s52 offen lds
    v_fma_f32 v48, -v44, v44, v48
    s_waitcnt vmcnt(16)
    v_lshlrev_b32 v120, 16, v124
    v_and_b32 v121, 0xffff0000, v124
    v_max_f32 v48, 0, v48
    v_lshlrev_b32 v122, 16, v125
    v_and_b32 v123, 0xffff0000, v125
    v_cvt_pk_bf16_f32 v48, v48, v48
    v_lshlrev_b32 v124, 16, v126
    v_and_b32 v125, 0xffff0000, v126
    v_and_b32 v48, 0xffff0000, v48
    v_lshlrev_b32 v126, 16, v127
    v_and_b32 v127, 0xffff0000, v127
    v_add_f32 v48, 0x3727c5ac, v48
    v_pk_add_f32 v[52:53], v[52:53], v[120:121]
    buffer_load_dwordx4 v11, s[8:11], s52 offen offset:1024 lds
    v_pk_fma_f32 v[56:57], v[120:121], v[120:121], v[56:57]
    v_cvt_pk_bf16_f32 v48, v48, v48
    v_pk_add_f32 v[54:55], v[54:55], v[122:123]
    v_pk_fma_f32 v[58:59], v[122:123], v[122:123], v[58:59]
    v_and_b32 v48, 0xffff0000, v48
    v_pk_add_f32 v[52:53], v[52:53], v[124:125]
    v_pk_fma_f32 v[56:57], v[124:125], v[124:125], v[56:57]
    v_sqrt_f32 v48, v48
    v_pk_add_f32 v[54:55], v[54:55], v[126:127]
    v_pk_fma_f32 v[58:59], v[126:127], v[126:127], v[58:59]
    v_cvt_pk_bf16_f32 v44, v44, v44
    s_waitcnt vmcnt(16)
    v_lshlrev_b32 v160, 16, v164
    v_and_b32 v161, 0xffff0000, v164
    v_and_b32 v44, 0xffff0000, v44
    buffer_load_dwordx4 v11, s[8:11], s52 offen offset:2048 lds
    v_lshlrev_b32 v162, 16, v165
    v_and_b32 v163, 0xffff0000, v165
    v_cvt_pk_bf16_f32 v48, v48, v48
    v_lshlrev_b32 v164, 16, v166
    v_and_b32 v165, 0xffff0000, v166
    v_and_b32 v48, 0xffff0000, v48
    v_lshlrev_b32 v166, 16, v167
    v_and_b32 v167, 0xffff0000, v167
    v_rcp_f32 v60, v48
    v_pk_add_f32 v[52:53], v[52:53], v[160:161]
    v_pk_fma_f32 v[56:57], v[160:161], v[160:161], v[56:57]
    v_mul_f32_e64 v61, -v44, v60
    v_pk_add_f32 v[54:55], v[54:55], v[162:163]
    v_pk_fma_f32 v[58:59], v[162:163], v[162:163], v[58:59]
    s_add_u32 m0, s71, 105472
    s_mul_i32 s52, s67, 6
    buffer_load_dwordx4 v11, s[8:11], s52 offen lds
    v_pk_fma_f32 v[192:193], v[192:193], v[60:61], v[60:61] op_sel:[0,0,1] op_sel_hi:[1,0,1]
    v_pk_add_f32 v[52:53], v[52:53], v[164:165]
    v_pk_fma_f32 v[56:57], v[164:165], v[164:165], v[56:57]
    v_pk_fma_f32 v[194:195], v[194:195], v[60:61], v[60:61] op_sel:[0,0,1] op_sel_hi:[1,0,1]
    v_pk_add_f32 v[54:55], v[54:55], v[166:167]
    v_pk_fma_f32 v[58:59], v[166:167], v[166:167], v[58:59]
    v_pk_fma_f32 v[196:197], v[196:197], v[60:61], v[60:61] op_sel:[0,0,1] op_sel_hi:[1,0,1]
    v_pk_fma_f32 v[198:199], v[198:199], v[60:61], v[60:61] op_sel:[0,0,1] op_sel_hi:[1,0,1]
    v_pk_fma_f32 v[72:73], v[72:73], v[60:61], v[60:61] op_sel:[0,0,1] op_sel_hi:[1,0,1]
    v_pk_fma_f32 v[74:75], v[74:75], v[60:61], v[60:61] op_sel:[0,0,1] op_sel_hi:[1,0,1]
    v_pk_fma_f32 v[76:77], v[76:77], v[60:61], v[60:61] op_sel:[0,0,1] op_sel_hi:[1,0,1]
    v_pk_fma_f32 v[78:79], v[78:79], v[60:61], v[60:61] op_sel:[0,0,1] op_sel_hi:[1,0,1]
    v_pk_fma_f32 v[112:113], v[112:113], v[60:61], v[60:61] op_sel:[0,0,1] op_sel_hi:[1,0,1]
    v_pk_fma_f32 v[114:115], v[114:115], v[60:61], v[60:61] op_sel:[0,0,1] op_sel_hi:[1,0,1]
    buffer_load_dwordx4 v11, s[8:11], s52 offen offset:1024 lds
    v_pk_fma_f32 v[116:117], v[116:117], v[60:61], v[60:61] op_sel:[0,0,1] op_sel_hi:[1,0,1]
    v_pk_fma_f32 v[118:119], v[118:119], v[60:61], v[60:61] op_sel:[0,0,1] op_sel_hi:[1,0,1]
    v_pk_fma_f32 v[152:153], v[152:153], v[60:61], v[60:61] op_sel:[0,0,1] op_sel_hi:[1,0,1]
    v_pk_fma_f32 v[154:155], v[154:155], v[60:61], v[60:61] op_sel:[0,0,1] op_sel_hi:[1,0,1]
    v_pk_fma_f32 v[156:157], v[156:157], v[60:61], v[60:61] op_sel:[0,0,1] op_sel_hi:[1,0,1]
    v_pk_fma_f32 v[158:159], v[158:159], v[60:61], v[60:61] op_sel:[0,0,1] op_sel_hi:[1,0,1]
    s_waitcnt vmcnt(18)
    v_lshlrev_b32 v208, 16, v212
    v_and_b32 v209, 0xffff0000, v212
    v_pk_add_f32 v[52:53], v[52:53], v[54:55]
    v_lshlrev_b32 v210, 16, v213
    v_and_b32 v211, 0xffff0000, v213
    v_pk_add_f32 v[56:57], v[56:57], v[58:59]
    v_lshlrev_b32 v212, 16, v214
    v_and_b32 v213, 0xffff0000, v214
    v_add_f32 v52, v52, v53
    v_lshlrev_b32 v214, 16, v215
    v_and_b32 v215, 0xffff0000, v215
    v_add_f32 v56, v56, v57
    v_pk_add_f32 v[44:45], v[208:209], v[212:213]
    v_pk_mul_f32 v[48:49], v[208:209], v[208:209]
    v_add_f32_dpp v52, v52, v52 row_ror:8 row_mask:0xf bank_mask:0xf
    v_pk_add_f32 v[46:47], v[210:211], v[214:215]
    buffer_load_dwordx4 v11, s[8:11], s52 offen offset:2048 lds
    v_pk_mul_f32 v[50:51], v[210:211], v[210:211]
    v_add_f32_dpp v56, v56, v56 row_ror:8 row_mask:0xf bank_mask:0xf
    v_pk_fma_f32 v[48:49], v[212:213], v[212:213], v[48:49]
    v_pk_fma_f32 v[50:51], v[214:215], v[214:215], v[50:51]
    v_add_f32_dpp v52, v52, v52 row_ror:4 row_mask:0xf bank_mask:0xf
    s_waitcnt vmcnt(18)
    v_lshlrev_b32 v88, 16, v92
    v_and_b32 v89, 0xffff0000, v92
    v_add_f32_dpp v56, v56, v56 row_ror:4 row_mask:0xf bank_mask:0xf
    v_lshlrev_b32 v90, 16, v93
    v_and_b32 v91, 0xffff0000, v93
    v_add_f32_dpp v52, v52, v52 row_ror:2 row_mask:0xf bank_mask:0xf
    v_lshlrev_b32 v92, 16, v94
    v_and_b32 v93, 0xffff0000, v94
    v_add_f32_dpp v56, v56, v56 row_ror:2 row_mask:0xf bank_mask:0xf
    s_add_u32 m0, s71, 117760
    s_mul_i32 s52, s68, 6
    buffer_load_dwordx4 v11, s[8:11], s52 offen lds
    v_lshlrev_b32 v94, 16, v95
    v_and_b32 v95, 0xffff0000, v95
    v_add_f32_dpp v52, v52, v52 row_ror:1 row_mask:0xf bank_mask:0xf
    v_pk_add_f32 v[44:45], v[44:45], v[88:89]
    v_pk_fma_f32 v[48:49], v[88:89], v[88:89], v[48:49]
    v_add_f32_dpp v56, v56, v56 row_ror:1 row_mask:0xf bank_mask:0xf
    v_pk_add_f32 v[46:47], v[46:47], v[90:91]
    v_pk_fma_f32 v[50:51], v[90:91], v[90:91], v[50:51]
    v_mul_f32 v52, 0x3b000000, v52
    v_pk_add_f32 v[44:45], v[44:45], v[92:93]
    v_pk_fma_f32 v[48:49], v[92:93], v[92:93], v[48:49]
    v_mul_f32 v56, 0x3b000000, v56
    v_pk_add_f32 v[46:47], v[46:47], v[94:95]
    v_pk_fma_f32 v[50:51], v[94:95], v[94:95], v[50:51]
    buffer_load_dwordx4 v11, s[8:11], s52 offen offset:1024 lds
    v_fma_f32 v56, -v52, v52, v56
    s_waitcnt vmcnt(19)
    v_lshlrev_b32 v128, 16, v132
    v_and_b32 v129, 0xffff0000, v132
    v_max_f32 v56, 0, v56
    v_lshlrev_b32 v130, 16, v133
    v_and_b32 v131, 0xffff0000, v133
    v_cvt_pk_bf16_f32 v56, v56, v56
    v_lshlrev_b32 v132, 16, v134
    v_and_b32 v133, 0xffff0000, v134
    v_and_b32 v56, 0xffff0000, v56
    v_lshlrev_b32 v134, 16, v135
    v_and_b32 v135, 0xffff0000, v135
    v_add_f32 v56, 0x3727c5ac, v56
    v_pk_add_f32 v[44:45], v[44:45], v[128:129]
    buffer_load_dwordx4 v11, s[8:11], s52 offen offset:2048 lds
    v_pk_fma_f32 v[48:49], v[128:129], v[128:129], v[48:49]
    v_cvt_pk_bf16_f32 v56, v56, v56
    v_pk_add_f32 v[46:47], v[46:47], v[130:131]
    v_pk_fma_f32 v[50:51], v[130:131], v[130:131], v[50:51]
    v_and_b32 v56, 0xffff0000, v56
    v_pk_add_f32 v[44:45], v[44:45], v[132:133]
    v_pk_fma_f32 v[48:49], v[132:133], v[132:133], v[48:49]
    v_sqrt_f32 v56, v56
    v_pk_add_f32 v[46:47], v[46:47], v[134:135]
    v_pk_fma_f32 v[50:51], v[134:135], v[134:135], v[50:51]
    v_cvt_pk_bf16_f32 v52, v52, v52
    s_waitcnt vmcnt(19)
    v_lshlrev_b32 v168, 16, v172
    v_and_b32 v169, 0xffff0000, v172
    v_and_b32 v52, 0xffff0000, v52
    s_add_u32 m0, s71, 130048
    s_mul_i32 s52, s69, 6
    buffer_load_dwordx4 v11, s[8:11], s52 offen lds
    v_lshlrev_b32 v170, 16, v173
    v_and_b32 v171, 0xffff0000, v173
    v_cvt_pk_bf16_f32 v56, v56, v56
    v_lshlrev_b32 v172, 16, v174
    v_and_b32 v173, 0xffff0000, v174
    v_and_b32 v56, 0xffff0000, v56
    v_lshlrev_b32 v174, 16, v175
    v_and_b32 v175, 0xffff0000, v175
    v_rcp_f32 v62, v56
    v_pk_add_f32 v[44:45], v[44:45], v[168:169]
    v_pk_fma_f32 v[48:49], v[168:169], v[168:169], v[48:49]
    v_mul_f32_e64 v63, -v52, v62
    v_pk_add_f32 v[46:47], v[46:47], v[170:171]
    v_pk_fma_f32 v[50:51], v[170:171], v[170:171], v[50:51]
    buffer_load_dwordx4 v11, s[8:11], s52 offen offset:1024 lds
    v_pk_fma_f32 v[200:201], v[200:201], v[62:63], v[62:63] op_sel:[0,0,1] op_sel_hi:[1,0,1]
    v_pk_add_f32 v[44:45], v[44:45], v[172:173]
    v_pk_fma_f32 v[48:49], v[172:173], v[172:173], v[48:49]
    v_pk_fma_f32 v[202:203], v[202:203], v[62:63], v[62:63] op_sel:[0,0,1] op_sel_hi:[1,0,1]
    v_pk_add_f32 v[46:47], v[46:47], v[174:175]
    v_pk_fma_f32 v[50:51], v[174:175], v[174:175], v[50:51]
    v_pk_fma_f32 v[204:205], v[204:205], v[62:63], v[62:63] op_sel:[0,0,1] op_sel_hi:[1,0,1]
    v_pk_fma_f32 v[206:207], v[206:207], v[62:63], v[62:63] op_sel:[0,0,1] op_sel_hi:[1,0,1]
    v_pk_fma_f32 v[80:81], v[80:81], v[62:63], v[62:63] op_sel:[0,0,1] op_sel_hi:[1,0,1]
    v_pk_fma_f32 v[82:83], v[82:83], v[62:63], v[62:63] op_sel:[0,0,1] op_sel_hi:[1,0,1]
    v_pk_fma_f32 v[84:85], v[84:85], v[62:63], v[62:63] op_sel:[0,0,1] op_sel_hi:[1,0,1]
    v_pk_fma_f32 v[86:87], v[86:87], v[62:63], v[62:63] op_sel:[0,0,1] op_sel_hi:[1,0,1]
    v_pk_fma_f32 v[120:121], v[120:121], v[62:63], v[62:63] op_sel:[0,0,1] op_sel_hi:[1,0,1]
    v_pk_fma_f32 v[122:123], v[122:123], v[62:63], v[62:63] op_sel:[0,0,1] op_sel_hi:[1,0,1]
    buffer_load_dwordx4 v11, s[8:11], s52 offen offset:2048 lds
    v_pk_fma_f32 v[124:125], v[124:125], v[62:63], v[62:63] op_sel:[0,0,1] op_sel_hi:[1,0,1]
    v_pk_fma_f32 v[126:127], v[126:127], v[62:63], v[62:63] op_sel:[0,0,1] op_sel_hi:[1,0,1]
    v_pk_fma_f32 v[160:161], v[160:161], v[62:63], v[62:63] op_sel:[0,0,1] op_sel_hi:[1,0,1]
    v_pk_fma_f32 v[162:163], v[162:163], v[62:63], v[62:63] op_sel:[0,0,1] op_sel_hi:[1,0,1]
    v_pk_fma_f32 v[164:165], v[164:165], v[62:63], v[62:63] op_sel:[0,0,1] op_sel_hi:[1,0,1]
    v_pk_fma_f32 v[166:167], v[166:167], v[62:63], v[62:63] op_sel:[0,0,1] op_sel_hi:[1,0,1]
    s_waitcnt vmcnt(21)
    v_lshlrev_b32 v216, 16, v220
    v_and_b32 v217, 0xffff0000, v220
    v_pk_add_f32 v[44:45], v[44:45], v[46:47]
    v_lshlrev_b32 v218, 16, v221
    v_and_b32 v219, 0xffff0000, v221
    v_pk_add_f32 v[48:49], v[48:49], v[50:51]
    v_lshlrev_b32 v220, 16, v222
    v_and_b32 v221, 0xffff0000, v222
    v_add_f32 v44, v44, v45
    v_lshlrev_b32 v222, 16, v223
    v_and_b32 v223, 0xffff0000, v223
    v_add_f32 v48, v48, v49
    v_pk_add_f32 v[52:53], v[216:217], v[220:221]
    v_pk_mul_f32 v[56:57], v[216:217], v[216:217]
    v_add_f32_dpp v44, v44, v44 row_ror:8 row_mask:0xf bank_mask:0xf
    v_pk_add_f32 v[54:55], v[218:219], v[222:223]
    s_add_u32 m0, s71, 142336
    s_mul_i32 s52, s66, 6
    s_add_u32 s52, s52, 393216
    buffer_load_dwordx4 v11, s[8:11], s52 offen lds
    v_pk_mul_f32 v[58:59], v[218:219], v[218:219]
    v_add_f32_dpp v48, v48, v48 row_ror:8 row_mask:0xf bank_mask:0xf
    v_pk_fma_f32 v[56:57], v[220:221], v[220:221], v[56:57]
    v_pk_fma_f32 v[58:59], v[222:223], v[222:223], v[58:59]
    v_add_f32_dpp v44, v44, v44 row_ror:4 row_mask:0xf bank_mask:0xf
    s_waitcnt vmcnt(21)
    v_lshlrev_b32 v96, 16, v100
    v_and_b32 v97, 0xffff0000, v100
    v_add_f32_dpp v48, v48, v48 row_ror:4 row_mask:0xf bank_mask:0xf
    v_lshlrev_b32 v98, 16, v101
    v_and_b32 v99, 0xffff0000, v101
    v_add_f32_dpp v44, v44, v44 row_ror:2 row_mask:0xf bank_mask:0xf
    v_lshlrev_b32 v100, 16, v102
    v_and_b32 v101, 0xffff0000, v102
    v_add_f32_dpp v48, v48, v48 row_ror:2 row_mask:0xf bank_mask:0xf
    buffer_load_dwordx4 v11, s[8:11], s52 offen offset:1024 lds
    v_lshlrev_b32 v102, 16, v103
    v_and_b32 v103, 0xffff0000, v103
    v_add_f32_dpp v44, v44, v44 row_ror:1 row_mask:0xf bank_mask:0xf
    v_pk_add_f32 v[52:53], v[52:53], v[96:97]
    v_pk_fma_f32 v[56:57], v[96:97], v[96:97], v[56:57]
    v_add_f32_dpp v48, v48, v48 row_ror:1 row_mask:0xf bank_mask:0xf
    v_pk_add_f32 v[54:55], v[54:55], v[98:99]
    v_pk_fma_f32 v[58:59], v[98:99], v[98:99], v[58:59]
    v_mul_f32 v44, 0x3b000000, v44
    v_pk_add_f32 v[52:53], v[52:53], v[100:101]
    v_pk_fma_f32 v[56:57], v[100:101], v[100:101], v[56:57]
    v_mul_f32 v48, 0x3b000000, v48
    v_pk_add_f32 v[54:55], v[54:55], v[102:103]
    v_pk_fma_f32 v[58:59], v[102:103], v[102:103], v[58:59]
    buffer_load_dwordx4 v11, s[8:11], s52 offen offset:2048 lds
    v_fma_f32 v48, -v44, v44, v48
    s_waitcnt vmcnt(22)
    v_lshlrev_b32 v136, 16, v140
    v_and_b32 v137, 0xffff0000, v140
    v_max_f32 v48, 0, v48
    v_lshlrev_b32 v138, 16, v141
    v_and_b32 v139, 0xffff0000, v141
    v_cvt_pk_bf16_f32 v48, v48, v48
    v_lshlrev_b32 v140, 16, v142
    v_and_b32 v141, 0xffff0000, v142
    v_and_b32 v48, 0xffff0000, v48
    v_lshlrev_b32 v142, 16, v143
    v_and_b32 v143, 0xffff0000, v143
    v_add_f32 v48, 0x3727c5ac, v48
    v_pk_add_f32 v[52:53], v[52:53], v[136:137]
    v_pk_fma_f32 v[56:57], v[136:137], v[136:137], v[56:57]
    v_cvt_pk_bf16_f32 v48, v48, v48
    v_pk_add_f32 v[54:55], v[54:55], v[138:139]
    v_pk_fma_f32 v[58:59], v[138:139], v[138:139], v[58:59]
    v_and_b32 v48, 0xffff0000, v48
    v_pk_add_f32 v[52:53], v[52:53], v[140:141]
    v_pk_fma_f32 v[56:57], v[140:141], v[140:141], v[56:57]
    v_sqrt_f32 v48, v48
    v_pk_add_f32 v[54:55], v[54:55], v[142:143]
    v_pk_fma_f32 v[58:59], v[142:143], v[142:143], v[58:59]
    v_cvt_pk_bf16_f32 v44, v44, v44
    s_waitcnt vmcnt(21)
    v_lshlrev_b32 v176, 16, v180
    v_and_b32 v177, 0xffff0000, v180
    v_and_b32 v44, 0xffff0000, v44
    v_lshlrev_b32 v178, 16, v181
    v_and_b32 v179, 0xffff0000, v181
    v_cvt_pk_bf16_f32 v48, v48, v48
    v_lshlrev_b32 v180, 16, v182
    v_and_b32 v181, 0xffff0000, v182
    v_and_b32 v48, 0xffff0000, v48
    v_lshlrev_b32 v182, 16, v183
    v_and_b32 v183, 0xffff0000, v183
    v_rcp_f32 v60, v48
    v_pk_add_f32 v[52:53], v[52:53], v[176:177]
    v_pk_fma_f32 v[56:57], v[176:177], v[176:177], v[56:57]
    v_mul_f32_e64 v61, -v44, v60
    v_pk_add_f32 v[54:55], v[54:55], v[178:179]
    v_pk_fma_f32 v[58:59], v[178:179], v[178:179], v[58:59]
    v_pk_fma_f32 v[208:209], v[208:209], v[60:61], v[60:61] op_sel:[0,0,1] op_sel_hi:[1,0,1]
    v_pk_add_f32 v[52:53], v[52:53], v[180:181]
    v_pk_fma_f32 v[56:57], v[180:181], v[180:181], v[56:57]
    v_pk_fma_f32 v[210:211], v[210:211], v[60:61], v[60:61] op_sel:[0,0,1] op_sel_hi:[1,0,1]
    v_pk_add_f32 v[54:55], v[54:55], v[182:183]
    v_pk_fma_f32 v[58:59], v[182:183], v[182:183], v[58:59]
    v_pk_fma_f32 v[212:213], v[212:213], v[60:61], v[60:61] op_sel:[0,0,1] op_sel_hi:[1,0,1]
    v_pk_fma_f32 v[214:215], v[214:215], v[60:61], v[60:61] op_sel:[0,0,1] op_sel_hi:[1,0,1]
    v_pk_fma_f32 v[88:89], v[88:89], v[60:61], v[60:61] op_sel:[0,0,1] op_sel_hi:[1,0,1]
    v_pk_fma_f32 v[90:91], v[90:91], v[60:61], v[60:61] op_sel:[0,0,1] op_sel_hi:[1,0,1]
    v_pk_fma_f32 v[92:93], v[92:93], v[60:61], v[60:61] op_sel:[0,0,1] op_sel_hi:[1,0,1]
    v_pk_fma_f32 v[94:95], v[94:95], v[60:61], v[60:61] op_sel:[0,0,1] op_sel_hi:[1,0,1]
    v_pk_fma_f32 v[128:129], v[128:129], v[60:61], v[60:61] op_sel:[0,0,1] op_sel_hi:[1,0,1]
    v_pk_fma_f32 v[130:131], v[130:131], v[60:61], v[60:61] op_sel:[0,0,1] op_sel_hi:[1,0,1]
    v_pk_fma_f32 v[132:133], v[132:133], v[60:61], v[60:61] op_sel:[0,0,1] op_sel_hi:[1,0,1]
    v_pk_fma_f32 v[134:135], v[134:135], v[60:61], v[60:61] op_sel:[0,0,1] op_sel_hi:[1,0,1]
    v_pk_fma_f32 v[168:169], v[168:169], v[60:61], v[60:61] op_sel:[0,0,1] op_sel_hi:[1,0,1]
    v_pk_fma_f32 v[170:171], v[170:171], v[60:61], v[60:61] op_sel:[0,0,1] op_sel_hi:[1,0,1]
    v_pk_fma_f32 v[172:173], v[172:173], v[60:61], v[60:61] op_sel:[0,0,1] op_sel_hi:[1,0,1]
    v_pk_fma_f32 v[174:175], v[174:175], v[60:61], v[60:61] op_sel:[0,0,1] op_sel_hi:[1,0,1]
    s_waitcnt vmcnt(20)
    v_lshlrev_b32 v224, 16, v228
    v_and_b32 v225, 0xffff0000, v228
    v_pk_add_f32 v[52:53], v[52:53], v[54:55]
    v_lshlrev_b32 v226, 16, v229
    v_and_b32 v227, 0xffff0000, v229
    v_pk_add_f32 v[56:57], v[56:57], v[58:59]
    v_lshlrev_b32 v228, 16, v230
    v_and_b32 v229, 0xffff0000, v230
    v_add_f32 v52, v52, v53
    v_lshlrev_b32 v230, 16, v231
    v_and_b32 v231, 0xffff0000, v231
    v_add_f32 v56, v56, v57
    v_pk_add_f32 v[44:45], v[224:225], v[228:229]
    v_pk_mul_f32 v[48:49], v[224:225], v[224:225]
    v_add_f32_dpp v52, v52, v52 row_ror:8 row_mask:0xf bank_mask:0xf
    v_pk_add_f32 v[46:47], v[226:227], v[230:231]
    v_pk_mul_f32 v[50:51], v[226:227], v[226:227]
    v_add_f32_dpp v56, v56, v56 row_ror:8 row_mask:0xf bank_mask:0xf
    v_pk_fma_f32 v[48:49], v[228:229], v[228:229], v[48:49]
    v_pk_fma_f32 v[50:51], v[230:231], v[230:231], v[50:51]
    v_add_f32_dpp v52, v52, v52 row_ror:4 row_mask:0xf bank_mask:0xf
    s_waitcnt vmcnt(19)
    v_lshlrev_b32 v104, 16, v108
    v_and_b32 v105, 0xffff0000, v108
    v_add_f32_dpp v56, v56, v56 row_ror:4 row_mask:0xf bank_mask:0xf
    v_lshlrev_b32 v106, 16, v109
    v_and_b32 v107, 0xffff0000, v109
    v_add_f32_dpp v52, v52, v52 row_ror:2 row_mask:0xf bank_mask:0xf
    v_lshlrev_b32 v108, 16, v110
    v_and_b32 v109, 0xffff0000, v110
    v_add_f32_dpp v56, v56, v56 row_ror:2 row_mask:0xf bank_mask:0xf
    v_lshlrev_b32 v110, 16, v111
    v_and_b32 v111, 0xffff0000, v111
    v_add_f32_dpp v52, v52, v52 row_ror:1 row_mask:0xf bank_mask:0xf
    v_pk_add_f32 v[44:45], v[44:45], v[104:105]
    v_pk_fma_f32 v[48:49], v[104:105], v[104:105], v[48:49]
    v_add_f32_dpp v56, v56, v56 row_ror:1 row_mask:0xf bank_mask:0xf
    v_pk_add_f32 v[46:47], v[46:47], v[106:107]
    v_pk_fma_f32 v[50:51], v[106:107], v[106:107], v[50:51]
    v_mul_f32 v52, 0x3b000000, v52
    v_pk_add_f32 v[44:45], v[44:45], v[108:109]
    v_pk_fma_f32 v[48:49], v[108:109], v[108:109], v[48:49]
    v_mul_f32 v56, 0x3b000000, v56
    v_pk_add_f32 v[46:47], v[46:47], v[110:111]
    v_pk_fma_f32 v[50:51], v[110:111], v[110:111], v[50:51]
    v_fma_f32 v56, -v52, v52, v56
    s_waitcnt vmcnt(18)
    v_lshlrev_b32 v144, 16, v148
    v_and_b32 v145, 0xffff0000, v148
    v_max_f32 v56, 0, v56
    v_lshlrev_b32 v146, 16, v149
    v_and_b32 v147, 0xffff0000, v149
    v_cvt_pk_bf16_f32 v56, v56, v56
    v_lshlrev_b32 v148, 16, v150
    v_and_b32 v149, 0xffff0000, v150
    v_and_b32 v56, 0xffff0000, v56
    v_lshlrev_b32 v150, 16, v151
    v_and_b32 v151, 0xffff0000, v151
    v_add_f32 v56, 0x3727c5ac, v56
    v_pk_add_f32 v[44:45], v[44:45], v[144:145]
    v_pk_fma_f32 v[48:49], v[144:145], v[144:145], v[48:49]
    v_cvt_pk_bf16_f32 v56, v56, v56
    v_pk_add_f32 v[46:47], v[46:47], v[146:147]
    v_pk_fma_f32 v[50:51], v[146:147], v[146:147], v[50:51]
    v_and_b32 v56, 0xffff0000, v56
    v_pk_add_f32 v[44:45], v[44:45], v[148:149]
    v_pk_fma_f32 v[48:49], v[148:149], v[148:149], v[48:49]
    v_sqrt_f32 v56, v56
    v_pk_add_f32 v[46:47], v[46:47], v[150:151]
    v_pk_fma_f32 v[50:51], v[150:151], v[150:151], v[50:51]
    v_cvt_pk_bf16_f32 v52, v52, v52
    s_waitcnt vmcnt(17)
    v_lshlrev_b32 v184, 16, v188
    v_and_b32 v185, 0xffff0000, v188
    v_and_b32 v52, 0xffff0000, v52
    v_lshlrev_b32 v186, 16, v189
    v_and_b32 v187, 0xffff0000, v189
    v_cvt_pk_bf16_f32 v56, v56, v56
    v_lshlrev_b32 v188, 16, v190
    v_and_b32 v189, 0xffff0000, v190
    v_and_b32 v56, 0xffff0000, v56
    v_lshlrev_b32 v190, 16, v191
    v_and_b32 v191, 0xffff0000, v191
    v_rcp_f32 v62, v56
    v_pk_add_f32 v[44:45], v[44:45], v[184:185]
    v_pk_fma_f32 v[48:49], v[184:185], v[184:185], v[48:49]
    v_mul_f32_e64 v63, -v52, v62
    v_pk_add_f32 v[46:47], v[46:47], v[186:187]
    v_pk_fma_f32 v[50:51], v[186:187], v[186:187], v[50:51]
    v_pk_fma_f32 v[216:217], v[216:217], v[62:63], v[62:63] op_sel:[0,0,1] op_sel_hi:[1,0,1]
    v_pk_add_f32 v[44:45], v[44:45], v[188:189]
    v_pk_fma_f32 v[48:49], v[188:189], v[188:189], v[48:49]
    v_pk_fma_f32 v[218:219], v[218:219], v[62:63], v[62:63] op_sel:[0,0,1] op_sel_hi:[1,0,1]
    v_pk_add_f32 v[46:47], v[46:47], v[190:191]
    v_pk_fma_f32 v[50:51], v[190:191], v[190:191], v[50:51]
    v_pk_fma_f32 v[220:221], v[220:221], v[62:63], v[62:63] op_sel:[0,0,1] op_sel_hi:[1,0,1]
    v_pk_fma_f32 v[222:223], v[222:223], v[62:63], v[62:63] op_sel:[0,0,1] op_sel_hi:[1,0,1]
    v_pk_fma_f32 v[96:97], v[96:97], v[62:63], v[62:63] op_sel:[0,0,1] op_sel_hi:[1,0,1]
    v_pk_fma_f32 v[98:99], v[98:99], v[62:63], v[62:63] op_sel:[0,0,1] op_sel_hi:[1,0,1]
    v_pk_fma_f32 v[100:101], v[100:101], v[62:63], v[62:63] op_sel:[0,0,1] op_sel_hi:[1,0,1]
    v_pk_fma_f32 v[102:103], v[102:103], v[62:63], v[62:63] op_sel:[0,0,1] op_sel_hi:[1,0,1]
    v_pk_fma_f32 v[136:137], v[136:137], v[62:63], v[62:63] op_sel:[0,0,1] op_sel_hi:[1,0,1]
    v_pk_fma_f32 v[138:139], v[138:139], v[62:63], v[62:63] op_sel:[0,0,1] op_sel_hi:[1,0,1]
    v_pk_fma_f32 v[140:141], v[140:141], v[62:63], v[62:63] op_sel:[0,0,1] op_sel_hi:[1,0,1]
    v_pk_fma_f32 v[142:143], v[142:143], v[62:63], v[62:63] op_sel:[0,0,1] op_sel_hi:[1,0,1]
    v_pk_fma_f32 v[176:177], v[176:177], v[62:63], v[62:63] op_sel:[0,0,1] op_sel_hi:[1,0,1]
    v_pk_fma_f32 v[178:179], v[178:179], v[62:63], v[62:63] op_sel:[0,0,1] op_sel_hi:[1,0,1]
    v_pk_fma_f32 v[180:181], v[180:181], v[62:63], v[62:63] op_sel:[0,0,1] op_sel_hi:[1,0,1]
    v_pk_fma_f32 v[182:183], v[182:183], v[62:63], v[62:63] op_sel:[0,0,1] op_sel_hi:[1,0,1]
    v_pk_add_f32 v[44:45], v[44:45], v[46:47]
    v_pk_add_f32 v[48:49], v[48:49], v[50:51]
    v_add_f32 v44, v44, v45
    v_add_f32 v48, v48, v49
    s_nop 0
    v_add_f32_dpp v44, v44, v44 row_ror:8 row_mask:0xf bank_mask:0xf
    v_add_f32_dpp v48, v48, v48 row_ror:8 row_mask:0xf bank_mask:0xf
    s_nop 0
    v_add_f32_dpp v44, v44, v44 row_ror:4 row_mask:0xf bank_mask:0xf
    v_add_f32_dpp v48, v48, v48 row_ror:4 row_mask:0xf bank_mask:0xf
    s_nop 0
    v_add_f32_dpp v44, v44, v44 row_ror:2 row_mask:0xf bank_mask:0xf
    v_add_f32_dpp v48, v48, v48 row_ror:2 row_mask:0xf bank_mask:0xf
    s_nop 0
    v_add_f32_dpp v44, v44, v44 row_ror:1 row_mask:0xf bank_mask:0xf
    v_add_f32_dpp v48, v48, v48 row_ror:1 row_mask:0xf bank_mask:0xf
    v_mul_f32 v44, 0x3b000000, v44
    v_mul_f32 v48, 0x3b000000, v48
    v_fma_f32 v48, -v44, v44, v48
    v_max_f32 v48, 0, v48
    v_cvt_pk_bf16_f32 v48, v48, v48
    v_and_b32 v48, 0xffff0000, v48
    v_add_f32 v48, 0x3727c5ac, v48
    v_cvt_pk_bf16_f32 v48, v48, v48
    v_and_b32 v48, 0xffff0000, v48
    v_sqrt_f32 v48, v48
    v_cvt_pk_bf16_f32 v44, v44, v44
    v_and_b32 v44, 0xffff0000, v44
    v_cvt_pk_bf16_f32 v48, v48, v48
    v_and_b32 v48, 0xffff0000, v48
    v_rcp_f32 v60, v48
    s_nop 0
    v_mul_f32_e64 v61, -v44, v60
    v_pk_fma_f32 v[224:225], v[224:225], v[60:61], v[60:61] op_sel:[0,0,1] op_sel_hi:[1,0,1]
    v_pk_fma_f32 v[226:227], v[226:227], v[60:61], v[60:61] op_sel:[0,0,1] op_sel_hi:[1,0,1]
    v_pk_fma_f32 v[228:229], v[228:229], v[60:61], v[60:61] op_sel:[0,0,1] op_sel_hi:[1,0,1]
    v_pk_fma_f32 v[230:231], v[230:231], v[60:61], v[60:61] op_sel:[0,0,1] op_sel_hi:[1,0,1]
    v_pk_fma_f32 v[104:105], v[104:105], v[60:61], v[60:61] op_sel:[0,0,1] op_sel_hi:[1,0,1]
    v_pk_fma_f32 v[106:107], v[106:107], v[60:61], v[60:61] op_sel:[0,0,1] op_sel_hi:[1,0,1]
    v_pk_fma_f32 v[108:109], v[108:109], v[60:61], v[60:61] op_sel:[0,0,1] op_sel_hi:[1,0,1]
    v_pk_fma_f32 v[110:111], v[110:111], v[60:61], v[60:61] op_sel:[0,0,1] op_sel_hi:[1,0,1]
    v_pk_fma_f32 v[144:145], v[144:145], v[60:61], v[60:61] op_sel:[0,0,1] op_sel_hi:[1,0,1]
    v_pk_fma_f32 v[146:147], v[146:147], v[60:61], v[60:61] op_sel:[0,0,1] op_sel_hi:[1,0,1]
    v_pk_fma_f32 v[148:149], v[148:149], v[60:61], v[60:61] op_sel:[0,0,1] op_sel_hi:[1,0,1]
    v_pk_fma_f32 v[150:151], v[150:151], v[60:61], v[60:61] op_sel:[0,0,1] op_sel_hi:[1,0,1]
    v_pk_fma_f32 v[184:185], v[184:185], v[60:61], v[60:61] op_sel:[0,0,1] op_sel_hi:[1,0,1]
    v_pk_fma_f32 v[186:187], v[186:187], v[60:61], v[60:61] op_sel:[0,0,1] op_sel_hi:[1,0,1]
    v_pk_fma_f32 v[188:189], v[188:189], v[60:61], v[60:61] op_sel:[0,0,1] op_sel_hi:[1,0,1]
    v_pk_fma_f32 v[190:191], v[190:191], v[60:61], v[60:61] op_sel:[0,0,1] op_sel_hi:[1,0,1]
    v_accvgpr_read_b32 v18, a6
    v_accvgpr_read_b32 v7, a7
    v_accvgpr_read_b32 v8, a8
    v_accvgpr_read_b32 v19, a4
    v_accvgpr_read_b32 v20, a5
    v_accvgpr_read_b32 v26, a9
    s_add_u32 s57, s44, 1
    s_bfe_u32 s57, s57, 0x10001
    v_xor_b32 v9, s57, v8
    v_lshl_add_u32 v22, v9, 4, v7
    s_add_u32 s57, s44, 2
    s_bfe_u32 s57, s57, 0x10001
    v_xor_b32 v9, s57, v8
    v_lshl_add_u32 v23, v9, 4, v7
    s_add_u32 s57, s44, 3
    s_bfe_u32 s57, s57, 0x10001
    v_xor_b32 v9, s57, v8
    v_lshl_add_u32 v24, v9, 4, v7
    s_add_u32 s57, s44, 4
    s_bfe_u32 s57, s57, 0x10001
    v_xor_b32 v9, s57, v8
    v_lshl_add_u32 v25, v9, 4, v7
    v_xor_b32 v29, 32, v26
    v_add_u32 v27, 61440, v26
    v_add_u32 v30, 61440, v29
    v_add_u32 v28, 122880, v26
    v_add_u32 v31, 122880, v29
    s_mov_b32 s3, 12288
    s_mov_b32 s0, 24576
    s_mov_b32 s1, 36864
    v_accvgpr_read_b32 v8, a10
    v_lshlrev_b32 v7, 4, v0
    v_add_u32 v7, 61440, v7
    v_add_u32 v18, 61440, v18
    v_add_u32 v48, 43520, v19
    v_add_u32 v49, 43520, v20
    s_mov_b32 s53, 0
Lpoll_3:
    s_add_u32 s53, s53, 1
    s_cmp_gt_u32 s53, 65536
    s_cbranch_scc1 Lexit
    buffer_load_dwordx4 v[32:35], v8, s[36:39], 0 offen sc1
    buffer_load_dwordx4 v[36:39], v8, s[36:39], s3 offen sc1
    buffer_load_dwordx4 v[40:43], v8, s[36:39], s0 offen sc1
    buffer_load_dwordx4 v[44:47], v8, s[36:39], s1 offen sc1
    s_waitcnt vmcnt(0)
    v_xor_b32 v9, s73, v32
    v_xor_b32 v10, s74, v33
    v_bitop3_b32 v9, v34, s75, v9 bitop3:0xbe
    v_bitop3_b32 v10, v35, s76, v10 bitop3:0xbe
    v_bitop3_b32 v9, v36, s73, v9 bitop3:0xbe
    v_bitop3_b32 v10, v37, s74, v10 bitop3:0xbe
    v_bitop3_b32 v9, v38, s75, v9 bitop3:0xbe
    v_bitop3_b32 v10, v39, s76, v10 bitop3:0xbe
    v_bitop3_b32 v9, v40, s73, v9 bitop3:0xbe
    v_bitop3_b32 v10, v41, s74, v10 bitop3:0xbe
    v_bitop3_b32 v9, v42, s75, v9 bitop3:0xbe
    v_bitop3_b32 v10, v43, s76, v10 bitop3:0xbe
    v_bitop3_b32 v9, v44, s73, v9 bitop3:0xbe
    v_bitop3_b32 v10, v45, s74, v10 bitop3:0xbe
    v_bitop3_b32 v9, v46, s75, v9 bitop3:0xbe
    v_bitop3_b32 v10, v47, s76, v10 bitop3:0xbe
    v_or_b32 v9, v9, v10
    v_and_b32 v9, 0xff, v9
    v_cmp_ne_u32 vcc, 0, v9
    s_cbranch_vccnz Lpoll_3
    v_and_b32 v32, 0xffffff00, v32
    v_and_b32 v33, 0xffffff00, v33
    v_and_b32 v34, 0xffffff00, v34
    v_and_b32 v35, 0xffffff00, v35
    v_and_b32 v36, 0xffffff00, v36
    v_and_b32 v37, 0xffffff00, v37
    v_and_b32 v38, 0xffffff00, v38
    v_and_b32 v39, 0xffffff00, v39
    v_and_b32 v40, 0xffffff00, v40
    v_and_b32 v41, 0xffffff00, v41
    v_and_b32 v42, 0xffffff00, v42
    v_and_b32 v43, 0xffffff00, v43
    v_and_b32 v44, 0xffffff00, v44
    v_and_b32 v45, 0xffffff00, v45
    v_and_b32 v46, 0xffffff00, v46
    v_and_b32 v47, 0xffffff00, v47
    v_pk_add_f32 v[32:33], v[32:33], v[36:37]
    v_pk_add_f32 v[34:35], v[34:35], v[38:39]
    v_pk_add_f32 v[40:41], v[40:41], v[44:45]
    v_pk_add_f32 v[42:43], v[42:43], v[46:47]
    v_pk_add_f32 v[32:33], v[32:33], v[40:41]
    v_pk_add_f32 v[34:35], v[34:35], v[42:43]
    v_cvt_pk_bf16_f32 v32, v32, v33
    v_cvt_pk_bf16_f32 v34, v34, v35
    v_lshlrev_b32 v52, 16, v32
    v_and_b32 v53, 0xffff0000, v32
    v_lshlrev_b32 v54, 16, v34
    v_and_b32 v55, 0xffff0000, v34
    s_cmp_lt_u32 s44, 2
    s_cbranch_scc1 Lnoa_4
    v_pk_add_f32 v[52:53], v[52:53], 1.0 op_sel_hi:[1,0]
    v_pk_add_f32 v[54:55], v[54:55], 1.0 op_sel_hi:[1,0]
    v_cvt_pk_bf16_f32 v32, v52, v53
    v_cvt_pk_bf16_f32 v34, v54, v55
    v_lshlrev_b32 v52, 16, v32
    v_and_b32 v53, 0xffff0000, v32
    v_lshlrev_b32 v54, 16, v34
    v_and_b32 v55, 0xffff0000, v34
Lnoa_4:
    ds_write_b128 v7, v[52:55] offset:27648
    s_waitcnt lgkmcnt(0)
    s_barrier
    ds_read_b128 v[56:59], v18 offset:27648
    ds_read_b128 v[64:67], v18 offset:29696
    ds_read_b128 v[60:63], v18 offset:27664
    ds_read_b128 v[68:71], v18 offset:29712
    ds_read_b128 v[232:235], v18 offset:28160
    ds_read_b128 v[240:243], v18 offset:30208
    ds_read_b128 v[236:239], v18 offset:28176
    ds_read_b128 v[244:247], v18 offset:30224
    v_accvgpr_read_b32 v7, a1
    buffer_load_dword a252, v7, s[12:15], 0 offen
    s_waitcnt lgkmcnt(6)
    v_pk_fma_f32 v[192:193], v[192:193], v[64:65], v[56:57]
    v_pk_fma_f32 v[194:195], v[194:195], v[66:67], v[58:59]
    s_waitcnt lgkmcnt(4)
    v_pk_fma_f32 v[196:197], v[196:197], v[68:69], v[60:61]
    v_pk_fma_f32 v[198:199], v[198:199], v[70:71], v[62:63]
    v_cvt_pk_bf16_f32 v192, v192, v193
    v_cvt_pk_bf16_f32 v193, v194, v195
    v_cvt_pk_bf16_f32 v194, v196, v197
    v_cvt_pk_bf16_f32 v195, v198, v199
    ds_write_b128 v22, v[192:195] offset:2048
    v_accvgpr_read_b32 v7, a2
    buffer_load_dword a252, v7, s[16:19], 0 offen
    v_pk_fma_f32 v[200:201], v[200:201], v[64:65], v[56:57]
    v_pk_fma_f32 v[202:203], v[202:203], v[66:67], v[58:59]
    v_pk_fma_f32 v[204:205], v[204:205], v[68:69], v[60:61]
    v_pk_fma_f32 v[206:207], v[206:207], v[70:71], v[62:63]
    v_cvt_pk_bf16_f32 v200, v200, v201
    v_cvt_pk_bf16_f32 v201, v202, v203
    v_cvt_pk_bf16_f32 v202, v204, v205
    v_cvt_pk_bf16_f32 v203, v206, v207
    ds_write_b128 v23, v[200:203] offset:3136
    buffer_load_dword a252, v7, s[20:23], 0 offen
    v_pk_fma_f32 v[208:209], v[208:209], v[64:65], v[56:57]
    v_pk_fma_f32 v[210:211], v[210:211], v[66:67], v[58:59]
    v_pk_fma_f32 v[212:213], v[212:213], v[68:69], v[60:61]
    v_pk_fma_f32 v[214:215], v[214:215], v[70:71], v[62:63]
    v_cvt_pk_bf16_f32 v208, v208, v209
    v_cvt_pk_bf16_f32 v209, v210, v211
    v_cvt_pk_bf16_f32 v210, v212, v213
    v_cvt_pk_bf16_f32 v211, v214, v215
    ds_write_b128 v24, v[208:211] offset:4224
    buffer_load_dword a252, v7, s[24:27], 0 offen
    v_pk_fma_f32 v[216:217], v[216:217], v[64:65], v[56:57]
    v_pk_fma_f32 v[218:219], v[218:219], v[66:67], v[58:59]
    v_pk_fma_f32 v[220:221], v[220:221], v[68:69], v[60:61]
    v_pk_fma_f32 v[222:223], v[222:223], v[70:71], v[62:63]
    v_cvt_pk_bf16_f32 v216, v216, v217
    v_cvt_pk_bf16_f32 v217, v218, v219
    v_cvt_pk_bf16_f32 v218, v220, v221
    v_cvt_pk_bf16_f32 v219, v222, v223
    ds_write_b128 v25, v[216:219] offset:5312
    s_cmp_ge_u32 s48, 14
    s_cselect_b32 s18, 0, s18
    s_cselect_b32 s22, 0, s22
    v_pk_fma_f32 v[224:225], v[224:225], v[64:65], v[56:57]
    v_pk_fma_f32 v[226:227], v[226:227], v[66:67], v[58:59]
    v_pk_fma_f32 v[228:229], v[228:229], v[68:69], v[60:61]
    v_pk_fma_f32 v[230:231], v[230:231], v[70:71], v[62:63]
    v_cvt_pk_bf16_f32 v224, v224, v225
    v_cvt_pk_bf16_f32 v225, v226, v227
    v_cvt_pk_bf16_f32 v226, v228, v229
    v_cvt_pk_bf16_f32 v227, v230, v231
    ds_write_b128 v22, v[224:227] offset:6400
    ds_read_b128 v[56:59], v18 offset:28672
    ds_read_b128 v[64:67], v18 offset:30720
    ds_read_b128 v[60:63], v18 offset:28688
    ds_read_b128 v[68:71], v18 offset:30736
    s_waitcnt lgkmcnt(11)
    v_pk_fma_f32 v[72:73], v[72:73], v[240:241], v[232:233]
    v_pk_fma_f32 v[74:75], v[74:75], v[242:243], v[234:235]
    s_waitcnt lgkmcnt(9)
    v_pk_fma_f32 v[76:77], v[76:77], v[244:245], v[236:237]
    v_pk_fma_f32 v[78:79], v[78:79], v[246:247], v[238:239]
    v_cvt_pk_bf16_f32 v72, v72, v73
    v_cvt_pk_bf16_f32 v73, v74, v75
    v_cvt_pk_bf16_f32 v74, v76, v77
    v_cvt_pk_bf16_f32 v75, v78, v79
    ds_write_b128 v22, v[72:75] offset:23808
    v_pk_fma_f32 v[80:81], v[80:81], v[240:241], v[232:233]
    v_pk_fma_f32 v[82:83], v[82:83], v[242:243], v[234:235]
    v_pk_fma_f32 v[84:85], v[84:85], v[244:245], v[236:237]
    v_pk_fma_f32 v[86:87], v[86:87], v[246:247], v[238:239]
    v_cvt_pk_bf16_f32 v80, v80, v81
    v_cvt_pk_bf16_f32 v81, v82, v83
    v_cvt_pk_bf16_f32 v82, v84, v85
    v_cvt_pk_bf16_f32 v83, v86, v87
    ds_write_b128 v23, v[80:83] offset:24896
    v_pk_fma_f32 v[88:89], v[88:89], v[240:241], v[232:233]
    v_pk_fma_f32 v[90:91], v[90:91], v[242:243], v[234:235]
    v_pk_fma_f32 v[92:93], v[92:93], v[244:245], v[236:237]
    v_pk_fma_f32 v[94:95], v[94:95], v[246:247], v[238:239]
    v_cvt_pk_bf16_f32 v88, v88, v89
    v_cvt_pk_bf16_f32 v89, v90, v91
    v_cvt_pk_bf16_f32 v90, v92, v93
    v_cvt_pk_bf16_f32 v91, v94, v95
    ds_write_b128 v24, v[88:91] offset:25984
    v_pk_fma_f32 v[96:97], v[96:97], v[240:241], v[232:233]
    v_pk_fma_f32 v[98:99], v[98:99], v[242:243], v[234:235]
    v_pk_fma_f32 v[100:101], v[100:101], v[244:245], v[236:237]
    v_pk_fma_f32 v[102:103], v[102:103], v[246:247], v[238:239]
    v_cvt_pk_bf16_f32 v96, v96, v97
    v_cvt_pk_bf16_f32 v97, v98, v99
    v_cvt_pk_bf16_f32 v98, v100, v101
    v_cvt_pk_bf16_f32 v99, v102, v103
    ds_write_b128 v25, v[96:99] offset:27072
    v_pk_fma_f32 v[104:105], v[104:105], v[240:241], v[232:233]
    v_pk_fma_f32 v[106:107], v[106:107], v[242:243], v[234:235]
    v_pk_fma_f32 v[108:109], v[108:109], v[244:245], v[236:237]
    v_pk_fma_f32 v[110:111], v[110:111], v[246:247], v[238:239]
    v_cvt_pk_bf16_f32 v104, v104, v105
    v_cvt_pk_bf16_f32 v105, v106, v107
    v_cvt_pk_bf16_f32 v106, v108, v109
    v_cvt_pk_bf16_f32 v107, v110, v111
    ds_write_b128 v22, v[104:107] offset:28160
    ds_read_b128 v[232:235], v18 offset:29184
    ds_read_b128 v[240:243], v18 offset:31232
    ds_read_b128 v[236:239], v18 offset:29200
    ds_read_b128 v[244:247], v18 offset:31248
    s_waitcnt lgkmcnt(11)
    v_pk_fma_f32 v[112:113], v[112:113], v[64:65], v[56:57]
    v_pk_fma_f32 v[114:115], v[114:115], v[66:67], v[58:59]
    s_waitcnt lgkmcnt(9)
    v_pk_fma_f32 v[116:117], v[116:117], v[68:69], v[60:61]
    v_pk_fma_f32 v[118:119], v[118:119], v[70:71], v[62:63]
    v_cvt_pk_bf16_f32 v112, v112, v113
    v_cvt_pk_bf16_f32 v113, v114, v115
    v_cvt_pk_bf16_f32 v114, v116, v117
    v_cvt_pk_bf16_f32 v115, v118, v119
    ds_write_b128 v22, v[112:115] offset:45568
    v_pk_fma_f32 v[120:121], v[120:121], v[64:65], v[56:57]
    v_pk_fma_f32 v[122:123], v[122:123], v[66:67], v[58:59]
    v_pk_fma_f32 v[124:125], v[124:125], v[68:69], v[60:61]
    v_pk_fma_f32 v[126:127], v[126:127], v[70:71], v[62:63]
    v_cvt_pk_bf16_f32 v120, v120, v121
    v_cvt_pk_bf16_f32 v121, v122, v123
    v_cvt_pk_bf16_f32 v122, v124, v125
    v_cvt_pk_bf16_f32 v123, v126, v127
    ds_write_b128 v23, v[120:123] offset:46656
    v_pk_fma_f32 v[128:129], v[128:129], v[64:65], v[56:57]
    v_pk_fma_f32 v[130:131], v[130:131], v[66:67], v[58:59]
    v_pk_fma_f32 v[132:133], v[132:133], v[68:69], v[60:61]
    v_pk_fma_f32 v[134:135], v[134:135], v[70:71], v[62:63]
    v_cvt_pk_bf16_f32 v128, v128, v129
    v_cvt_pk_bf16_f32 v129, v130, v131
    v_cvt_pk_bf16_f32 v130, v132, v133
    v_cvt_pk_bf16_f32 v131, v134, v135
    ds_write_b128 v24, v[128:131] offset:47744
    v_pk_fma_f32 v[136:137], v[136:137], v[64:65], v[56:57]
    v_pk_fma_f32 v[138:139], v[138:139], v[66:67], v[58:59]
    v_pk_fma_f32 v[140:141], v[140:141], v[68:69], v[60:61]
    v_pk_fma_f32 v[142:143], v[142:143], v[70:71], v[62:63]
    v_cvt_pk_bf16_f32 v136, v136, v137
    v_cvt_pk_bf16_f32 v137, v138, v139
    v_cvt_pk_bf16_f32 v138, v140, v141
    v_cvt_pk_bf16_f32 v139, v142, v143
    ds_write_b128 v25, v[136:139] offset:48832
    v_pk_fma_f32 v[144:145], v[144:145], v[64:65], v[56:57]
    v_pk_fma_f32 v[146:147], v[146:147], v[66:67], v[58:59]
    v_pk_fma_f32 v[148:149], v[148:149], v[68:69], v[60:61]
    v_pk_fma_f32 v[150:151], v[150:151], v[70:71], v[62:63]
    v_cvt_pk_bf16_f32 v144, v144, v145
    v_cvt_pk_bf16_f32 v145, v146, v147
    v_cvt_pk_bf16_f32 v146, v148, v149
    v_cvt_pk_bf16_f32 v147, v150, v151
    ds_write_b128 v22, v[144:147] offset:49920
    s_waitcnt lgkmcnt(7)
    v_pk_fma_f32 v[152:153], v[152:153], v[240:241], v[232:233]
    v_pk_fma_f32 v[154:155], v[154:155], v[242:243], v[234:235]
    s_waitcnt lgkmcnt(5)
    v_pk_fma_f32 v[156:157], v[156:157], v[244:245], v[236:237]
    v_pk_fma_f32 v[158:159], v[158:159], v[246:247], v[238:239]
    v_cvt_pk_bf16_f32 v152, v152, v153
    v_cvt_pk_bf16_f32 v153, v154, v155
    v_cvt_pk_bf16_f32 v154, v156, v157
    v_cvt_pk_bf16_f32 v155, v158, v159
    v_add_u32 v22, 43520, v22
    ds_write_b128 v22, v[152:155] offset:23808
    v_pk_fma_f32 v[160:161], v[160:161], v[240:241], v[232:233]
    v_pk_fma_f32 v[162:163], v[162:163], v[242:243], v[234:235]
    v_pk_fma_f32 v[164:165], v[164:165], v[244:245], v[236:237]
    v_pk_fma_f32 v[166:167], v[166:167], v[246:247], v[238:239]
    v_cvt_pk_bf16_f32 v160, v160, v161
    v_cvt_pk_bf16_f32 v161, v162, v163
    v_cvt_pk_bf16_f32 v162, v164, v165
    v_cvt_pk_bf16_f32 v163, v166, v167
    v_add_u32 v23, 43520, v23
    ds_write_b128 v23, v[160:163] offset:24896
    v_pk_fma_f32 v[168:169], v[168:169], v[240:241], v[232:233]
    v_pk_fma_f32 v[170:171], v[170:171], v[242:243], v[234:235]
    v_pk_fma_f32 v[172:173], v[172:173], v[244:245], v[236:237]
    v_pk_fma_f32 v[174:175], v[174:175], v[246:247], v[238:239]
    v_cvt_pk_bf16_f32 v168, v168, v169
    v_cvt_pk_bf16_f32 v169, v170, v171
    v_cvt_pk_bf16_f32 v170, v172, v173
    v_cvt_pk_bf16_f32 v171, v174, v175
    v_add_u32 v24, 43520, v24
    ds_write_b128 v24, v[168:171] offset:25984
    v_pk_fma_f32 v[176:177], v[176:177], v[240:241], v[232:233]
    v_pk_fma_f32 v[178:179], v[178:179], v[242:243], v[234:235]
    v_pk_fma_f32 v[180:181], v[180:181], v[244:245], v[236:237]
    v_pk_fma_f32 v[182:183], v[182:183], v[246:247], v[238:239]
    v_cvt_pk_bf16_f32 v176, v176, v177
    v_cvt_pk_bf16_f32 v177, v178, v179
    v_cvt_pk_bf16_f32 v178, v180, v181
    v_cvt_pk_bf16_f32 v179, v182, v183
    v_add_u32 v25, 43520, v25
    ds_write_b128 v25, v[176:179] offset:27072
    v_pk_fma_f32 v[184:185], v[184:185], v[240:241], v[232:233]
    v_pk_fma_f32 v[186:187], v[186:187], v[242:243], v[234:235]
    v_pk_fma_f32 v[188:189], v[188:189], v[244:245], v[236:237]
    v_pk_fma_f32 v[190:191], v[190:191], v[246:247], v[238:239]
    v_cvt_pk_bf16_f32 v184, v184, v185
    v_cvt_pk_bf16_f32 v185, v186, v187
    v_cvt_pk_bf16_f32 v186, v188, v189
    v_cvt_pk_bf16_f32 v187, v190, v191
    ds_write_b128 v22, v[184:187] offset:28160
    s_waitcnt lgkmcnt(0)
    s_barrier
    ds_read_b128 a[28:31], v19 offset:2048
    ds_read_b64_tr_b16 a[40:41], v27 offset:32768
    ds_read_b64_tr_b16 a[42:43], v27 offset:33280
    ds_read_b128 a[32:35], v19 offset:6400
    ds_read_b64_tr_b16 a[44:45], v27 offset:33792
    ds_read_b64_tr_b16 a[46:47], v27 offset:34304
    ds_read_b128 a[36:39], v20 offset:2048
    ds_read_b64_tr_b16 a[48:49], v27 offset:31744
    ds_read_b64_tr_b16 a[50:51], v27 offset:32256
    ds_read_b64_tr_b16 a[52:53], v30 offset:32768
    ds_read_b64_tr_b16 a[54:55], v30 offset:33280
    ds_read_b64_tr_b16 a[56:57], v30 offset:33792
    ds_read_b64_tr_b16 a[58:59], v30 offset:34304
    ds_read_b64_tr_b16 a[60:61], v30 offset:31744
    ds_read_b64_tr_b16 a[62:63], v30 offset:32256
    s_waitcnt lgkmcnt(6)
    v_mfma_f32_16x16x32_bf16 v[208:211], a[40:43], a[28:31], 0
    s_barrier
    ds_read_b128 a[64:67], v19 offset:2112
    ds_read_b64_tr_b16 a[76:77], v27 offset:45056
    v_mfma_f32_16x16x32_bf16 v[212:215], a[40:43], a[32:35], 0
    ds_read_b64_tr_b16 a[78:79], v27 offset:45568
    s_and_b32 s57, s2, 3
    s_mul_i32 s57, s57, 49152
    v_mfma_f32_16x16x32_bf16 v[240:243], a[40:43], a[36:39], 0
    ds_read_b128 a[68:71], v19 offset:6464
    s_lshl_b32 s59, s44, 11
    s_lshl_b32 s58, s49, 8
    v_mfma_f32_16x16x32_bf16 v[224:227], a[28:31], a[44:47], 0
    ds_read_b64_tr_b16 a[80:81], v27 offset:46080
    s_add_u32 s58, s58, s57
    s_add_u32 s58, s58, s59
    v_mfma_f32_16x16x32_bf16 v[228:231], a[32:35], a[44:47], 0
    ds_read_b64_tr_b16 a[82:83], v27 offset:46592
    s_add_u32 s58, s58, 69632
    v_and_b32 v92, 15, v1
    v_mfma_f32_16x16x32_bf16 v[244:247], a[36:39], a[44:47], 0
    ds_read_b128 a[72:75], v20 offset:2112
    v_lshl_add_u32 v88, v92, 4, s58
    v_accvgpr_write_b32 a11, v88
    v_mfma_f32_16x16x32_bf16 v[192:195], a[48:51], a[28:31], 0
    ds_read_b64_tr_b16 a[84:85], v27 offset:44032
    s_lshl_b32 s57, s47, 6
    v_lshl_add_u32 v88, v92, 2, s57
    v_mfma_f32_16x16x32_bf16 v[196:199], a[48:51], a[32:35], 0
    ds_read_b64_tr_b16 a[86:87], v27 offset:44544
    v_accvgpr_write_b32 a20, v88
    s_waitcnt lgkmcnt(9)
    v_mfma_f32_16x16x32_bf16 v[216:219], a[52:55], a[28:31], 0
    ds_read_b64_tr_b16 a[88:89], v30 offset:45056
    s_lshl_b32 s57, s61, 2
    s_add_u32 s57, s57, s44
    v_mfma_f32_16x16x32_bf16 v[220:223], a[52:55], a[32:35], 0
    ds_read_b64_tr_b16 a[90:91], v30 offset:45568
    s_mul_i32 s57, s57, 4096
    s_add_u32 s57, s57, 384
    v_mfma_f32_16x16x32_bf16 v[232:235], a[28:31], a[56:59], 0
    ds_read_b64_tr_b16 a[92:93], v30 offset:46080
    v_lshl_add_u32 v88, v1, 10, s57
    v_sub_u32 v89, 3, v1
    v_mfma_f32_16x16x32_bf16 v[236:239], a[32:35], a[56:59], 0
    ds_read_b64_tr_b16 a[94:95], v30 offset:46592
    v_and_b32 v89, 0x80000000, v89
    v_or_b32 v88, v88, v89
    v_mfma_f32_16x16x32_bf16 v[200:203], a[60:63], a[28:31], 0
    ds_read_b64_tr_b16 a[96:97], v30 offset:44032
    v_accvgpr_write_b32 a21, v88
    s_lshl_b32 s57, s61, 2
    v_mfma_f32_16x16x32_bf16 v[204:207], a[60:63], a[32:35], 0
    ds_read_b64_tr_b16 a[98:99], v30 offset:44544
    s_add_u32 s57, s57, s44
    s_waitcnt lgkmcnt(6)
    v_mfma_f32_16x16x32_bf16 v[208:211], a[76:79], a[64:67], v[208:211]
    s_barrier
    ds_read_b128 a[28:31], v19 offset:2176
    ds_read_b64_tr_b16 a[40:41], v27 offset:57344
    s_add_u32 m0, s71, 89088
    v_mfma_f32_16x16x32_bf16 v[212:215], a[76:79], a[68:71], v[212:215]
    ds_read_b64_tr_b16 a[42:43], v27 offset:57856
    s_mul_i32 s52, s67, 6
    s_add_u32 s52, s52, 393216
    buffer_load_dwordx4 v11, s[8:11], s52 offen lds
    v_mfma_f32_16x16x32_bf16 v[240:243], a[76:79], a[72:75], v[240:243]
    ds_read_b128 a[32:35], v19 offset:6528
    buffer_load_dwordx4 v11, s[8:11], s52 offen offset:1024 lds
    s_mul_i32 s57, s57, 14336
    v_mfma_f32_16x16x32_bf16 v[224:227], a[64:67], a[80:83], v[224:227]
    ds_read_b64_tr_b16 a[44:45], v27 offset:58368
    s_add_u32 s57, s57, 384
    v_lshl_add_u32 v88, v1, 10, s57
    v_mfma_f32_16x16x32_bf16 v[228:231], a[68:71], a[80:83], v[228:231]
    ds_read_b64_tr_b16 a[46:47], v27 offset:58880
    buffer_load_dwordx4 v11, s[8:11], s52 offen offset:2048 lds
    v_sub_u32 v89, 13, v1
    v_mfma_f32_16x16x32_bf16 v[244:247], a[72:75], a[80:83], v[244:247]
    ds_read_b128 a[36:39], v20 offset:2176
    v_and_b32 v89, 0x80000000, v89
    v_or_b32 v88, v88, v89
    v_mfma_f32_16x16x32_bf16 v[192:195], a[84:87], a[64:67], v[192:195]
    ds_read_b64_tr_b16 a[48:49], v27 offset:56320
    v_accvgpr_write_b32 a22, v88
    s_sub_u32 s58, s50, s45
    v_mfma_f32_16x16x32_bf16 v[196:199], a[84:87], a[68:71], v[196:199]
    ds_read_b64_tr_b16 a[50:51], v27 offset:56832
    s_lshl_b32 s58, s58, 5
    s_waitcnt lgkmcnt(9)
    v_mfma_f32_16x16x32_bf16 v[216:219], a[88:91], a[64:67], v[216:219]
    ds_read_b64_tr_b16 a[52:53], v30 offset:57344
    s_lshl_b32 s59, s44, 4
    s_add_u32 s58, s58, s59
    v_mfma_f32_16x16x32_bf16 v[220:223], a[88:91], a[68:71], v[220:223]
    ds_read_b64_tr_b16 a[54:55], v30 offset:57856
    v_lshrrev_b32 v88, 3, v1
    v_add_u32 v89, s58, v88
    v_mfma_f32_16x16x32_bf16 v[232:235], a[64:67], a[92:95], v[232:235]
    ds_read_b64_tr_b16 a[56:57], v30 offset:58368
    v_lshlrev_b32 v89, 10, v89
    v_and_b32 v90, 7, v1
    v_mfma_f32_16x16x32_bf16 v[236:239], a[68:71], a[92:95], v[236:239]
    ds_read_b64_tr_b16 a[58:59], v30 offset:58880
    v_lshlrev_b32 v90, 4, v90
    s_lshl_b32 s58, s49, 7
    v_mfma_f32_16x16x32_bf16 v[200:203], a[96:99], a[64:67], v[200:203]
    ds_read_b64_tr_b16 a[60:61], v30 offset:56320
    v_add3_u32 v89, v89, v90, s58
    v_add_u32 v88, s59, v88
    v_mfma_f32_16x16x32_bf16 v[204:207], a[96:99], a[68:71], v[204:207]
    ds_read_b64_tr_b16 a[62:63], v30 offset:56832
    v_mul_u32_u24 v88, 144, v88
    s_waitcnt lgkmcnt(6)
    v_mfma_f32_16x16x32_bf16 v[208:211], a[40:43], a[28:31], v[208:211]
    s_barrier
    ds_read_b128 a[64:67], v19 offset:2240
    ds_read_b64_tr_b16 a[76:77], v28 offset:8192
    s_add_u32 m0, s71, 101376
    v_mfma_f32_16x16x32_bf16 v[212:215], a[40:43], a[32:35], v[212:215]
    ds_read_b64_tr_b16 a[78:79], v28 offset:8704
    s_mul_i32 s52, s68, 6
    s_add_u32 s52, s52, 393216
    buffer_load_dwordx4 v11, s[8:11], s52 offen lds
    v_mfma_f32_16x16x32_bf16 v[240:243], a[40:43], a[36:39], v[240:243]
    ds_read_b128 a[68:71], v19 offset:6592
    buffer_load_dwordx4 v11, s[8:11], s52 offen offset:1024 lds
    v_add_u32 v88, v88, v90
    v_mfma_f32_16x16x32_bf16 v[224:227], a[28:31], a[44:47], v[224:227]
    ds_read_b64_tr_b16 a[80:81], v28 offset:9216
    v_accvgpr_write_b32 a23, v89
    v_accvgpr_write_b32 a24, v88
    v_mfma_f32_16x16x32_bf16 v[228:231], a[32:35], a[44:47], v[228:231]
    ds_read_b64_tr_b16 a[82:83], v28 offset:9728
    buffer_load_dwordx4 v11, s[8:11], s52 offen offset:2048 lds
    s_lshl_b32 s57, s50, 5
    v_mfma_f32_16x16x32_bf16 v[244:247], a[36:39], a[44:47], v[244:247]
    ds_read_b128 a[72:75], v20 offset:2240
    s_lshl_b32 s58, s49, 2
    s_add_u32 s57, s57, s58
    v_mfma_f32_16x16x32_bf16 v[192:195], a[48:51], a[28:31], v[192:195]
    ds_read_b64_tr_b16 a[84:85], v28 offset:7168
    s_lshl_b32 s58, s46, 1
    s_add_u32 s57, s57, s58
    v_mfma_f32_16x16x32_bf16 v[196:199], a[48:51], a[32:35], v[196:199]
    ds_read_b64_tr_b16 a[86:87], v28 offset:7680
    s_lshl_b32 s57, s57, 10
    s_waitcnt lgkmcnt(9)
    v_mfma_f32_16x16x32_bf16 v[216:219], a[52:55], a[28:31], v[216:219]
    ds_read_b64_tr_b16 a[88:89], v31 offset:8192
    s_add_u32 s64, s57, 1048576
    s_lshl_b32 s57, s47, 11
    v_mfma_f32_16x16x32_bf16 v[220:223], a[52:55], a[32:35], v[220:223]
    ds_read_b64_tr_b16 a[90:91], v31 offset:8704
    s_add_u32 s57, s57, 4096
    s_lshl_b32 s58, s44, 9
    v_mfma_f32_16x16x32_bf16 v[232:235], a[28:31], a[56:59], v[232:235]
    ds_read_b64_tr_b16 a[92:93], v31 offset:9216
    s_add_u32 s57, s57, s58
    v_lshl_add_u32 v88, v1, 3, s57
    v_mfma_f32_16x16x32_bf16 v[236:239], a[32:35], a[56:59], v[236:239]
    ds_read_b64_tr_b16 a[94:95], v31 offset:9728
    v_accvgpr_write_b32 a25, v88
    s_lshl_b32 s57, s50, 5
    v_mfma_f32_16x16x32_bf16 v[200:203], a[60:63], a[28:31], v[200:203]
    ds_read_b64_tr_b16 a[96:97], v31 offset:7168
    s_lshl_b32 s58, s46, 4
    s_add_u32 s57, s57, s58
    v_mfma_f32_16x16x32_bf16 v[204:207], a[60:63], a[32:35], v[204:207]
    ds_read_b64_tr_b16 a[98:99], v31 offset:7680
    v_add_u32 v88, s57, v92
    s_waitcnt lgkmcnt(6)
    v_mfma_f32_16x16x32_bf16 v[208:211], a[76:79], a[64:67], v[208:211]
    s_barrier
    ds_read_b128 a[28:31], v19 offset:23808
    ds_read_b64_tr_b16 a[40:41], v28 offset:20480
    s_add_u32 m0, s71, 113664
    v_mfma_f32_16x16x32_bf16 v[212:215], a[76:79], a[68:71], v[212:215]
    ds_read_b64_tr_b16 a[42:43], v28 offset:20992
    s_mul_i32 s52, s69, 6
    s_add_u32 s52, s52, 393216
    buffer_load_dwordx4 v11, s[8:11], s52 offen lds
    v_mfma_f32_16x16x32_bf16 v[240:243], a[76:79], a[72:75], v[240:243]
    ds_read_b128 a[32:35], v19 offset:28160
    buffer_load_dwordx4 v11, s[8:11], s52 offen offset:1024 lds
    v_lshlrev_b32 v88, 10, v88
    v_mfma_f32_16x16x32_bf16 v[224:227], a[64:67], a[80:83], v[224:227]
    ds_read_b64_tr_b16 a[44:45], v28 offset:21504
    v_and_b32 v89, 16, v1
    v_lshl_add_u32 v88, v89, 1, v88
    v_mfma_f32_16x16x32_bf16 v[228:231], a[68:71], a[80:83], v[228:231]
    ds_read_b64_tr_b16 a[46:47], v28 offset:22016
    buffer_load_dwordx4 v11, s[8:11], s52 offen offset:2048 lds
    s_lshl_b32 s57, s49, 7
    v_mfma_f32_16x16x32_bf16 v[244:247], a[72:75], a[80:83], v[244:247]
    ds_read_b128 a[36:39], v20 offset:23808
    v_lshlrev_b32 v89, 4, v3
    v_add3_u32 v88, v88, v89, s57
    v_mfma_f32_16x16x32_bf16 v[192:195], a[84:87], a[64:67], v[192:195]
    ds_read_b64_tr_b16 a[48:49], v28 offset:19456
    v_accvgpr_write_b32 a26, v88
    s_lshl_b32 s57, s47, 2
    v_mfma_f32_16x16x32_bf16 v[196:199], a[84:87], a[68:71], v[196:199]
    ds_read_b64_tr_b16 a[50:51], v28 offset:19968
    s_add_u32 s57, s57, s44
    s_waitcnt lgkmcnt(9)
    v_mfma_f32_16x16x32_bf16 v[216:219], a[88:91], a[64:67], v[216:219]
    ds_read_b64_tr_b16 a[52:53], v31 offset:20480
    s_mul_i32 s57, s57, 112
    s_lshl_b32 s58, s48, 3
    v_mfma_f32_16x16x32_bf16 v[220:223], a[88:91], a[68:71], v[220:223]
    ds_read_b64_tr_b16 a[54:55], v31 offset:20992
    s_add_u32 s57, s57, s58
    s_lshl_b32 s57, s57, 10
    v_mfma_f32_16x16x32_bf16 v[232:235], a[64:67], a[92:95], v[232:235]
    ds_read_b64_tr_b16 a[56:57], v31 offset:21504
    s_add_u32 s65, s57, 5242880
    s_cmp_ge_u32 s48, 14
    s_cselect_b32 s65, 0x40000000, s65
    v_mfma_f32_16x16x32_bf16 v[236:239], a[68:71], a[92:95], v[236:239]
    ds_read_b64_tr_b16 a[58:59], v31 offset:22016
    s_mul_i32 s57, s46, 6144
    s_lshl_b32 s58, s45, 9
    v_mfma_f32_16x16x32_bf16 v[200:203], a[96:99], a[64:67], v[200:203]
    ds_read_b64_tr_b16 a[60:61], v31 offset:19456
    s_add_u32 s57, s57, s58
    v_lshl_add_u32 v32, v1, 3, s57
    v_mfma_f32_16x16x32_bf16 v[204:207], a[96:99], a[68:71], v[204:207]
    ds_read_b64_tr_b16 a[62:63], v31 offset:19968
    s_lshl_b32 s58, s45, 11
    s_waitcnt lgkmcnt(6)
    v_mfma_f32_16x16x32_bf16 v[208:211], a[40:43], a[28:31], v[208:211]
    s_waitcnt vmcnt(6)
    s_barrier
    ds_read_b128 a[64:67], v19 offset:23872
    ds_read_b64_tr_b16 a[76:77], v27 offset:28672
    v_mfma_f32_16x16x32_bf16 v[212:215], a[40:43], a[32:35], v[212:215]
    ds_read_b64_tr_b16 a[78:79], v27 offset:29184
    s_add_u32 m0, s71, 125952
    s_mul_i32 s52, s66, 6
    s_add_u32 s52, s52, 786432
    v_mfma_f32_16x16x32_bf16 v[240:243], a[40:43], a[36:39], v[240:243]
    ds_read_b128 a[68:71], v19 offset:28224
    buffer_load_dwordx4 v11, s[8:11], s52 offen lds
    v_add_u32 v33, s58, v32
    v_mfma_f32_16x16x32_bf16 v[224:227], a[28:31], a[44:47], v[224:227]
    ds_read_b64_tr_b16 a[80:81], v27 offset:29696
    buffer_load_dwordx4 v11, s[8:11], s52 offen offset:1024 lds
    s_lshl_b32 s58, s45, 10
    v_mfma_f32_16x16x32_bf16 v[228:231], a[32:35], a[44:47], v[228:231]
    ds_read_b64_tr_b16 a[82:83], v27 offset:30208
    buffer_load_dwordx4 v11, s[8:11], s52 offen offset:2048 lds
    s_add_u32 s58, s58, 512
    v_mfma_f32_16x16x32_bf16 v[244:247], a[36:39], a[44:47], v[244:247]
    ds_read_b128 a[72:75], v20 offset:23872
    v_add_u32 v34, s58, v32
    v_lshrrev_b32 v88, 2, v1
    v_mfma_f32_16x16x32_bf16 v[192:195], a[48:51], a[28:31], v[192:195]
    ds_read_b64_tr_b16 a[84:85], v27 offset:27648
    v_and_b32 v88, 12, v88
    v_sub_u32 v88, v92, v88
    v_mfma_f32_16x16x32_bf16 v[196:199], a[48:51], a[32:35], v[196:199]
    ds_read_b64_tr_b16 a[86:87], v27 offset:28160
    v_mov_b32 v89, 0xcf6e6b28
    s_waitcnt lgkmcnt(9)
    v_mfma_f32_16x16x32_bf16 v[216:219], a[52:55], a[28:31], v[216:219]
    ds_read_b64_tr_b16 a[88:89], v30 offset:28672
    s_cmp_eq_u32 s50, 0
    s_cselect_b32 s57, 0xcf6e6b28, 0
    v_mfma_f32_16x16x32_bf16 v[220:223], a[52:55], a[32:35], v[220:223]
    ds_read_b64_tr_b16 a[90:91], v30 offset:29184
    v_subrev_u32 v90, 0, v88
    v_and_b32 v91, 0x80000001, v90
    v_mfma_f32_16x16x32_bf16 v[232:235], a[28:31], a[56:59], v[232:235]
    ds_read_b64_tr_b16 a[92:93], v30 offset:29696
    v_cmp_eq_u32 vcc, 0, v91
    s_nop 1
    v_cndmask_b32 v96, v89, 0, vcc
    v_mfma_f32_16x16x32_bf16 v[236:239], a[32:35], a[56:59], v[236:239]
    ds_read_b64_tr_b16 a[94:95], v30 offset:30208
    v_cmp_eq_u32 vcc, 2147483648, v91
    s_nop 1
    v_cndmask_b32 v100, v89, 0, vcc
    v_mfma_f32_16x16x32_bf16 v[200:203], a[60:63], a[28:31], v[200:203]
    ds_read_b64_tr_b16 a[96:97], v30 offset:27648
    v_min_f32 v104, s57, v100
    v_subrev_u32 v90, 1, v88
    v_mfma_f32_16x16x32_bf16 v[204:207], a[60:63], a[32:35], v[204:207]
    ds_read_b64_tr_b16 a[98:99], v30 offset:28160
    v_and_b32 v91, 0x80000001, v90
    s_waitcnt lgkmcnt(6)
    v_mfma_f32_16x16x32_bf16 v[208:211], a[76:79], a[64:67], v[208:211]
    s_waitcnt vmcnt(6)
    s_barrier
    ds_read_b128 a[28:31], v19 offset:23936
    ds_read_b64_tr_b16 a[40:41], v27 offset:40960
    v_mfma_f32_16x16x32_bf16 v[212:215], a[76:79], a[68:71], v[212:215]
    ds_read_b64_tr_b16 a[42:43], v27 offset:41472
    s_add_u32 m0, s71, 2048
    s_mul_i32 s52, s67, 6
    s_add_u32 s52, s52, 786432
    v_mfma_f32_16x16x32_bf16 v[240:243], a[76:79], a[72:75], v[240:243]
    ds_read_b128 a[32:35], v19 offset:28288
    buffer_load_dwordx4 v11, s[8:11], s52 offen lds
    v_cmp_eq_u32 vcc, 0, v91
    s_nop 1
    v_cndmask_b32 v97, v89, 0, vcc
    v_mfma_f32_16x16x32_bf16 v[224:227], a[64:67], a[80:83], v[224:227]
    ds_read_b64_tr_b16 a[44:45], v27 offset:41984
    buffer_load_dwordx4 v11, s[8:11], s52 offen offset:1024 lds
    v_cmp_eq_u32 vcc, 2147483648, v91
    s_nop 1
    v_cndmask_b32 v101, v89, 0, vcc
    v_mfma_f32_16x16x32_bf16 v[228:231], a[68:71], a[80:83], v[228:231]
    ds_read_b64_tr_b16 a[46:47], v27 offset:42496
    buffer_load_dwordx4 v11, s[8:11], s52 offen offset:2048 lds
    v_min_f32 v105, s57, v101
    v_mfma_f32_16x16x32_bf16 v[244:247], a[72:75], a[80:83], v[244:247]
    ds_read_b128 a[36:39], v20 offset:23936
    v_subrev_u32 v90, 2, v88
    v_and_b32 v91, 0x80000001, v90
    v_mfma_f32_16x16x32_bf16 v[192:195], a[84:87], a[64:67], v[192:195]
    ds_read_b64_tr_b16 a[48:49], v27 offset:39936
    v_cmp_eq_u32 vcc, 0, v91
    s_nop 1
    v_cndmask_b32 v98, v89, 0, vcc
    v_mfma_f32_16x16x32_bf16 v[196:199], a[84:87], a[68:71], v[196:199]
    ds_read_b64_tr_b16 a[50:51], v27 offset:40448
    s_add_u32 m0, s71, 138240
    s_mul_i32 s52, s68, 6
    s_waitcnt lgkmcnt(9)
    v_mfma_f32_16x16x32_bf16 v[216:219], a[88:91], a[64:67], v[216:219]
    ds_read_b64_tr_b16 a[52:53], v30 offset:40960
    s_add_u32 s52, s52, 786432
    buffer_load_dwordx4 v11, s[8:11], s52 offen lds
    v_mfma_f32_16x16x32_bf16 v[220:223], a[88:91], a[68:71], v[220:223]
    ds_read_b64_tr_b16 a[54:55], v30 offset:41472
    v_cmp_eq_u32 vcc, 2147483648, v91
    s_nop 1
    v_cndmask_b32 v102, v89, 0, vcc
    v_mfma_f32_16x16x32_bf16 v[232:235], a[64:67], a[92:95], v[232:235]
    ds_read_b64_tr_b16 a[56:57], v30 offset:41984
    buffer_load_dwordx4 v11, s[8:11], s52 offen offset:1024 lds
    v_min_f32 v106, s57, v102
    v_mfma_f32_16x16x32_bf16 v[236:239], a[68:71], a[92:95], v[236:239]
    ds_read_b64_tr_b16 a[58:59], v30 offset:42496
    v_subrev_u32 v90, 3, v88
    v_and_b32 v91, 0x80000001, v90
    v_mfma_f32_16x16x32_bf16 v[200:203], a[96:99], a[64:67], v[200:203]
    ds_read_b64_tr_b16 a[60:61], v30 offset:39936
    v_cmp_eq_u32 vcc, 0, v91
    s_nop 1
    v_cndmask_b32 v99, v89, 0, vcc
    v_mfma_f32_16x16x32_bf16 v[204:207], a[96:99], a[68:71], v[204:207]
    ds_read_b64_tr_b16 a[62:63], v30 offset:40448
    buffer_load_dwordx4 v11, s[8:11], s52 offen offset:2048 lds
    s_waitcnt lgkmcnt(6)
    v_mfma_f32_16x16x32_bf16 v[208:211], a[40:43], a[28:31], v[208:211]
    s_waitcnt vmcnt(9)
    s_barrier
    ds_read_b128 a[64:67], v19 offset:24000
    ds_read_b64_tr_b16 a[76:77], v27 offset:53248
    v_mfma_f32_16x16x32_bf16 v[212:215], a[40:43], a[32:35], v[212:215]
    ds_read_b64_tr_b16 a[78:79], v27 offset:53760
    s_add_u32 m0, s71, 89088
    s_mul_i32 s52, s69, 6
    s_add_u32 s52, s52, 786432
    v_mfma_f32_16x16x32_bf16 v[240:243], a[40:43], a[36:39], v[240:243]
    ds_read_b128 a[68:71], v19 offset:28352
    buffer_load_dwordx4 v11, s[8:11], s52 offen lds
    v_cmp_eq_u32 vcc, 2147483648, v91
    s_nop 1
    v_cndmask_b32 v103, v89, 0, vcc
    v_mfma_f32_16x16x32_bf16 v[224:227], a[28:31], a[44:47], v[224:227]
    ds_read_b64_tr_b16 a[80:81], v27 offset:54272
    v_min_f32 v107, s57, v103
    v_mov_b32 v110, 0
    v_mfma_f32_16x16x32_bf16 v[228:231], a[32:35], a[44:47], v[228:231]
    ds_read_b64_tr_b16 a[82:83], v27 offset:54784
    buffer_load_dwordx4 v11, s[8:11], s52 offen offset:1024 lds
    v_mov_b32 v111, 0
    v_mfma_f32_16x16x32_bf16 v[244:247], a[36:39], a[44:47], v[244:247]
    ds_read_b128 a[72:75], v20 offset:24000
    v_mov_b32 v114, 0
    v_mov_b32 v115, 0
    v_mfma_f32_16x16x32_bf16 v[192:195], a[48:51], a[28:31], v[192:195]
    ds_read_b64_tr_b16 a[84:85], v27 offset:52224
    v_mov_b32 v116, 0
    v_mov_b32 v117, 0
    v_mfma_f32_16x16x32_bf16 v[196:199], a[48:51], a[32:35], v[196:199]
    ds_read_b64_tr_b16 a[86:87], v27 offset:52736
    buffer_load_dwordx4 v11, s[8:11], s52 offen offset:2048 lds
    s_waitcnt lgkmcnt(9)
    v_mfma_f32_16x16x32_bf16 v[216:219], a[52:55], a[28:31], v[216:219]
    ds_read_b64_tr_b16 a[88:89], v30 offset:53248
    v_mov_b32 v120, 0
    v_mov_b32 v121, 0
    v_mfma_f32_16x16x32_bf16 v[220:223], a[52:55], a[32:35], v[220:223]
    ds_read_b64_tr_b16 a[90:91], v30 offset:53760
    v_mfma_f32_16x16x32_bf16 v[232:235], a[28:31], a[56:59], v[232:235]
    ds_read_b64_tr_b16 a[92:93], v30 offset:54272
    s_add_u32 m0, s71, 150528
    s_mul_i32 s52, s66, 6
    s_add_u32 s52, s52, 1179648
    v_mfma_f32_16x16x32_bf16 v[236:239], a[32:35], a[56:59], v[236:239]
    ds_read_b64_tr_b16 a[94:95], v30 offset:54784
    buffer_load_dwordx4 v11, s[8:11], s52 offen lds
    v_mfma_f32_16x16x32_bf16 v[200:203], a[60:63], a[28:31], v[200:203]
    ds_read_b64_tr_b16 a[96:97], v30 offset:52224
    v_mfma_f32_16x16x32_bf16 v[204:207], a[60:63], a[32:35], v[204:207]
    ds_read_b64_tr_b16 a[98:99], v30 offset:52736
    buffer_load_dwordx4 v11, s[8:11], s52 offen offset:1024 lds
    s_waitcnt lgkmcnt(6)
    v_mfma_f32_16x16x32_bf16 v[208:211], a[76:79], a[64:67], v[208:211]
    s_waitcnt vmcnt(11)
    s_barrier
    ds_read_b128 a[28:31], v48 offset:2048
    ds_read_b64_tr_b16 a[40:41], v28 offset:4096
    v_mfma_f32_16x16x32_bf16 v[212:215], a[76:79], a[68:71], v[212:215]
    ds_read_b64_tr_b16 a[42:43], v28 offset:4608
    v_accvgpr_read_b32 v35, a11
    v_accvgpr_read_b32 v38, a20
    v_mfma_f32_16x16x32_bf16 v[240:243], a[76:79], a[72:75], v[240:243]
    ds_read_b128 a[32:35], v48 offset:6400
    buffer_load_dwordx4 v11, s[8:11], s52 offen offset:2048 lds
    buffer_load_dwordx4 v[72:75], v35, s[36:39], 0 offen sc1
    v_mfma_f32_16x16x32_bf16 v[224:227], a[64:67], a[80:83], v[224:227]
    ds_read_b64_tr_b16 a[44:45], v28 offset:5120
    buffer_load_dwordx4 v[76:79], v35, s[36:39], s3 offen sc1
    buffer_load_dwordx4 v[80:83], v35, s[36:39], s0 offen sc1
    v_mfma_f32_16x16x32_bf16 v[228:231], a[68:71], a[80:83], v[228:231]
    ds_read_b64_tr_b16 a[46:47], v28 offset:5632
    buffer_load_dwordx4 v[84:87], v35, s[36:39], s1 offen sc1
    buffer_load_dword v36, v38, s[36:39], 0 offen offset:1024 sc1
    v_mfma_f32_16x16x32_bf16 v[244:247], a[72:75], a[80:83], v[244:247]
    ds_read_b128 a[36:39], v49 offset:2048
    s_add_u32 m0, s71, 101376
    s_mul_i32 s52, s67, 6
    s_add_u32 s52, s52, 1179648
    v_mfma_f32_16x16x32_bf16 v[192:195], a[84:87], a[64:67], v[192:195]
    ds_read_b64_tr_b16 a[48:49], v28 offset:3072
    buffer_load_dwordx4 v11, s[8:11], s52 offen lds
    v_mfma_f32_16x16x32_bf16 v[196:199], a[84:87], a[68:71], v[196:199]
    ds_read_b64_tr_b16 a[50:51], v28 offset:3584
    s_waitcnt lgkmcnt(9)
    v_mfma_f32_16x16x32_bf16 v[216:219], a[88:91], a[64:67], v[216:219]
    ds_read_b64_tr_b16 a[52:53], v31 offset:4096
    buffer_load_dwordx4 v11, s[8:11], s52 offen offset:1024 lds
    v_mfma_f32_16x16x32_bf16 v[220:223], a[88:91], a[68:71], v[220:223]
    ds_read_b64_tr_b16 a[54:55], v31 offset:4608
    v_mfma_f32_16x16x32_bf16 v[232:235], a[64:67], a[92:95], v[232:235]
    ds_read_b64_tr_b16 a[56:57], v31 offset:5120
    v_mfma_f32_16x16x32_bf16 v[236:239], a[68:71], a[92:95], v[236:239]
    ds_read_b64_tr_b16 a[58:59], v31 offset:5632
    buffer_load_dwordx4 v11, s[8:11], s52 offen offset:2048 lds
    v_mfma_f32_16x16x32_bf16 v[200:203], a[96:99], a[64:67], v[200:203]
    ds_read_b64_tr_b16 a[60:61], v31 offset:3072
    v_mfma_f32_16x16x32_bf16 v[204:207], a[96:99], a[68:71], v[204:207]
    ds_read_b64_tr_b16 a[62:63], v31 offset:3584
    s_waitcnt lgkmcnt(6)
    v_mfma_f32_16x16x32_bf16 v[208:211], a[40:43], a[28:31], v[208:211]
    s_waitcnt vmcnt(17)
    s_barrier
    ds_read_b128 a[64:67], v48 offset:2112
    ds_read_b64_tr_b16 a[76:77], v26 offset:3072
    v_mfma_f32_16x16x32_bf16 v[212:215], a[40:43], a[32:35], v[212:215]
    ds_read_b64_tr_b16 a[78:79], v26 offset:3584
    s_add_u32 m0, s71, 113664
    s_mul_i32 s52, s68, 6
    s_add_u32 s52, s52, 1179648
    v_mfma_f32_16x16x32_bf16 v[240:243], a[40:43], a[36:39], v[240:243]
    ds_read_b128 a[68:71], v48 offset:6464
    buffer_load_dwordx4 v11, s[8:11], s52 offen lds
    v_mfma_f32_16x16x32_bf16 v[224:227], a[28:31], a[44:47], v[224:227]
    ds_read_b64_tr_b16 a[80:81], v26 offset:4096
    buffer_load_dwordx4 v11, s[8:11], s52 offen offset:1024 lds
    v_mfma_f32_16x16x32_bf16 v[228:231], a[32:35], a[44:47], v[228:231]
    ds_read_b64_tr_b16 a[82:83], v26 offset:4608
    v_mfma_f32_16x16x32_bf16 v[244:247], a[36:39], a[44:47], v[244:247]
    ds_read_b128 a[72:75], v49 offset:2112
    v_mfma_f32_16x16x32_bf16 v[192:195], a[48:51], a[28:31], v[192:195]
    ds_read_b64_tr_b16 a[84:85], v26 offset:2048
    buffer_load_dwordx4 v11, s[8:11], s52 offen offset:2048 lds
    v_mfma_f32_16x16x32_bf16 v[196:199], a[48:51], a[32:35], v[196:199]
    ds_read_b64_tr_b16 a[86:87], v26 offset:2560
    s_waitcnt lgkmcnt(9)
    v_mfma_f32_16x16x32_bf16 v[216:219], a[52:55], a[28:31], v[216:219]
    ds_read_b64_tr_b16 a[88:89], v29 offset:3072
    v_mfma_f32_16x16x32_bf16 v[220:223], a[52:55], a[32:35], v[220:223]
    ds_read_b64_tr_b16 a[90:91], v29 offset:3584
    v_mfma_f32_16x16x32_bf16 v[232:235], a[28:31], a[56:59], v[232:235]
    ds_read_b64_tr_b16 a[92:93], v29 offset:4096
    v_mfma_f32_16x16x32_bf16 v[236:239], a[32:35], a[56:59], v[236:239]
    ds_read_b64_tr_b16 a[94:95], v29 offset:4608
    v_mfma_f32_16x16x32_bf16 v[200:203], a[60:63], a[28:31], v[200:203]
    ds_read_b64_tr_b16 a[96:97], v29 offset:2048
    v_mfma_f32_16x16x32_bf16 v[204:207], a[60:63], a[32:35], v[204:207]
    ds_read_b64_tr_b16 a[98:99], v29 offset:2560
    s_waitcnt lgkmcnt(6)
    v_mfma_f32_16x16x32_bf16 v[208:211], a[76:79], a[64:67], v[208:211]
    s_waitcnt vmcnt(17)
    s_barrier
    ds_read_b128 a[28:31], v48 offset:2176
    ds_read_b64_tr_b16 a[40:41], v28 offset:16384
    v_mfma_f32_16x16x32_bf16 v[212:215], a[76:79], a[68:71], v[212:215]
    ds_read_b64_tr_b16 a[42:43], v28 offset:16896
    s_add_u32 m0, s71, 14336
    s_mul_i32 s52, s69, 6
    s_add_u32 s52, s52, 1179648
    v_mfma_f32_16x16x32_bf16 v[240:243], a[76:79], a[72:75], v[240:243]
    ds_read_b128 a[32:35], v48 offset:6528
    buffer_load_dwordx4 v11, s[8:11], s52 offen lds
    v_mfma_f32_16x16x32_bf16 v[224:227], a[64:67], a[80:83], v[224:227]
    ds_read_b64_tr_b16 a[44:45], v28 offset:17408
    buffer_load_dwordx4 v11, s[8:11], s52 offen offset:1024 lds
    v_mfma_f32_16x16x32_bf16 v[228:231], a[68:71], a[80:83], v[228:231]
    ds_read_b64_tr_b16 a[46:47], v28 offset:17920
    buffer_load_dwordx4 v11, s[8:11], s52 offen offset:2048 lds
    v_mfma_f32_16x16x32_bf16 v[244:247], a[72:75], a[80:83], v[244:247]
    ds_read_b128 a[36:39], v49 offset:2176
    v_mfma_f32_16x16x32_bf16 v[192:195], a[84:87], a[64:67], v[192:195]
    ds_read_b64_tr_b16 a[48:49], v28 offset:15360
    v_mfma_f32_16x16x32_bf16 v[196:199], a[84:87], a[68:71], v[196:199]
    ds_read_b64_tr_b16 a[50:51], v28 offset:15872
    s_add_u32 m0, s51, 125952
    s_xor_b32 s52, s72, 0
    s_waitcnt lgkmcnt(9)
    v_mfma_f32_16x16x32_bf16 v[216:219], a[88:91], a[64:67], v[216:219]
    ds_read_b64_tr_b16 a[52:53], v31 offset:16384
    buffer_load_dwordx4 v12, s[12:15], s52 offen lds
    v_mfma_f32_16x16x32_bf16 v[220:223], a[88:91], a[68:71], v[220:223]
    ds_read_b64_tr_b16 a[54:55], v31 offset:16896
    v_mfma_f32_16x16x32_bf16 v[232:235], a[64:67], a[92:95], v[232:235]
    ds_read_b64_tr_b16 a[56:57], v31 offset:17408
    s_add_u32 m0, s51, 130048
    s_xor_b32 s52, s72, 16384
    buffer_load_dwordx4 v12, s[12:15], s52 offen lds
    v_mfma_f32_16x16x32_bf16 v[236:239], a[68:71], a[92:95], v[236:239]
    ds_read_b64_tr_b16 a[58:59], v31 offset:17920
    v_mfma_f32_16x16x32_bf16 v[200:203], a[96:99], a[64:67], v[200:203]
    ds_read_b64_tr_b16 a[60:61], v31 offset:15360
    v_mfma_f32_16x16x32_bf16 v[204:207], a[96:99], a[68:71], v[204:207]
    ds_read_b64_tr_b16 a[62:63], v31 offset:15872
    s_waitcnt lgkmcnt(6)
    v_mfma_f32_16x16x32_bf16 v[208:211], a[40:43], a[28:31], v[208:211]
    s_waitcnt vmcnt(19)
    s_barrier
    ds_read_b128 a[64:67], v48 offset:2240
    ds_read_b64_tr_b16 a[76:77], v27 offset:28672
    v_mfma_f32_16x16x32_bf16 v[212:215], a[40:43], a[32:35], v[212:215]
    ds_read_b64_tr_b16 a[78:79], v27 offset:29184
    s_add_u32 m0, s51, 2048
    s_xor_b32 s52, s72, 32768
    buffer_load_dwordx4 v12, s[12:15], s52 offen lds
    v_mfma_f32_16x16x32_bf16 v[240:243], a[40:43], a[36:39], v[240:243]
    ds_read_b128 a[68:71], v48 offset:6592
    s_add_u32 m0, s51, 6144
    s_xor_b32 s52, s72, 49152
    buffer_load_dwordx4 v12, s[12:15], s52 offen lds
    v_mfma_f32_16x16x32_bf16 v[224:227], a[28:31], a[44:47], v[224:227]
    ds_read_b64_tr_b16 a[80:81], v27 offset:29696
    v_mfma_f32_16x16x32_bf16 v[228:231], a[32:35], a[44:47], v[228:231]
    ds_read_b64_tr_b16 a[82:83], v27 offset:30208
    v_mfma_f32_16x16x32_bf16 v[244:247], a[36:39], a[44:47], v[244:247]
    ds_read_b128 a[72:75], v49 offset:2240
    v_mfma_f32_16x16x32_bf16 v[192:195], a[48:51], a[28:31], v[192:195]
    ds_read_b64_tr_b16 a[84:85], v27 offset:27648
    v_mfma_f32_16x16x32_bf16 v[196:199], a[48:51], a[32:35], v[196:199]
    ds_read_b64_tr_b16 a[86:87], v27 offset:28160
    s_waitcnt lgkmcnt(9)
    v_mfma_f32_16x16x32_bf16 v[216:219], a[52:55], a[28:31], v[216:219]
    ds_read_b64_tr_b16 a[88:89], v30 offset:28672
    v_mfma_f32_16x16x32_bf16 v[220:223], a[52:55], a[32:35], v[220:223]
    ds_read_b64_tr_b16 a[90:91], v30 offset:29184
    v_mfma_f32_16x16x32_bf16 v[232:235], a[28:31], a[56:59], v[232:235]
    ds_read_b64_tr_b16 a[92:93], v30 offset:29696
    v_mfma_f32_16x16x32_bf16 v[236:239], a[32:35], a[56:59], v[236:239]
    ds_read_b64_tr_b16 a[94:95], v30 offset:30208
    v_mfma_f32_16x16x32_bf16 v[200:203], a[60:63], a[28:31], v[200:203]
    ds_read_b64_tr_b16 a[96:97], v30 offset:27648
    v_mfma_f32_16x16x32_bf16 v[204:207], a[60:63], a[32:35], v[204:207]
    ds_read_b64_tr_b16 a[98:99], v30 offset:28160
    s_waitcnt lgkmcnt(6)
    v_mfma_f32_16x16x32_bf16 v[208:211], a[76:79], a[64:67], v[208:211]
    s_waitcnt vmcnt(18)
    s_barrier
    ds_read_b128 a[28:31], v48 offset:23808
    ds_read_b64_tr_b16 a[40:41], v28 offset:28672
    v_mfma_f32_16x16x32_bf16 v[212:215], a[76:79], a[68:71], v[212:215]
    ds_read_b64_tr_b16 a[42:43], v28 offset:29184
    s_add_u32 m0, s51, 134144
    s_xor_b32 s52, s72, 65536
    buffer_load_dwordx4 v12, s[12:15], s52 offen lds
    v_mfma_f32_16x16x32_bf16 v[240:243], a[76:79], a[72:75], v[240:243]
    ds_read_b128 a[32:35], v48 offset:28160
    s_add_u32 m0, s51, 138240
    s_xor_b32 s52, s72, 81920
    buffer_load_dwordx4 v12, s[12:15], s52 offen lds
    v_mfma_f32_16x16x32_bf16 v[224:227], a[64:67], a[80:83], v[224:227]
    ds_read_b64_tr_b16 a[44:45], v28 offset:29696
    s_waitcnt vmcnt(19)
    v_xor_b32 v40, s73, v72
    v_mfma_f32_16x16x32_bf16 v[228:231], a[68:71], a[80:83], v[228:231]
    ds_read_b64_tr_b16 a[46:47], v28 offset:30208
    s_add_u32 m0, s51, 142336
    s_xor_b32 s52, s72, 98304
    buffer_load_dwordx4 v12, s[12:15], s52 offen lds
    v_mfma_f32_16x16x32_bf16 v[244:247], a[72:75], a[80:83], v[244:247]
    ds_read_b128 a[36:39], v49 offset:23808
    v_xor_b32 v41, s74, v73
    v_bitop3_b32 v40, v74, s75, v40 bitop3:0xbe
    v_mfma_f32_16x16x32_bf16 v[192:195], a[84:87], a[64:67], v[192:195]
    ds_read_b64_tr_b16 a[48:49], v28 offset:27648
    v_bitop3_b32 v41, v75, s76, v41 bitop3:0xbe
    s_waitcnt vmcnt(19)
    v_bitop3_b32 v40, v76, s73, v40 bitop3:0xbe
    v_mfma_f32_16x16x32_bf16 v[196:199], a[84:87], a[68:71], v[196:199]
    ds_read_b64_tr_b16 a[50:51], v28 offset:28160
    s_add_u32 m0, s51, 146432
    s_xor_b32 s52, s72, 114688
    s_waitcnt lgkmcnt(9)
    v_mfma_f32_16x16x32_bf16 v[216:219], a[88:91], a[64:67], v[216:219]
    ds_read_b64_tr_b16 a[52:53], v31 offset:28672
    buffer_load_dwordx4 v12, s[12:15], s52 offen lds
    v_bitop3_b32 v41, v77, s74, v41 bitop3:0xbe
    v_mfma_f32_16x16x32_bf16 v[220:223], a[88:91], a[68:71], v[220:223]
    ds_read_b64_tr_b16 a[54:55], v31 offset:29184
    v_bitop3_b32 v40, v78, s75, v40 bitop3:0xbe
    v_bitop3_b32 v41, v79, s76, v41 bitop3:0xbe
    v_mfma_f32_16x16x32_bf16 v[232:235], a[64:67], a[92:95], v[232:235]
    ds_read_b64_tr_b16 a[56:57], v31 offset:29696
    s_waitcnt vmcnt(19)
    v_bitop3_b32 v40, v80, s73, v40 bitop3:0xbe
    v_mfma_f32_16x16x32_bf16 v[236:239], a[68:71], a[92:95], v[236:239]
    ds_read_b64_tr_b16 a[58:59], v31 offset:30208
    v_bitop3_b32 v41, v81, s74, v41 bitop3:0xbe
    v_bitop3_b32 v40, v82, s75, v40 bitop3:0xbe
    v_mfma_f32_16x16x32_bf16 v[200:203], a[96:99], a[64:67], v[200:203]
    ds_read_b64_tr_b16 a[60:61], v31 offset:27648
    v_bitop3_b32 v41, v83, s76, v41 bitop3:0xbe
    s_waitcnt vmcnt(18)
    v_bitop3_b32 v40, v84, s73, v40 bitop3:0xbe
    v_mfma_f32_16x16x32_bf16 v[204:207], a[96:99], a[68:71], v[204:207]
    ds_read_b64_tr_b16 a[62:63], v31 offset:28160
    v_bitop3_b32 v41, v85, s74, v41 bitop3:0xbe
    s_waitcnt lgkmcnt(6)
    v_mfma_f32_16x16x32_bf16 v[208:211], a[40:43], a[28:31], v[208:211]
    s_waitcnt vmcnt(14)
    s_barrier
    ds_read_b128 a[64:67], v48 offset:23872
    ds_read_b64_tr_b16 a[76:77], v27 offset:40960
    v_mfma_f32_16x16x32_bf16 v[212:215], a[40:43], a[32:35], v[212:215]
    ds_read_b64_tr_b16 a[78:79], v27 offset:41472
    s_add_u32 m0, s51, 89088
    s_xor_b32 s52, s72, 131072
    buffer_load_dwordx4 v12, s[12:15], s52 offen lds
    v_mfma_f32_16x16x32_bf16 v[240:243], a[40:43], a[36:39], v[240:243]
    ds_read_b128 a[68:71], v48 offset:28224
    s_add_u32 m0, s51, 93184
    s_xor_b32 s52, s72, 147456
    buffer_load_dwordx4 v12, s[12:15], s52 offen lds
    v_mfma_f32_16x16x32_bf16 v[224:227], a[28:31], a[44:47], v[224:227]
    ds_read_b64_tr_b16 a[80:81], v27 offset:41984
    v_bitop3_b32 v40, v86, s75, v40 bitop3:0xbe
    v_bitop3_b32 v41, v87, s76, v41 bitop3:0xbe
    v_mfma_f32_16x16x32_bf16 v[228:231], a[32:35], a[44:47], v[228:231]
    ds_read_b64_tr_b16 a[82:83], v27 offset:42496
    v_or_b32 v40, v40, v41
    v_and_b32 v40, 0xff, v40
    v_mfma_f32_16x16x32_bf16 v[244:247], a[36:39], a[44:47], v[244:247]
    ds_read_b128 a[72:75], v49 offset:23872
    v_and_b32 v37, -8, v36
    v_xor_b32 v37, v37, v6
    v_mfma_f32_16x16x32_bf16 v[192:195], a[48:51], a[28:31], v[192:195]
    ds_read_b64_tr_b16 a[84:85], v27 offset:39936
    v_or_b32 v40, v40, v37
    v_cmp_ne_u32 vcc, 0, v40
    s_cbranch_vccnz Lretry_5
Lback_6:
    v_mfma_f32_16x16x32_bf16 v[196:199], a[48:51], a[32:35], v[196:199]
    ds_read_b64_tr_b16 a[86:87], v27 offset:40448
    v_and_b32 v72, 0xffffff00, v72
    s_waitcnt lgkmcnt(9)
    v_mfma_f32_16x16x32_bf16 v[216:219], a[52:55], a[28:31], v[216:219]
    ds_read_b64_tr_b16 a[88:89], v30 offset:40960
    v_and_b32 v73, 0xffffff00, v73
    v_and_b32 v74, 0xffffff00, v74
    v_mfma_f32_16x16x32_bf16 v[220:223], a[52:55], a[32:35], v[220:223]
    ds_read_b64_tr_b16 a[90:91], v30 offset:41472
    v_and_b32 v75, 0xffffff00, v75
    v_and_b32 v76, 0xffffff00, v76
    v_mfma_f32_16x16x32_bf16 v[232:235], a[28:31], a[56:59], v[232:235]
    ds_read_b64_tr_b16 a[92:93], v30 offset:41984
    v_and_b32 v77, 0xffffff00, v77
    v_and_b32 v78, 0xffffff00, v78
    v_mfma_f32_16x16x32_bf16 v[236:239], a[32:35], a[56:59], v[236:239]
    ds_read_b64_tr_b16 a[94:95], v30 offset:42496
    v_and_b32 v79, 0xffffff00, v79
    v_and_b32 v80, 0xffffff00, v80
    v_mfma_f32_16x16x32_bf16 v[200:203], a[60:63], a[28:31], v[200:203]
    ds_read_b64_tr_b16 a[96:97], v30 offset:39936
    v_and_b32 v81, 0xffffff00, v81
    v_and_b32 v82, 0xffffff00, v82
    v_mfma_f32_16x16x32_bf16 v[204:207], a[60:63], a[32:35], v[204:207]
    ds_read_b64_tr_b16 a[98:99], v30 offset:40448
    v_and_b32 v83, 0xffffff00, v83
    s_waitcnt lgkmcnt(6)
    v_mfma_f32_16x16x32_bf16 v[208:211], a[76:79], a[64:67], v[208:211]
    s_waitcnt vmcnt(13)
    s_barrier
    ds_read_b128 a[28:31], v48 offset:23936
    ds_read_b64_tr_b16 a[40:41], v27 offset:53248
    v_mfma_f32_16x16x32_bf16 v[212:215], a[76:79], a[68:71], v[212:215]
    ds_read_b64_tr_b16 a[42:43], v27 offset:53760
    s_add_u32 m0, s51, 45568
    s_xor_b32 s52, s72, 163840
    buffer_load_dwordx4 v12, s[12:15], s52 offen lds
    v_mfma_f32_16x16x32_bf16 v[240:243], a[76:79], a[72:75], v[240:243]
    ds_read_b128 a[32:35], v48 offset:28288
    v_and_b32 v84, 0xffffff00, v84
    v_and_b32 v85, 0xffffff00, v85
    v_mfma_f32_16x16x32_bf16 v[224:227], a[64:67], a[80:83], v[224:227]
    ds_read_b64_tr_b16 a[44:45], v27 offset:54272
    v_and_b32 v86, 0xffffff00, v86
    v_and_b32 v87, 0xffffff00, v87
    v_mfma_f32_16x16x32_bf16 v[228:231], a[68:71], a[80:83], v[228:231]
    ds_read_b64_tr_b16 a[46:47], v27 offset:54784
    v_add_f32 v72, v72, v76
    v_add_f32 v73, v73, v77
    v_mfma_f32_16x16x32_bf16 v[244:247], a[72:75], a[80:83], v[244:247]
    ds_read_b128 a[36:39], v49 offset:23936
    v_accvgpr_read_b32 v7, a21
    buffer_load_dword a252, v7, s[12:15], 0 offen
    v_mfma_f32_16x16x32_bf16 v[192:195], a[84:87], a[64:67], v[192:195]
    ds_read_b64_tr_b16 a[48:49], v27 offset:52224
    v_add_f32 v74, v74, v78
    v_add_f32 v75, v75, v79
    v_mfma_f32_16x16x32_bf16 v[196:199], a[84:87], a[68:71], v[196:199]
    ds_read_b64_tr_b16 a[50:51], v27 offset:52736
    v_add_f32 v80, v80, v84
    s_waitcnt lgkmcnt(9)
    v_mfma_f32_16x16x32_bf16 v[216:219], a[88:91], a[64:67], v[216:219]
    ds_read_b64_tr_b16 a[52:53], v30 offset:53248
    v_add_f32 v81, v81, v85
    v_add_f32 v82, v82, v86
    v_mfma_f32_16x16x32_bf16 v[220:223], a[88:91], a[68:71], v[220:223]
    ds_read_b64_tr_b16 a[54:55], v30 offset:53760
    v_add_f32 v83, v83, v87
    v_add_f32 v72, v72, v80
    v_mfma_f32_16x16x32_bf16 v[232:235], a[64:67], a[92:95], v[232:235]
    ds_read_b64_tr_b16 a[56:57], v30 offset:54272
    v_add_f32 v73, v73, v81
    v_add_f32 v74, v74, v82
    v_mfma_f32_16x16x32_bf16 v[236:239], a[68:71], a[92:95], v[236:239]
    ds_read_b64_tr_b16 a[58:59], v30 offset:54784
    v_accvgpr_read_b32 v7, a23
    buffer_load_dwordx4 a[12:15], v7, s[4:7], 0 offen
    v_mfma_f32_16x16x32_bf16 v[200:203], a[96:99], a[64:67], v[200:203]
    ds_read_b64_tr_b16 a[60:61], v30 offset:52224
    v_add_f32 v75, v75, v83
    v_cvt_pk_bf16_f32 v72, v72, v73
    v_mfma_f32_16x16x32_bf16 v[204:207], a[96:99], a[68:71], v[204:207]
    ds_read_b64_tr_b16 a[62:63], v30 offset:52736
    v_cvt_pk_bf16_f32 v74, v74, v75
    s_waitcnt lgkmcnt(6)
    v_mfma_f32_16x16x32_bf16 v[208:211], a[40:43], a[28:31], v[208:211]
    s_waitcnt vmcnt(13)
    s_barrier
    ds_read_b128 a[64:67], v48 offset:24000
    ds_read_b64_tr_b16 a[76:77], v26 offset:15360
    v_mfma_f32_16x16x32_bf16 v[212:215], a[40:43], a[32:35], v[212:215]
    ds_read_b64_tr_b16 a[78:79], v26 offset:15872
    buffer_load_dword a252, v16, s[36:39], s70 offen sc1
    v_lshlrev_b32 v40, 16, v72
    v_mfma_f32_16x16x32_bf16 v[240:243], a[40:43], a[36:39], v[240:243]
    ds_read_b128 a[68:71], v48 offset:28352
    v_and_b32 v41, 0xffff0000, v72
    v_lshlrev_b32 v42, 16, v74
    v_mfma_f32_16x16x32_bf16 v[224:227], a[28:31], a[44:47], v[224:227]
    ds_read_b64_tr_b16 a[80:81], v26 offset:16384
    s_mov_b32 s60, 8192
    buffer_load_dwordx4 a[16:19], v7, s[4:7], s60 offen
    v_mfma_f32_16x16x32_bf16 v[228:231], a[32:35], a[44:47], v[228:231]
    ds_read_b64_tr_b16 a[82:83], v26 offset:16896
    v_and_b32 v43, 0xffff0000, v74
    s_cmp_eq_u32 s44, 2
    s_cselect_b32 s57, 1.0, 0
    v_mfma_f32_16x16x32_bf16 v[244:247], a[36:39], a[44:47], v[244:247]
    ds_read_b128 a[72:75], v49 offset:24000
    v_add_f32 v44, s57, v40
    v_add_f32 v45, s57, v41
    v_mfma_f32_16x16x32_bf16 v[192:195], a[48:51], a[28:31], v[192:195]
    ds_read_b64_tr_b16 a[84:85], v26 offset:14336
    v_add_f32 v46, s57, v42
    v_add_f32 v47, s57, v43
    v_mfma_f32_16x16x32_bf16 v[196:199], a[48:51], a[32:35], v[196:199]
    ds_read_b64_tr_b16 a[86:87], v26 offset:14848
    v_cvt_pk_bf16_f32 v72, v44, v45
    s_waitcnt lgkmcnt(9)
    v_mfma_f32_16x16x32_bf16 v[216:219], a[52:55], a[28:31], v[216:219]
    ds_read_b64_tr_b16 a[88:89], v29 offset:15360
    v_cvt_pk_bf16_f32 v74, v46, v47
    v_lshlrev_b32 v40, 16, v72
    v_mfma_f32_16x16x32_bf16 v[220:223], a[52:55], a[32:35], v[220:223]
    ds_read_b64_tr_b16 a[90:91], v29 offset:15872
    buffer_load_dwordx4 a[252:255], v16, s[36:39], s64 offen offset:0 sc1
    v_and_b32 v41, 0xffff0000, v72
    v_mfma_f32_16x16x32_bf16 v[232:235], a[28:31], a[56:59], v[232:235]
    ds_read_b64_tr_b16 a[92:93], v29 offset:16384
    v_lshlrev_b32 v42, 16, v74
    v_and_b32 v43, 0xffff0000, v74
    v_mfma_f32_16x16x32_bf16 v[236:239], a[32:35], a[56:59], v[236:239]
    ds_read_b64_tr_b16 a[94:95], v29 offset:16896
    v_and_b32 v37, 15, v1
    s_lshl_b32 s57, s44, 8
    v_mfma_f32_16x16x32_bf16 v[200:203], a[60:63], a[28:31], v[200:203]
    ds_read_b64_tr_b16 a[96:97], v29 offset:14336
    v_lshl_add_u32 v37, v37, 4, s57
    ds_write_b128 v37, v[40:43] offset:0
    v_mfma_f32_16x16x32_bf16 v[204:207], a[60:63], a[32:35], v[204:207]
    ds_read_b64_tr_b16 a[98:99], v29 offset:14848
    s_getreg_b32 s57, hwreg(HW_REG_XCC_ID)
    s_waitcnt lgkmcnt(7)
    v_mfma_f32_16x16x32_bf16 v[208:211], a[76:79], a[64:67], v[208:211]
    s_and_b32 s57, s57, 7
    s_or_b32 s57, s57, s54
    v_cmp_ne_u32 vcc, s57, v36
    s_nop 1
    s_cmp_eq_u64 vcc, 0
    s_cselect_b32 s55, 1, 0
    v_mfma_f32_16x16x32_bf16 v[212:215], a[76:79], a[68:71], v[212:215]
    buffer_load_dwordx4 a[252:255], v16, s[36:39], s64 offen offset:1024 sc1
    v_mfma_f32_16x16x32_bf16 v[240:243], a[76:79], a[72:75], v[240:243]
    v_mfma_f32_16x16x32_bf16 v[224:227], a[64:67], a[80:83], v[224:227]
    v_mfma_f32_16x16x32_bf16 v[228:231], a[68:71], a[80:83], v[228:231]
    v_mfma_f32_16x16x32_bf16 v[244:247], a[72:75], a[80:83], v[244:247]
    v_mfma_f32_16x16x32_bf16 v[192:195], a[84:87], a[64:67], v[192:195]
    v_accvgpr_read_b32 v7, a25
    buffer_load_dword a252, v7, s[36:39], 0 offen sc1
    v_mfma_f32_16x16x32_bf16 v[196:199], a[84:87], a[68:71], v[196:199]
    s_waitcnt lgkmcnt(0)
    v_mfma_f32_16x16x32_bf16 v[216:219], a[88:91], a[64:67], v[216:219]
    v_mfma_f32_16x16x32_bf16 v[220:223], a[88:91], a[68:71], v[220:223]
    v_mfma_f32_16x16x32_bf16 v[232:235], a[64:67], a[92:95], v[232:235]
    v_mfma_f32_16x16x32_bf16 v[236:239], a[68:71], a[92:95], v[236:239]
    v_mfma_f32_16x16x32_bf16 v[200:203], a[96:99], a[64:67], v[200:203]
    v_mfma_f32_16x16x32_bf16 v[204:207], a[96:99], a[68:71], v[204:207]
    v_cvt_pk_bf16_f32 v132, v212, v213
    v_cvt_pk_bf16_f32 v133, v214, v215
    ds_write_b64 v33, v[132:133] offset:35328
    s_nop 0
    v_cvt_pk_bf16_f32 v134, v220, v221
    v_cvt_pk_bf16_f32 v135, v222, v223
    ds_write_b64 v34, v[134:135] offset:35328
    v_cvt_pk_bf16_f32 v152, v240, v241
    v_cvt_pk_bf16_f32 v153, v242, v243
    ds_write_b64 v32, v[152:153] offset:33280
    v_cvt_pk_bf16_f32 v154, v244, v245
    v_cvt_pk_bf16_f32 v155, v246, v247
    ds_write_b64 v32, v[154:155] offset:34304
    v_cvt_pk_bf16_f32 v142, v228, v229
    v_cvt_pk_bf16_f32 v143, v230, v231
    ds_write_b64 v33, v[142:143] offset:36352
    v_cvt_pk_bf16_f32 v150, v236, v237
    v_cvt_pk_bf16_f32 v151, v238, v239
    ds_write_b64 v34, v[150:151] offset:36352
    v_cvt_pk_bf16_f32 v128, v208, v209
    v_cvt_pk_bf16_f32 v129, v210, v211
    v_cvt_pk_bf16_f32 v108, v192, v193
    v_cvt_pk_bf16_f32 v109, v194, v195
    v_cvt_pk_bf16_f32 v112, v196, v197
    v_cvt_pk_bf16_f32 v113, v198, v199
    v_cvt_pk_bf16_f32 v130, v216, v217
    v_cvt_pk_bf16_f32 v131, v218, v219
    v_cvt_pk_bf16_f32 v118, v200, v201
    v_cvt_pk_bf16_f32 v119, v202, v203
    v_cvt_pk_bf16_f32 v122, v204, v205
    v_cvt_pk_bf16_f32 v123, v206, v207
    s_waitcnt lgkmcnt(0)
    s_barrier
    ds_read_b64 v[124:125], v33 offset:33280
    ds_read_b64 v[126:127], v34 offset:33280
    ds_read_b64 v[136:137], v33 offset:34304
    ds_read_b64 v[144:145], v34 offset:34304
    v_mfma_f32_16x16x32_bf16 v[216:219], v[128:131], v[112:115], v[100:103]
    v_mfma_f32_16x16x32_bf16 v[220:223], v[132:135], v[112:115], v[96:99]
    v_mfma_f32_16x16x32_bf16 v[248:251], v[128:131], v[120:123], v[100:103]
    v_mfma_f32_16x16x32_bf16 v[252:255], v[132:135], v[120:123], v[96:99]
    v_mfma_f32_16x16x32_bf16 v[212:215], v[128:131], v[108:111], v[96:99]
    v_mfma_f32_16x16x32_bf16 v[244:247], v[128:131], v[116:119], v[96:99]
    v_cvt_pk_bf16_f32 v138, v224, v225
    v_cvt_pk_bf16_f32 v139, v226, v227
    s_add_u32 m0, s51, 49664
    s_xor_b32 s52, s72, 180224
    buffer_load_dwordx4 v12, s[12:15], s52 offen lds
    v_cvt_pk_bf16_f32 v140, v224, v225
    v_cvt_pk_bf16_f32 v141, v226, v227
    v_cvt_pk_bf16_f32 v146, v232, v233
    v_cvt_pk_bf16_f32 v147, v234, v235
    v_cvt_pk_bf16_f32 v148, v232, v233
    v_cvt_pk_bf16_f32 v149, v234, v235
    s_waitcnt lgkmcnt(2)
    v_mfma_f32_16x16x32_bf16 v[208:211], v[124:127], v[108:111], v[104:107]
    v_mfma_f32_16x16x32_bf16 v[240:243], v[124:127], v[116:119], v[104:107]
    s_add_u32 m0, s51, 10240
    s_xor_b32 s52, s72, 196608
    buffer_load_dwordx4 v12, s[12:15], s52 offen lds
    v_mov_b32 v200, 0x3f803f80
    v_mov_b32 v201, 0x3f803f80
    v_mov_b32 v202, 0x3f803f80
    v_mov_b32 v203, 0x3f803f80
    s_mov_b32 s57, 0x3eb8aa3b
    v_max3_f32 v193, v216, v217, v218
    v_max3_f32 v197, v219, v220, v221
    v_max3_f32 v195, v248, v249, v250
    s_add_u32 m0, s51, 14336
    s_xor_b32 s52, s72, 212992
    buffer_load_dwordx4 v12, s[12:15], s52 offen lds
    v_max3_f32 v199, v251, v252, v253
    v_max3_f32 v192, v208, v209, v210
    v_max3_f32 v196, v211, v212, v213
    v_max3_f32 v194, v240, v241, v242
    v_max3_f32 v198, v243, v244, v245
    v_max3_f32 v193, v193, v222, v223
    v_max3_f32 v195, v195, v254, v255
    v_max3_f32 v192, v192, v214, v215
    s_add_u32 m0, s51, 18432
    s_xor_b32 s52, s72, 229376
    buffer_load_dwordx4 v12, s[12:15], s52 offen lds
    v_max3_f32 v194, v194, v246, v247
    v_max_f32 v193, v193, v197
    v_max_f32 v195, v195, v199
    v_max_f32 v192, v192, v196
    v_max_f32 v194, v194, v198
    v_mov_b32 v197, v193
    v_mov_b32 v199, v195
    v_mov_b32 v196, v192
    s_add_u32 m0, s51, 22528
    s_xor_b32 s52, s72, 245760
    buffer_load_dwordx4 v12, s[12:15], s52 offen lds
    v_mov_b32 v198, v194
    v_permlane32_swap_b32 v193, v197
    v_permlane32_swap_b32 v195, v199
    v_permlane32_swap_b32 v192, v196
    v_permlane32_swap_b32 v194, v198
    v_max_f32 v193, v193, v197
    v_max_f32 v195, v195, v199
    v_max_f32 v192, v192, v196
    s_add_u32 m0, s51, 53760
    s_nop 0
    buffer_load_dwordx4 v14, s[16:19], 0 offen lds
    v_max_f32 v194, v194, v198
    v_mov_b32 v197, v193
    v_mov_b32 v199, v195
    v_mov_b32 v196, v192
    v_mov_b32 v198, v194
    v_permlane16_swap_b32 v193, v197
    v_permlane16_swap_b32 v195, v199
    v_permlane16_swap_b32 v192, v196
    s_add_u32 m0, s51, 57888
    s_nop 0
    buffer_load_dwordx4 v14, s[20:23], 0 offen lds
    v_permlane16_swap_b32 v194, v198
    v_max_f32 v193, v193, v197
    v_max_f32 v195, v195, v199
    v_max_f32 v192, v192, v196
    v_max_f32 v194, v194, v198
    v_mul_f32 v193, s57, v193
    v_mul_f32 v195, s57, v195
    v_mul_f32 v192, s57, v192
    s_add_u32 m0, s51, 62016
    s_mov_b32 s52, 114688
    buffer_load_dwordx4 v14, s[16:19], s52 offen lds
    v_mul_f32 v194, s57, v194
    v_fma_f32 v216, v216, s57, -v193
    v_fma_f32 v217, v217, s57, -v193
    v_fma_f32 v218, v218, s57, -v193
    v_fma_f32 v219, v219, s57, -v193
    v_fma_f32 v220, v220, s57, -v193
    v_fma_f32 v221, v221, s57, -v193
    v_fma_f32 v222, v222, s57, -v193
    s_add_u32 m0, s51, 66144
    s_nop 0
    buffer_load_dwordx4 v14, s[20:23], s52 offen lds
    v_fma_f32 v223, v223, s57, -v193
    v_exp_f32 v216, v216
    v_exp_f32 v217, v217
    v_exp_f32 v218, v218
    v_exp_f32 v219, v219
    v_exp_f32 v220, v220
    v_exp_f32 v221, v221
    v_exp_f32 v222, v222
    s_add_u32 m0, s51, 70272
    s_mov_b32 s52, 229376
    buffer_load_dwordx4 v14, s[16:19], s52 offen lds
    v_exp_f32 v223, v223
    v_cvt_pk_bf16_f32 v216, v216, v217
    v_cvt_pk_bf16_f32 v217, v218, v219
    v_cvt_pk_bf16_f32 v218, v220, v221
    v_cvt_pk_bf16_f32 v219, v222, v223
    s_nop 1
    v_mfma_f32_16x16x32_bf16 v[168:171], v[200:203], v[216:219], 0
    v_mfma_f32_16x16x32_bf16 v[164:167], v[140:143], v[216:219], 0
    v_fma_f32 v248, v248, s57, -v195
    s_add_u32 m0, s51, 74400
    s_nop 0
    buffer_load_dwordx4 v14, s[20:23], s52 offen lds
    v_fma_f32 v249, v249, s57, -v195
    v_fma_f32 v250, v250, s57, -v195
    v_fma_f32 v251, v251, s57, -v195
    v_fma_f32 v252, v252, s57, -v195
    v_fma_f32 v253, v253, s57, -v195
    v_fma_f32 v254, v254, s57, -v195
    v_fma_f32 v255, v255, s57, -v195
    v_exp_f32 v248, v248
    s_add_u32 m0, s51, 78528
    s_mov_b32 s52, 344064
    buffer_load_dwordx4 v14, s[16:19], s52 offen lds
    v_exp_f32 v249, v249
    v_exp_f32 v250, v250
    v_exp_f32 v251, v251
    v_exp_f32 v252, v252
    v_exp_f32 v253, v253
    v_exp_f32 v254, v254
    v_exp_f32 v255, v255
    v_cvt_pk_bf16_f32 v248, v248, v249
    v_cvt_pk_bf16_f32 v249, v250, v251
    v_cvt_pk_bf16_f32 v250, v252, v253
    v_cvt_pk_bf16_f32 v251, v254, v255
    s_nop 1
    v_mfma_f32_16x16x32_bf16 v[184:187], v[200:203], v[248:251], 0
    v_mfma_f32_16x16x32_bf16 v[180:183], v[148:151], v[248:251], 0
    v_fma_f32 v208, v208, s57, -v192
    v_fma_f32 v209, v209, s57, -v192
    v_fma_f32 v210, v210, s57, -v192
    v_fma_f32 v211, v211, s57, -v192
    v_fma_f32 v212, v212, s57, -v192
    v_fma_f32 v213, v213, s57, -v192
    v_fma_f32 v214, v214, s57, -v192
    v_fma_f32 v215, v215, s57, -v192
    v_exp_f32 v208, v208
    v_exp_f32 v209, v209
    v_exp_f32 v210, v210
    v_exp_f32 v211, v211
    v_exp_f32 v212, v212
    v_exp_f32 v213, v213
    v_exp_f32 v214, v214
    v_exp_f32 v215, v215
    v_cvt_pk_bf16_f32 v208, v208, v209
    v_cvt_pk_bf16_f32 v209, v210, v211
    v_cvt_pk_bf16_f32 v210, v212, v213
    v_cvt_pk_bf16_f32 v211, v214, v215
    s_nop 1
    v_mfma_f32_16x16x32_bf16 v[160:163], v[200:203], v[208:211], 0
    s_waitcnt lgkmcnt(1)
    v_mfma_f32_16x16x32_bf16 v[156:159], v[136:139], v[208:211], 0
    v_fma_f32 v240, v240, s57, -v194
    v_fma_f32 v241, v241, s57, -v194
    v_fma_f32 v242, v242, s57, -v194
    v_fma_f32 v243, v243, s57, -v194
    v_fma_f32 v244, v244, s57, -v194
    v_fma_f32 v245, v245, s57, -v194
    v_fma_f32 v246, v246, s57, -v194
    v_fma_f32 v247, v247, s57, -v194
    v_exp_f32 v240, v240
    v_exp_f32 v241, v241
    v_exp_f32 v242, v242
    v_exp_f32 v243, v243
    v_exp_f32 v244, v244
    v_exp_f32 v245, v245
    v_exp_f32 v246, v246
    v_exp_f32 v247, v247
    v_cvt_pk_bf16_f32 v240, v240, v241
    v_cvt_pk_bf16_f32 v241, v242, v243
    v_cvt_pk_bf16_f32 v242, v244, v245
    v_cvt_pk_bf16_f32 v243, v246, v247
    s_nop 1
    v_mfma_f32_16x16x32_bf16 v[176:179], v[200:203], v[240:243], 0
    s_waitcnt lgkmcnt(0)
    v_mfma_f32_16x16x32_bf16 v[172:175], v[144:147], v[240:243], 0
    v_rcp_f32 v168, v168
    v_rcp_f32 v184, v184
    v_rcp_f32 v160, v160
    s_nop 2
    v_rcp_f32 v176, v176
    v_pk_mul_f32 v[164:165], v[164:165], v[168:169] op_sel_hi:[1,0]
    v_pk_mul_f32 v[166:167], v[166:167], v[168:169] op_sel_hi:[1,0]
    v_pk_mul_f32 v[180:181], v[180:181], v[184:185] op_sel_hi:[1,0]
    v_pk_mul_f32 v[182:183], v[182:183], v[184:185] op_sel_hi:[1,0]
    v_pk_mul_f32 v[156:157], v[156:157], v[160:161] op_sel_hi:[1,0]
    v_pk_mul_f32 v[158:159], v[158:159], v[160:161] op_sel_hi:[1,0]
    v_pk_mul_f32 v[172:173], v[172:173], v[176:177] op_sel_hi:[1,0]
    v_pk_mul_f32 v[174:175], v[174:175], v[176:177] op_sel_hi:[1,0]
    v_cvt_pk_bf16_f32 v228, v164, v165
    v_cvt_pk_bf16_f32 v229, v166, v167
    v_cvt_pk_bf16_f32 v230, v180, v181
    v_cvt_pk_bf16_f32 v231, v182, v183
    v_cvt_pk_bf16_f32 v224, v156, v157
    v_cvt_pk_bf16_f32 v225, v158, v159
    v_cvt_pk_bf16_f32 v226, v172, v173
    v_cvt_pk_bf16_f32 v227, v174, v175
    s_cmp_eq_u32 s45, 0
    s_cbranch_scc1 Lnoswap_7
    v_swap_b32 v224, v226
    v_swap_b32 v225, v227
    v_swap_b32 v228, v230
    v_swap_b32 v229, v231
Lnoswap_7:
    s_cmp_eq_u32 s55, 0
    s_cbranch_scc1 Lslow_8
    buffer_store_dwordx4 v[224:227], v16, s[36:39], s64 offen
    buffer_store_dwordx4 v[228:231], v16, s[36:39], s64 offen offset:1024
    s_branch Ljoin_9
Lslow_8:
    buffer_store_dwordx4 v[224:227], v16, s[36:39], s64 offen sc1
    buffer_store_dwordx4 v[228:231], v16, s[36:39], s64 offen offset:1024 sc1
Ljoin_9:
    v_and_b32 v7, 48, v1
    ds_read_b128 v[24:27], v7 offset:0
    ds_read_b128 v[28:31], v7 offset:64
    ds_read_b128 v[32:35], v7 offset:128
    ds_read_b128 v[36:39], v7 offset:192
    ds_read_b128 v[56:59], v7 offset:256
    ds_read_b128 v[60:63], v7 offset:320
    ds_read_b128 v[64:67], v7 offset:384
    ds_read_b128 v[68:71], v7 offset:448
    ds_read_b128 v[40:43], v7 offset:512
    ds_read_b128 v[44:47], v7 offset:576
    ds_read_b128 v[48:51], v7 offset:640
    ds_read_b128 v[52:55], v7 offset:704
    ds_read_b128 v[72:75], v7 offset:768
    ds_read_b128 v[76:79], v7 offset:832
    ds_read_b128 v[80:83], v7 offset:896
    ds_read_b128 v[84:87], v7 offset:960
    v_and_b32 v8, 15, v1
    v_lshl_add_u32 v18, v8, 2, s63
    s_lshr_b32 s67, s72, 4
    v_bfe_u32 v8, v1, 4, 1
    v_lshl_add_u32 v7, v8, 9, v17
    v_lshl_add_u32 v104, v3, 10, v7
    v_xor_b32 v107, 32, v104
    v_add_u32 v105, 61440, v104
    v_add_u32 v106, 122880, v104
    v_add_u32 v108, 61440, v107
    v_add_u32 v109, 122880, v107
    s_lshl_b32 s57, s50, 5
    s_add_u32 s57, s57, s46
    s_lshl_b32 s57, s57, 10
    s_add_u32 s57, s57, 1048576
    s_lshl_b32 s58, s49, 12
    s_add_u32 s64, s57, s58
    v_add_u32 v19, s57, v16
    v_add_u32 v20, s51, v16
    v_lshlrev_b32 v20, 2, v20
    v_mul_u32_u24 v7, 48, v1
    v_sub_u32 v20, v20, v7
    v_and_b32 v8, 15, v1
    v_mul_u32_u24 v8, 144, v8
    s_mul_i32 s57, s45, 4608
    s_mul_i32 s58, s46, 2304
    s_add_u32 s57, s57, s58
    v_lshrrev_b32 v9, 4, v1
    v_lshlrev_b32 v9, 3, v9
    v_add3_u32 v9, v8, v9, s57
    v_add_u32 v110, s51, v16
    v_add_u32 v111, 61440, v110
    v_add_u32 v112, 122880, v110
    v_accvgpr_read_b32 v10, a24
    s_waitcnt vmcnt(0)
    s_mov_b64 exec, 1
    s_cmp_eq_u32 s55, 0
    s_cbranch_scc1 Lslow_10
    buffer_store_dword v6, v15, s[36:39], 0 offen offset:0
    s_branch Ljoin_11
Lslow_10:
    buffer_store_dword v6, v15, s[36:39], 0 offen offset:0 sc1
Ljoin_11:
    s_mov_b64 exec, -1
    s_waitcnt lgkmcnt(0)
    s_barrier
    ds_write_b128 v10, a[12:15] offset:33280
    ds_write_b128 v10, a[16:19] offset:34432
    s_waitcnt lgkmcnt(0)
    s_barrier
    buffer_load_dword v22, v18, s[36:39], 0 offen offset:0 sc1
    ds_read_b64 v[116:117], v9 offset:33280
    ds_read_b64 v[118:119], v9 offset:33312
    ds_read_b64 v[120:121], v9 offset:33344
    ds_read_b64 v[122:123], v9 offset:33376
    s_add_u32 m0, s51, 82656
    s_nop 0
    buffer_load_dwordx4 v14, s[20:23], s52 offen lds
    s_add_u32 m0, s51, 97280
    s_nop 0
    buffer_load_dwordx4 v21, s[16:19], 0 offen lds
    s_add_u32 m0, s51, 101408
    s_nop 0
    buffer_load_dwordx4 v21, s[20:23], 0 offen lds
    s_waitcnt lgkmcnt(3)
    v_lshlrev_b32 v88, 16, v116
    v_and_b32 v89, 0xffff0000, v116
    v_lshlrev_b32 v90, 16, v117
    v_and_b32 v91, 0xffff0000, v117
    s_waitcnt lgkmcnt(2)
    v_lshlrev_b32 v92, 16, v118
    v_and_b32 v93, 0xffff0000, v118
    v_lshlrev_b32 v94, 16, v119
    v_and_b32 v95, 0xffff0000, v119
    s_waitcnt lgkmcnt(1)
    v_lshlrev_b32 v96, 16, v120
    v_and_b32 v97, 0xffff0000, v120
    v_lshlrev_b32 v98, 16, v121
    v_and_b32 v99, 0xffff0000, v121
    s_waitcnt lgkmcnt(0)
    v_lshlrev_b32 v100, 16, v122
    v_and_b32 v101, 0xffff0000, v122
    v_lshlrev_b32 v102, 16, v123
    v_and_b32 v103, 0xffff0000, v123
    ds_read_b64_tr_b16 a[4:5], v106 offset:3072
    ds_read_b64_tr_b16 a[6:7], v106 offset:7168
    ds_read_b64_tr_b16 a[8:9], v109 offset:3072
    ds_read_b64_tr_b16 a[10:11], v109 offset:7168
    ds_read_b64_tr_b16 a[12:13], v106 offset:3328
    ds_read_b64_tr_b16 a[14:15], v106 offset:7424
    ds_read_b64_tr_b16 a[16:17], v109 offset:3328
    ds_read_b64_tr_b16 a[18:19], v109 offset:7424
    ds_read_b64_tr_b16 a[28:29], v104 offset:2048
    ds_read_b64_tr_b16 a[30:31], v104 offset:6144
    ds_read_b64_tr_b16 a[32:33], v107 offset:2048
    ds_read_b64_tr_b16 a[34:35], v107 offset:6144
    ds_read_b64_tr_b16 a[36:37], v104 offset:2304
    ds_read_b64_tr_b16 a[38:39], v104 offset:6400
    ds_read_b64_tr_b16 a[40:41], v107 offset:2304
    ds_read_b64_tr_b16 a[42:43], v107 offset:6400
    s_waitcnt vmcnt(3)
    v_cmp_ne_u32 vcc, s54, v22
    s_cbranch_vccnz Lretry_12
Lback_13:
    s_xor_b32 s62, s67, 0
    buffer_load_dwordx4 a[60:63], v19, s[36:39], s62 offen offset:0 sc1
    s_xor_b32 s62, s67, 2048
    buffer_load_dwordx4 a[64:67], v19, s[36:39], s62 offen offset:0 sc1
    s_xor_b32 s62, s67, 4096
    buffer_load_dwordx4 a[68:71], v19, s[36:39], s62 offen offset:0 sc1
    s_xor_b32 s62, s67, 6144
    buffer_load_dwordx4 a[72:75], v19, s[36:39], s62 offen offset:0 sc1
    s_xor_b32 s62, s67, 8192
    buffer_load_dwordx4 a[76:79], v19, s[36:39], s62 offen offset:0 sc1
    s_xor_b32 s62, s67, 10240
    buffer_load_dwordx4 a[80:83], v19, s[36:39], s62 offen offset:0 sc1
    s_waitcnt vmcnt(5) lgkmcnt(8)
    v_mfma_f32_16x16x32_bf16 v[116:119], a[4:7], a[60:63], 0
    ds_read_b64_tr_b16 a[44:45], v106 offset:11264
    ds_read_b64_tr_b16 a[46:47], v106 offset:15360
    v_mfma_f32_16x16x32_bf16 v[120:123], a[8:11], a[60:63], 0
    ds_read_b64_tr_b16 a[48:49], v109 offset:11264
    ds_read_b64_tr_b16 a[50:51], v109 offset:15360
    s_xor_b32 s62, s67, 12288
    buffer_load_dwordx4 a[84:87], v19, s[36:39], s62 offen offset:0 sc1
    v_mfma_f32_16x16x32_bf16 v[124:127], a[12:15], a[60:63], 0
    ds_read_b64_tr_b16 a[52:53], v106 offset:11520
    ds_read_b64_tr_b16 a[54:55], v106 offset:15616
    v_mfma_f32_16x16x32_bf16 v[128:131], a[16:19], a[60:63], 0
    ds_read_b64_tr_b16 a[56:57], v109 offset:11520
    ds_read_b64_tr_b16 a[58:59], v109 offset:15616
    s_waitcnt vmcnt(5) lgkmcnt(8)
    v_mfma_f32_16x16x32_bf16 v[116:119], a[28:31], a[64:67], v[116:119]
    ds_read_b64_tr_b16 a[4:5], v106 offset:19456
    ds_read_b64_tr_b16 a[6:7], v106 offset:23552
    s_xor_b32 s62, s67, 14336
    buffer_load_dwordx4 a[88:91], v19, s[36:39], s62 offen offset:0 sc1
    v_mfma_f32_16x16x32_bf16 v[120:123], a[32:35], a[64:67], v[120:123]
    ds_read_b64_tr_b16 a[8:9], v109 offset:19456
    ds_read_b64_tr_b16 a[10:11], v109 offset:23552
    s_xor_b32 s62, s67, 16384
    buffer_load_dwordx4 a[92:95], v19, s[36:39], s62 offen offset:0 sc1
    v_mfma_f32_16x16x32_bf16 v[124:127], a[36:39], a[64:67], v[124:127]
    ds_read_b64_tr_b16 a[12:13], v106 offset:19712
    ds_read_b64_tr_b16 a[14:15], v106 offset:23808
    v_mfma_f32_16x16x32_bf16 v[128:131], a[40:43], a[64:67], v[128:131]
    ds_read_b64_tr_b16 a[16:17], v109 offset:19712
    ds_read_b64_tr_b16 a[18:19], v109 offset:23808
    s_waitcnt vmcnt(6) lgkmcnt(8)
    v_mfma_f32_16x16x32_bf16 v[116:119], a[44:47], a[68:71], v[116:119]
    ds_read_b64_tr_b16 a[28:29], v105 offset:27648
    ds_read_b64_tr_b16 a[30:31], v105 offset:31744
    s_xor_b32 s62, s67, 18432
    buffer_load_dwordx4 a[96:99], v19, s[36:39], s62 offen offset:0 sc1
    v_mfma_f32_16x16x32_bf16 v[120:123], a[48:51], a[68:71], v[120:123]
    ds_read_b64_tr_b16 a[32:33], v108 offset:27648
    ds_read_b64_tr_b16 a[34:35], v108 offset:31744
    s_xor_b32 s62, s67, 20480
    buffer_load_dwordx4 a[100:103], v19, s[36:39], s62 offen offset:0 sc1
    v_mfma_f32_16x16x32_bf16 v[124:127], a[52:55], a[68:71], v[124:127]
    ds_read_b64_tr_b16 a[36:37], v105 offset:27904
    ds_read_b64_tr_b16 a[38:39], v105 offset:32000
    v_mfma_f32_16x16x32_bf16 v[128:131], a[56:59], a[68:71], v[128:131]
    ds_read_b64_tr_b16 a[40:41], v108 offset:27904
    ds_read_b64_tr_b16 a[42:43], v108 offset:32000
    s_waitcnt vmcnt(7) lgkmcnt(8)
    v_mfma_f32_16x16x32_bf16 v[116:119], a[4:7], a[72:75], v[116:119]
    ds_read_b64_tr_b16 a[44:45], v104 offset:45568
    ds_read_b64_tr_b16 a[46:47], v104 offset:49664
    s_xor_b32 s62, s67, 22528
    buffer_load_dwordx4 a[104:107], v19, s[36:39], s62 offen offset:0 sc1
    v_mfma_f32_16x16x32_bf16 v[120:123], a[8:11], a[72:75], v[120:123]
    ds_read_b64_tr_b16 a[48:49], v107 offset:45568
    ds_read_b64_tr_b16 a[50:51], v107 offset:49664
    s_xor_b32 s62, s67, 24576
    buffer_load_dwordx4 a[108:111], v19, s[36:39], s62 offen offset:0 sc1
    v_mfma_f32_16x16x32_bf16 v[124:127], a[12:15], a[72:75], v[124:127]
    ds_read_b64_tr_b16 a[52:53], v104 offset:45824
    ds_read_b64_tr_b16 a[54:55], v104 offset:49920
    v_mfma_f32_16x16x32_bf16 v[128:131], a[16:19], a[72:75], v[128:131]
    ds_read_b64_tr_b16 a[56:57], v107 offset:45824
    ds_read_b64_tr_b16 a[58:59], v107 offset:49920
    s_waitcnt vmcnt(8) lgkmcnt(8)
    v_mfma_f32_16x16x32_bf16 v[116:119], a[28:31], a[76:79], v[116:119]
    ds_read_b64_tr_b16 a[4:5], v104 offset:10240
    ds_read_b64_tr_b16 a[6:7], v104 offset:14336
    s_xor_b32 s62, s67, 26624
    buffer_load_dwordx4 a[112:115], v19, s[36:39], s62 offen offset:0 sc1
    v_mfma_f32_16x16x32_bf16 v[120:123], a[32:35], a[76:79], v[120:123]
    ds_read_b64_tr_b16 a[8:9], v107 offset:10240
    ds_read_b64_tr_b16 a[10:11], v107 offset:14336
    s_xor_b32 s62, s67, 28672
    buffer_load_dwordx4 a[116:119], v19, s[36:39], s62 offen offset:0 sc1
    v_mfma_f32_16x16x32_bf16 v[124:127], a[36:39], a[76:79], v[124:127]
    ds_read_b64_tr_b16 a[12:13], v104 offset:10496
    ds_read_b64_tr_b16 a[14:15], v104 offset:14592
    v_mfma_f32_16x16x32_bf16 v[128:131], a[40:43], a[76:79], v[128:131]
    ds_read_b64_tr_b16 a[16:17], v107 offset:10496
    ds_read_b64_tr_b16 a[18:19], v107 offset:14592
    s_waitcnt vmcnt(9) lgkmcnt(8)
    v_mfma_f32_16x16x32_bf16 v[116:119], a[44:47], a[80:83], v[116:119]
    ds_read_b64_tr_b16 a[28:29], v104 offset:18432
    ds_read_b64_tr_b16 a[30:31], v104 offset:22528
    s_xor_b32 s62, s67, 30720
    buffer_load_dwordx4 a[120:123], v19, s[36:39], s62 offen offset:0 sc1
    v_mfma_f32_16x16x32_bf16 v[120:123], a[48:51], a[80:83], v[120:123]
    ds_read_b64_tr_b16 a[32:33], v107 offset:18432
    ds_read_b64_tr_b16 a[34:35], v107 offset:22528
    s_mov_b32 s56, 917504
    buffer_load_dwordx4 a[124:127], v14, s[16:19], s56 offen
    v_mfma_f32_16x16x32_bf16 v[124:127], a[52:55], a[80:83], v[124:127]
    ds_read_b64_tr_b16 a[36:37], v104 offset:18688
    ds_read_b64_tr_b16 a[38:39], v104 offset:22784
    v_mfma_f32_16x16x32_bf16 v[128:131], a[56:59], a[80:83], v[128:131]
    ds_read_b64_tr_b16 a[40:41], v107 offset:18688
    ds_read_b64_tr_b16 a[42:43], v107 offset:22784
    s_waitcnt vmcnt(10) lgkmcnt(8)
    v_mfma_f32_16x16x32_bf16 v[116:119], a[4:7], a[84:87], v[116:119]
    ds_read_b64_tr_b16 a[44:45], v106 offset:5120
    ds_read_b64_tr_b16 a[46:47], v106 offset:9216
    buffer_load_dwordx4 a[128:131], v14, s[20:23], s56 offen
    v_mfma_f32_16x16x32_bf16 v[120:123], a[8:11], a[84:87], v[120:123]
    ds_read_b64_tr_b16 a[48:49], v109 offset:5120
    ds_read_b64_tr_b16 a[50:51], v109 offset:9216
    s_mov_b32 s56, 1032192
    buffer_load_dwordx4 a[132:135], v14, s[16:19], s56 offen
    v_mfma_f32_16x16x32_bf16 v[124:127], a[12:15], a[84:87], v[124:127]
    ds_read_b64_tr_b16 a[52:53], v106 offset:5376
    ds_read_b64_tr_b16 a[54:55], v106 offset:9472
    v_mfma_f32_16x16x32_bf16 v[128:131], a[16:19], a[84:87], v[128:131]
    ds_read_b64_tr_b16 a[56:57], v109 offset:5376
    ds_read_b64_tr_b16 a[58:59], v109 offset:9472
    s_waitcnt vmcnt(11) lgkmcnt(8)
    v_mfma_f32_16x16x32_bf16 v[116:119], a[28:31], a[88:91], v[116:119]
    ds_read_b64_tr_b16 a[4:5], v104 offset:4096
    ds_read_b64_tr_b16 a[6:7], v104 offset:8192
    buffer_load_dwordx4 a[136:139], v14, s[20:23], s56 offen
    v_mfma_f32_16x16x32_bf16 v[120:123], a[32:35], a[88:91], v[120:123]
    ds_read_b64_tr_b16 a[8:9], v107 offset:4096
    ds_read_b64_tr_b16 a[10:11], v107 offset:8192
    s_mov_b32 s56, 1146880
    buffer_load_dwordx4 a[140:143], v14, s[16:19], s56 offen
    v_mfma_f32_16x16x32_bf16 v[124:127], a[36:39], a[88:91], v[124:127]
    ds_read_b64_tr_b16 a[12:13], v104 offset:4352
    ds_read_b64_tr_b16 a[14:15], v104 offset:8448
    v_mfma_f32_16x16x32_bf16 v[128:131], a[40:43], a[88:91], v[128:131]
    ds_read_b64_tr_b16 a[16:17], v107 offset:4352
    ds_read_b64_tr_b16 a[18:19], v107 offset:8448
    s_waitcnt vmcnt(12) lgkmcnt(8)
    v_mfma_f32_16x16x32_bf16 v[116:119], a[44:47], a[92:95], v[116:119]
    ds_read_b64_tr_b16 a[28:29], v106 offset:13312
    ds_read_b64_tr_b16 a[30:31], v106 offset:17408
    buffer_load_dwordx4 a[144:147], v14, s[20:23], s56 offen
    v_mfma_f32_16x16x32_bf16 v[120:123], a[48:51], a[92:95], v[120:123]
    ds_read_b64_tr_b16 a[32:33], v109 offset:13312
    ds_read_b64_tr_b16 a[34:35], v109 offset:17408
    s_mov_b32 s56, 1261568
    buffer_load_dwordx4 a[148:151], v14, s[16:19], s56 offen
    v_mfma_f32_16x16x32_bf16 v[124:127], a[52:55], a[92:95], v[124:127]
    ds_read_b64_tr_b16 a[36:37], v106 offset:13568
    ds_read_b64_tr_b16 a[38:39], v106 offset:17664
    v_mfma_f32_16x16x32_bf16 v[128:131], a[56:59], a[92:95], v[128:131]
    ds_read_b64_tr_b16 a[40:41], v109 offset:13568
    ds_read_b64_tr_b16 a[42:43], v109 offset:17664
    s_waitcnt vmcnt(13) lgkmcnt(8)
    v_mfma_f32_16x16x32_bf16 v[116:119], a[4:7], a[96:99], v[116:119]
    ds_read_b64_tr_b16 a[44:45], v106 offset:21504
    ds_read_b64_tr_b16 a[46:47], v106 offset:25600
    buffer_load_dwordx4 a[152:155], v14, s[20:23], s56 offen
    v_mfma_f32_16x16x32_bf16 v[120:123], a[8:11], a[96:99], v[120:123]
    ds_read_b64_tr_b16 a[48:49], v109 offset:21504
    ds_read_b64_tr_b16 a[50:51], v109 offset:25600
    v_mfma_f32_16x16x32_bf16 v[124:127], a[12:15], a[96:99], v[124:127]
    ds_read_b64_tr_b16 a[52:53], v106 offset:21760
    ds_read_b64_tr_b16 a[54:55], v106 offset:25856
    v_mfma_f32_16x16x32_bf16 v[128:131], a[16:19], a[96:99], v[128:131]
    ds_read_b64_tr_b16 a[56:57], v109 offset:21760
    ds_read_b64_tr_b16 a[58:59], v109 offset:25856
    s_waitcnt vmcnt(13) lgkmcnt(8)
    v_mfma_f32_16x16x32_bf16 v[116:119], a[28:31], a[100:103], v[116:119]
    ds_read_b64_tr_b16 a[4:5], v105 offset:29696
    ds_read_b64_tr_b16 a[6:7], v105 offset:33792
    v_mfma_f32_16x16x32_bf16 v[120:123], a[32:35], a[100:103], v[120:123]
    ds_read_b64_tr_b16 a[8:9], v108 offset:29696
    ds_read_b64_tr_b16 a[10:11], v108 offset:33792
    v_mfma_f32_16x16x32_bf16 v[124:127], a[36:39], a[100:103], v[124:127]
    ds_read_b64_tr_b16 a[12:13], v105 offset:29952
    ds_read_b64_tr_b16 a[14:15], v105 offset:34048
    v_mfma_f32_16x16x32_bf16 v[128:131], a[40:43], a[100:103], v[128:131]
    ds_read_b64_tr_b16 a[16:17], v108 offset:29952
    ds_read_b64_tr_b16 a[18:19], v108 offset:34048
    s_waitcnt vmcnt(12) lgkmcnt(8)
    v_mfma_f32_16x16x32_bf16 v[116:119], a[44:47], a[104:107], v[116:119]
    ds_read_b64_tr_b16 a[28:29], v104 offset:47616
    ds_read_b64_tr_b16 a[30:31], v104 offset:51712
    v_mfma_f32_16x16x32_bf16 v[120:123], a[48:51], a[104:107], v[120:123]
    ds_read_b64_tr_b16 a[32:33], v107 offset:47616
    ds_read_b64_tr_b16 a[34:35], v107 offset:51712
    v_mfma_f32_16x16x32_bf16 v[124:127], a[52:55], a[104:107], v[124:127]
    ds_read_b64_tr_b16 a[36:37], v104 offset:47872
    ds_read_b64_tr_b16 a[38:39], v104 offset:51968
    v_mfma_f32_16x16x32_bf16 v[128:131], a[56:59], a[104:107], v[128:131]
    ds_read_b64_tr_b16 a[40:41], v107 offset:47872
    ds_read_b64_tr_b16 a[42:43], v107 offset:51968
    s_waitcnt vmcnt(11) lgkmcnt(8)
    v_mfma_f32_16x16x32_bf16 v[116:119], a[4:7], a[108:111], v[116:119]
    ds_read_b64_tr_b16 a[44:45], v104 offset:12288
    ds_read_b64_tr_b16 a[46:47], v104 offset:16384
    v_mfma_f32_16x16x32_bf16 v[120:123], a[8:11], a[108:111], v[120:123]
    ds_read_b64_tr_b16 a[48:49], v107 offset:12288
    ds_read_b64_tr_b16 a[50:51], v107 offset:16384
    v_mfma_f32_16x16x32_bf16 v[124:127], a[12:15], a[108:111], v[124:127]
    ds_read_b64_tr_b16 a[52:53], v104 offset:12544
    ds_read_b64_tr_b16 a[54:55], v104 offset:16640
    v_mfma_f32_16x16x32_bf16 v[128:131], a[16:19], a[108:111], v[128:131]
    ds_read_b64_tr_b16 a[56:57], v107 offset:12544
    ds_read_b64_tr_b16 a[58:59], v107 offset:16640
    s_waitcnt vmcnt(10) lgkmcnt(8)
    v_mfma_f32_16x16x32_bf16 v[116:119], a[28:31], a[112:115], v[116:119]
    ds_read_b64_tr_b16 a[4:5], v104 offset:20480
    ds_read_b64_tr_b16 a[6:7], v104 offset:24576
    v_mfma_f32_16x16x32_bf16 v[120:123], a[32:35], a[112:115], v[120:123]
    ds_read_b64_tr_b16 a[8:9], v107 offset:20480
    ds_read_b64_tr_b16 a[10:11], v107 offset:24576
    v_mfma_f32_16x16x32_bf16 v[124:127], a[36:39], a[112:115], v[124:127]
    ds_read_b64_tr_b16 a[12:13], v104 offset:20736
    ds_read_b64_tr_b16 a[14:15], v104 offset:24832
    v_mfma_f32_16x16x32_bf16 v[128:131], a[40:43], a[112:115], v[128:131]
    ds_read_b64_tr_b16 a[16:17], v107 offset:20736
    ds_read_b64_tr_b16 a[18:19], v107 offset:24832
    s_waitcnt vmcnt(9) lgkmcnt(8)
    v_mfma_f32_16x16x32_bf16 v[116:119], a[44:47], a[116:119], v[116:119]
    v_mfma_f32_16x16x32_bf16 v[120:123], a[48:51], a[116:119], v[120:123]
    v_mfma_f32_16x16x32_bf16 v[124:127], a[52:55], a[116:119], v[124:127]
    v_mfma_f32_16x16x32_bf16 v[128:131], a[56:59], a[116:119], v[128:131]
    s_waitcnt vmcnt(8) lgkmcnt(0)
    v_mfma_f32_16x16x32_bf16 v[116:119], a[4:7], a[120:123], v[116:119]
    v_mfma_f32_16x16x32_bf16 v[120:123], a[8:11], a[120:123], v[120:123]
    v_mfma_f32_16x16x32_bf16 v[124:127], a[12:15], a[120:123], v[124:127]
    v_mfma_f32_16x16x32_bf16 v[128:131], a[16:19], a[120:123], v[128:131]
    s_nop 4
    v_pk_fma_f32 v[88:89], v[116:117], v[24:25], v[88:89]
    v_pk_fma_f32 v[90:91], v[118:119], v[26:27], v[90:91]
    v_pk_fma_f32 v[92:93], v[120:121], v[28:29], v[92:93]
    v_pk_fma_f32 v[94:95], v[122:123], v[30:31], v[94:95]
    v_pk_fma_f32 v[96:97], v[124:125], v[32:33], v[96:97]
    v_pk_fma_f32 v[98:99], v[126:127], v[34:35], v[98:99]
    v_pk_fma_f32 v[100:101], v[128:129], v[36:37], v[100:101]
    v_pk_fma_f32 v[102:103], v[130:131], v[38:39], v[102:103]
    v_accvgpr_read_b32 v10, a0
    v_pk_add_f32 v[132:133], v[88:89], v[92:93]
    v_pk_mul_f32 v[136:137], v[88:89], v[88:89]
    v_pk_add_f32 v[134:135], v[90:91], v[94:95]
    v_pk_mul_f32 v[138:139], v[90:91], v[90:91]
    v_pk_fma_f32 v[136:137], v[92:93], v[92:93], v[136:137]
    v_pk_fma_f32 v[138:139], v[94:95], v[94:95], v[138:139]
    v_pk_add_f32 v[132:133], v[132:133], v[96:97]
    v_pk_fma_f32 v[136:137], v[96:97], v[96:97], v[136:137]
    v_pk_add_f32 v[134:135], v[134:135], v[98:99]
    v_pk_fma_f32 v[138:139], v[98:99], v[98:99], v[138:139]
    v_pk_add_f32 v[132:133], v[132:133], v[100:101]
    v_pk_fma_f32 v[136:137], v[100:101], v[100:101], v[136:137]
    v_pk_add_f32 v[134:135], v[134:135], v[102:103]
    v_pk_fma_f32 v[138:139], v[102:103], v[102:103], v[138:139]
    v_pk_add_f32 v[132:133], v[132:133], v[134:135]
    v_pk_add_f32 v[136:137], v[136:137], v[138:139]
    s_and_b32 s57, s70, -1024
    v_add_f32 v132, v132, v133
    v_add_f32 v136, v136, v137
    s_nop 1
    v_permlane32_swap_b32 v132, v136
    v_add_f32 v132, v132, v136
    v_mov_b32 v133, v132
    s_nop 1
    v_permlane16_swap_b32 v132, v133
    v_add_f32 v140, v132, v133
    v_min_u32 v140, -2, v140
    s_cmp_eq_u32 s55, 0
    s_cbranch_scc1 Lslow_14
    buffer_store_dword v140, v10, s[36:39], s70 offen
    s_branch Ljoin_15
Lslow_14:
    buffer_store_dword v140, v10, s[36:39], s70 offen sc1
Ljoin_15:
    s_barrier
    s_mov_b32 s71, s57
    s_lshr_b32 s57, s61, 3
    s_lshl_b32 s57, s57, 1
    s_lshl_b32 s58, s49, 1
    s_xor_b32 s57, s57, s58
    s_and_b32 s58, s57, 2
    s_lshl_b32 s67, s58, 14
    s_and_b32 s57, s57, 4
    s_lshl_b32 s57, s57, 15
    s_or_b32 s66, s67, s57
    s_lshl_b32 s57, s46, 10
    s_lshr_b32 s68, s66, 4
    s_lshr_b32 s69, s67, 4
    s_or_b32 s68, s68, s57
    s_or_b32 s69, s69, s57
    v_bfe_u32 v8, v1, 4, 1
    v_lshl_add_u32 v7, v8, 9, v17
    v_lshl_add_u32 v104, v3, 10, v7
    s_lshl_b32 s57, s46, 11
    v_add_u32 v104, s57, v104
    v_xor_b32 v107, 32, v104
    v_add_u32 v105, 61440, v104
    v_add_u32 v106, 122880, v104
    v_add_u32 v108, 61440, v107
    v_add_u32 v109, 122880, v107
    v_bfe_u32 v9, v1, 4, 1
    v_lshl_add_u32 v113, v9, 9, v17
    v_lshl_add_u32 v113, v3, 10, v113
    v_xor_b32 v159, 32, v113
    v_add_u32 v114, 61440, v113
    v_add_u32 v160, 61440, v159
    v_add_u32 v115, 122880, v113
    v_add_u32 v161, 122880, v159
    s_lshl_b32 s57, s47, 2
    s_add_u32 s57, s57, s44
    s_lshl_b32 s58, s57, 15
    s_add_u32 s58, s58, 1048576
    s_lshr_b32 s59, s61, 4
    s_mul_i32 s59, s59, 8192
    v_add_u32 v19, s58, v16
    v_subrev_u32 v158, s59, v19
    v_add_u32 v19, s59, v19
    s_lshl_b32 s57, s47, 11
    s_lshl_b32 s58, s44, 7
    s_add_u32 s57, s57, s58
    s_add_u32 s57, s57, 4096
    v_and_b32 v7, 15, v1
    v_lshlrev_b32 v7, 2, v7
    v_add_u32 v22, s57, v7
    s_lshl_b32 s58, s48, 2
    s_add_u32 s57, s57, s58
    v_mov_b32 v23, s57
    s_mul_i32 s57, s50, 112
    s_mul_i32 s58, s46, 56
    s_add_u32 s57, s57, s58
    s_lshl_b32 s57, s57, 10
    s_add_u32 s57, s57, 5242880
    v_add_u32 v156, s57, v16
    v_and_b32 v8, 7, v1
    v_min_u32 v8, 6, v8
    v_lshlrev_b32 v8, 2, v8
    s_mul_i32 s57, s46, 28
    s_add_u32 s57, s57, s63
    v_add_u32 v18, s57, v8
    buffer_load_dwordx4 v[148:151], v16, s[36:39], s71 offen sc1
    s_waitcnt vmcnt(9)
    ds_write_b128 v110, a[124:127] offset:2048
    s_waitcnt vmcnt(8)
    ds_write_b128 v110, a[128:131] offset:6176
    s_waitcnt vmcnt(7)
    ds_write_b128 v110, a[132:135] offset:10304
    s_waitcnt vmcnt(6)
    ds_write_b128 v110, a[136:139] offset:14432
    s_waitcnt vmcnt(5)
    ds_write_b128 v110, a[140:143] offset:18560
    s_waitcnt vmcnt(4)
    ds_write_b128 v110, a[144:147] offset:22688
    s_waitcnt vmcnt(3)
    ds_write_b128 v110, a[148:151] offset:26816
    s_waitcnt vmcnt(2)
    ds_write_b128 v110, a[152:155] offset:30944
    s_waitcnt vmcnt(0)
    v_max3_u32 v4, v148, v149, v150
    v_max_u32 v4, v4, v151
    v_cmp_eq_u32 vcc, -1, v4
    s_cbranch_vccnz Lretry_16
Lback_17:
    v_pk_add_f32 v[148:149], v[148:149], v[150:151]
    v_add_f32 v148, v148, v149
    v_mov_b32 v149, v148
    s_nop 1
    v_permlane16_swap_b32 v148, v149
    v_add_f32 v148, v148, v149
    v_mov_b32 v149, v148
    s_nop 1
    v_permlane32_swap_b32 v148, v149
    v_mul_f32 v148, 0x3b000000, v148
    v_mul_f32 v149, 0x3b000000, v149
    v_fma_f32 v149, -v148, v148, v149
    v_max_f32 v149, 0, v149
    v_cvt_pk_bf16_f32 v149, v149, v149
    v_and_b32 v149, 0xffff0000, v149
    v_add_f32 v149, 0x3727c5ac, v149
    v_cvt_pk_bf16_f32 v149, v149, v149
    v_and_b32 v149, 0xffff0000, v149
    v_sqrt_f32 v149, v149
    v_cvt_pk_bf16_f32 v148, v148, v148
    v_and_b32 v148, 0xffff0000, v148
    v_cvt_pk_bf16_f32 v149, v149, v149
    v_and_b32 v149, 0xffff0000, v149
    v_rcp_f32 v150, v149
    s_nop 0
    v_mul_f32_e64 v151, -v148, v150
    v_pk_fma_f32 v[116:117], v[88:89], v[150:151], v[150:151] op_sel:[0,0,1] op_sel_hi:[1,0,1]
    v_pk_fma_f32 v[118:119], v[90:91], v[150:151], v[150:151] op_sel:[0,0,1] op_sel_hi:[1,0,1]
    v_pk_fma_f32 v[120:121], v[92:93], v[150:151], v[150:151] op_sel:[0,0,1] op_sel_hi:[1,0,1]
    v_pk_fma_f32 v[122:123], v[94:95], v[150:151], v[150:151] op_sel:[0,0,1] op_sel_hi:[1,0,1]
    v_pk_fma_f32 v[124:125], v[96:97], v[150:151], v[150:151] op_sel:[0,0,1] op_sel_hi:[1,0,1]
    v_pk_fma_f32 v[126:127], v[98:99], v[150:151], v[150:151] op_sel:[0,0,1] op_sel_hi:[1,0,1]
    v_pk_fma_f32 v[128:129], v[100:101], v[150:151], v[150:151] op_sel:[0,0,1] op_sel_hi:[1,0,1]
    v_pk_fma_f32 v[130:131], v[102:103], v[150:151], v[150:151] op_sel:[0,0,1] op_sel_hi:[1,0,1]
    v_pk_fma_f32 v[116:117], v[116:117], v[40:41], v[56:57]
    v_pk_fma_f32 v[118:119], v[118:119], v[42:43], v[58:59]
    v_pk_fma_f32 v[120:121], v[120:121], v[44:45], v[60:61]
    v_pk_fma_f32 v[122:123], v[122:123], v[46:47], v[62:63]
    v_pk_fma_f32 v[124:125], v[124:125], v[48:49], v[64:65]
    v_pk_fma_f32 v[126:127], v[126:127], v[50:51], v[66:67]
    v_pk_fma_f32 v[128:129], v[128:129], v[52:53], v[68:69]
    v_pk_fma_f32 v[130:131], v[130:131], v[54:55], v[70:71]
    v_cvt_pk_bf16_f32 v132, v116, v117
    v_cvt_pk_bf16_f32 v133, v118, v119
    v_cvt_pk_bf16_f32 v134, v120, v121
    v_cvt_pk_bf16_f32 v135, v122, v123
    v_cvt_pk_bf16_f32 v136, v124, v125
    v_cvt_pk_bf16_f32 v137, v126, v127
    v_cvt_pk_bf16_f32 v138, v128, v129
    v_cvt_pk_bf16_f32 v139, v130, v131
    s_cmp_eq_u32 s55, 0
    s_cbranch_scc1 Lslow_18
    buffer_store_dwordx4 v[132:135], v16, s[36:39], s64 offen
    buffer_store_dwordx4 v[136:139], v16, s[36:39], s64 offen offset:2048
    s_branch Ljoin_19
Lslow_18:
    buffer_store_dwordx4 v[132:135], v16, s[36:39], s64 offen sc1
    buffer_store_dwordx4 v[136:139], v16, s[36:39], s64 offen offset:2048 sc1
Ljoin_19:
    s_waitcnt vmcnt(0)
    s_mov_b64 exec, 1
    s_cmp_eq_u32 s55, 0
    s_cbranch_scc1 Lslow_20
    buffer_store_dword v6, v15, s[36:39], 0 offen offset:512
    s_branch Ljoin_21
Lslow_20:
    buffer_store_dword v6, v15, s[36:39], 0 offen offset:512 sc1
Ljoin_21:
    s_mov_b64 exec, -1
    s_add_u32 m0, s51, 35072
    s_mov_b32 s52, 114688
    buffer_load_dwordx4 v21, s[16:19], s52 offen lds
    s_add_u32 m0, s51, 39200
    s_nop 0
    buffer_load_dwordx4 v21, s[20:23], s52 offen lds
    s_add_u32 m0, s51, 43328
    s_mov_b32 s52, 229376
    buffer_load_dwordx4 v21, s[16:19], s52 offen lds
    s_add_u32 m0, s51, 47456
    s_nop 0
    buffer_load_dwordx4 v21, s[20:23], s52 offen lds
    s_add_u32 m0, s51, 86784
    s_mov_b32 s52, 344064
    buffer_load_dwordx4 v21, s[16:19], s52 offen lds
    s_add_u32 m0, s51, 90912
    s_nop 0
    buffer_load_dwordx4 v21, s[20:23], s52 offen lds
    s_mov_b32 s40, s36
    s_mov_b32 s41, s37
    s_mov_b32 s42, s38
    s_cmp_ge_u32 s48, 14
    s_cbranch_scc1 Lidle_22
    s_barrier
    ds_read_b64_tr_b16 a[4:5], v113 offset:53760
    ds_read_b64_tr_b16 a[6:7], v113 offset:55808
    ds_read_b64_tr_b16 a[8:9], v113 offset:57888
    ds_read_b64_tr_b16 a[10:11], v113 offset:59936
    ds_read_b64_tr_b16 a[12:13], v159 offset:53760
    ds_read_b64_tr_b16 a[14:15], v159 offset:55808
    ds_read_b64_tr_b16 a[16:17], v159 offset:57888
    ds_read_b64_tr_b16 a[18:19], v159 offset:59936
    ds_read_b64_tr_b16 a[28:29], v113 offset:54016
    ds_read_b64_tr_b16 a[30:31], v113 offset:56064
    ds_read_b64_tr_b16 a[32:33], v113 offset:58144
    ds_read_b64_tr_b16 a[34:35], v113 offset:60192
    ds_read_b64_tr_b16 a[36:37], v159 offset:54016
    ds_read_b64_tr_b16 a[38:39], v159 offset:56064
    ds_read_b64_tr_b16 a[40:41], v159 offset:58144
    ds_read_b64_tr_b16 a[42:43], v159 offset:60192
    s_mov_b32 s53, 0
Lpoll_24:
    s_add_u32 s53, s53, 1
    s_cmp_gt_u32 s53, 65536
    s_cbranch_scc1 Lexit
    buffer_load_dword v8, v22, s[36:39], 0 offen offset:512 sc1
    s_waitcnt vmcnt(0)
    v_cmp_ne_u32 vcc, s54, v8
    s_cbranch_vccnz Lpoll_24
    s_mov_b32 s62, 0
    buffer_load_dwordx4 a[60:63], v19, s[40:43], s62 offen offset:0 sc1
    buffer_load_dwordx4 a[64:67], v19, s[40:43], s62 offen offset:1024 sc1
    buffer_load_dwordx4 a[68:71], v19, s[40:43], s62 offen offset:2048 sc1
    buffer_load_dwordx4 a[72:75], v19, s[40:43], s62 offen offset:3072 sc1
    s_mov_b32 s62, 4096
    buffer_load_dwordx4 a[76:79], v19, s[40:43], s62 offen offset:0 sc1
    buffer_load_dwordx4 a[80:83], v19, s[40:43], s62 offen offset:1024 sc1
    buffer_load_dwordx4 a[84:87], v19, s[40:43], s62 offen offset:2048 sc1
    buffer_load_dwordx4 a[88:91], v19, s[40:43], s62 offen offset:3072 sc1
    s_waitcnt vmcnt(6) lgkmcnt(8)
    v_mfma_f32_16x16x32_bf16 v[24:27], a[4:7], a[60:63], 0
    ds_read_b64_tr_b16 a[44:45], v114 offset:576
    v_accvgpr_read_b32 v7, a22
    buffer_load_dword a252, v7, s[24:27], 0 offen
    v_mfma_f32_16x16x32_bf16 v[28:31], a[4:7], a[64:67], 0
    ds_read_b64_tr_b16 a[46:47], v114 offset:2624
    v_mfma_f32_16x16x32_bf16 v[32:35], a[8:11], a[60:63], 0
    ds_read_b64_tr_b16 a[48:49], v114 offset:4704
    v_mfma_f32_16x16x32_bf16 v[36:39], a[8:11], a[64:67], 0
    ds_read_b64_tr_b16 a[50:51], v114 offset:6752
    v_mfma_f32_16x16x32_bf16 v[40:43], a[12:15], a[60:63], 0
    ds_read_b64_tr_b16 a[52:53], v160 offset:576
    v_mfma_f32_16x16x32_bf16 v[44:47], a[12:15], a[64:67], 0
    ds_read_b64_tr_b16 a[54:55], v160 offset:2624
    v_mfma_f32_16x16x32_bf16 v[48:51], a[16:19], a[60:63], 0
    ds_read_b64_tr_b16 a[56:57], v160 offset:4704
    s_add_u32 m0, s51, 105536
    s_mov_b32 s52, 917504
    v_mfma_f32_16x16x32_bf16 v[52:55], a[16:19], a[64:67], 0
    ds_read_b64_tr_b16 a[58:59], v160 offset:6752
    s_mov_b32 s62, 8192
    buffer_load_dwordx4 a[92:95], v158, s[40:43], s62 offen offset:0 sc1
    s_waitcnt lgkmcnt(8)
    v_mfma_f32_16x16x32_bf16 v[56:59], a[28:31], a[60:63], 0
    ds_read_b64_tr_b16 a[4:5], v114 offset:832
    buffer_load_dwordx4 v21, s[16:19], s52 offen lds
    v_mfma_f32_16x16x32_bf16 v[60:63], a[28:31], a[64:67], 0
    ds_read_b64_tr_b16 a[6:7], v114 offset:2880
    v_mfma_f32_16x16x32_bf16 v[64:67], a[32:35], a[60:63], 0
    ds_read_b64_tr_b16 a[8:9], v114 offset:4960
    v_mfma_f32_16x16x32_bf16 v[68:71], a[32:35], a[64:67], 0
    ds_read_b64_tr_b16 a[10:11], v114 offset:7008
    v_mfma_f32_16x16x32_bf16 v[164:167], a[36:39], a[60:63], 0
    ds_read_b64_tr_b16 a[12:13], v160 offset:832
    v_mfma_f32_16x16x32_bf16 v[168:171], a[36:39], a[64:67], 0
    ds_read_b64_tr_b16 a[14:15], v160 offset:2880
    s_add_u32 m0, s51, 109664
    s_nop 0
    buffer_load_dwordx4 v21, s[20:23], s52 offen lds
    v_mfma_f32_16x16x32_bf16 v[172:175], a[40:43], a[60:63], 0
    ds_read_b64_tr_b16 a[16:17], v160 offset:4960
    buffer_load_dwordx4 a[96:99], v158, s[40:43], s62 offen offset:1024 sc1
    v_mfma_f32_16x16x32_bf16 v[176:179], a[40:43], a[64:67], 0
    ds_read_b64_tr_b16 a[18:19], v160 offset:7008
    s_waitcnt vmcnt(9) lgkmcnt(8)
    v_mfma_f32_16x16x32_bf16 v[24:27], a[44:47], a[68:71], v[24:27]
    s_barrier
    ds_read_b64_tr_b16 a[28:29], v114 offset:8832
    v_mfma_f32_16x16x32_bf16 v[28:31], a[44:47], a[72:75], v[28:31]
    ds_read_b64_tr_b16 a[30:31], v114 offset:10880
    v_mfma_f32_16x16x32_bf16 v[32:35], a[48:51], a[68:71], v[32:35]
    ds_read_b64_tr_b16 a[32:33], v114 offset:12960
    v_mfma_f32_16x16x32_bf16 v[36:39], a[48:51], a[72:75], v[36:39]
    ds_read_b64_tr_b16 a[34:35], v114 offset:15008
    s_add_u32 m0, s51, 51584
    s_mov_b32 s52, 1032192
    v_mfma_f32_16x16x32_bf16 v[40:43], a[52:55], a[68:71], v[40:43]
    ds_read_b64_tr_b16 a[36:37], v160 offset:8832
    buffer_load_dwordx4 v21, s[16:19], s52 offen lds
    v_mfma_f32_16x16x32_bf16 v[44:47], a[52:55], a[72:75], v[44:47]
    ds_read_b64_tr_b16 a[38:39], v160 offset:10880
    v_mfma_f32_16x16x32_bf16 v[48:51], a[56:59], a[68:71], v[48:51]
    ds_read_b64_tr_b16 a[40:41], v160 offset:12960
    buffer_load_dwordx4 a[100:103], v158, s[40:43], s62 offen offset:2048 sc1
    v_mfma_f32_16x16x32_bf16 v[52:55], a[56:59], a[72:75], v[52:55]
    ds_read_b64_tr_b16 a[42:43], v160 offset:15008
    s_waitcnt lgkmcnt(8)
    v_mfma_f32_16x16x32_bf16 v[56:59], a[4:7], a[68:71], v[56:59]
    ds_read_b64_tr_b16 a[44:45], v114 offset:9088
    v_mfma_f32_16x16x32_bf16 v[60:63], a[4:7], a[72:75], v[60:63]
    ds_read_b64_tr_b16 a[46:47], v114 offset:11136
    v_mfma_f32_16x16x32_bf16 v[64:67], a[8:11], a[68:71], v[64:67]
    ds_read_b64_tr_b16 a[48:49], v114 offset:13216
    s_add_u32 m0, s51, 55712
    s_nop 0
    buffer_load_dwordx4 v21, s[20:23], s52 offen lds
    v_mfma_f32_16x16x32_bf16 v[68:71], a[8:11], a[72:75], v[68:71]
    ds_read_b64_tr_b16 a[50:51], v114 offset:15264
    v_mfma_f32_16x16x32_bf16 v[164:167], a[12:15], a[68:71], v[164:167]
    ds_read_b64_tr_b16 a[52:53], v160 offset:9088
    v_mfma_f32_16x16x32_bf16 v[168:171], a[12:15], a[72:75], v[168:171]
    ds_read_b64_tr_b16 a[54:55], v160 offset:11136
    buffer_load_dwordx4 a[104:107], v158, s[40:43], s62 offen offset:3072 sc1
    v_mfma_f32_16x16x32_bf16 v[172:175], a[16:19], a[68:71], v[172:175]
    ds_read_b64_tr_b16 a[56:57], v160 offset:13216
    v_mfma_f32_16x16x32_bf16 v[176:179], a[16:19], a[72:75], v[176:179]
    ds_read_b64_tr_b16 a[58:59], v160 offset:15264
    s_waitcnt vmcnt(11) lgkmcnt(8)
    v_mfma_f32_16x16x32_bf16 v[24:27], a[28:31], a[76:79], v[24:27]
    ds_read_b64_tr_b16 a[4:5], v114 offset:17088
    v_mfma_f32_16x16x32_bf16 v[28:31], a[28:31], a[80:83], v[28:31]
    ds_read_b64_tr_b16 a[6:7], v114 offset:19136
    s_add_u32 m0, s51, 113792
    s_mov_b32 s52, 1146880
    v_mfma_f32_16x16x32_bf16 v[32:35], a[32:35], a[76:79], v[32:35]
    ds_read_b64_tr_b16 a[8:9], v114 offset:21216
    buffer_load_dwordx4 v21, s[16:19], s52 offen lds
    v_mfma_f32_16x16x32_bf16 v[36:39], a[32:35], a[80:83], v[36:39]
    ds_read_b64_tr_b16 a[10:11], v114 offset:23264
    v_mfma_f32_16x16x32_bf16 v[40:43], a[36:39], a[76:79], v[40:43]
    ds_read_b64_tr_b16 a[12:13], v160 offset:17088
    v_mfma_f32_16x16x32_bf16 v[44:47], a[36:39], a[80:83], v[44:47]
    ds_read_b64_tr_b16 a[14:15], v160 offset:19136
    s_mov_b32 s62, 12288
    buffer_load_dwordx4 a[108:111], v158, s[40:43], s62 offen offset:0 sc1
    v_mfma_f32_16x16x32_bf16 v[48:51], a[40:43], a[76:79], v[48:51]
    ds_read_b64_tr_b16 a[16:17], v160 offset:21216
    v_mfma_f32_16x16x32_bf16 v[52:55], a[40:43], a[80:83], v[52:55]
    ds_read_b64_tr_b16 a[18:19], v160 offset:23264
    s_add_u32 m0, s51, 117920
    s_waitcnt lgkmcnt(8)
    v_mfma_f32_16x16x32_bf16 v[56:59], a[44:47], a[76:79], v[56:59]
    ds_read_b64_tr_b16 a[28:29], v114 offset:17344
    buffer_load_dwordx4 v21, s[20:23], s52 offen lds
    v_mfma_f32_16x16x32_bf16 v[60:63], a[44:47], a[80:83], v[60:63]
    ds_read_b64_tr_b16 a[30:31], v114 offset:19392
    v_mfma_f32_16x16x32_bf16 v[64:67], a[48:51], a[76:79], v[64:67]
    ds_read_b64_tr_b16 a[32:33], v114 offset:21472
    v_mfma_f32_16x16x32_bf16 v[68:71], a[48:51], a[80:83], v[68:71]
    ds_read_b64_tr_b16 a[34:35], v114 offset:23520
    v_mfma_f32_16x16x32_bf16 v[164:167], a[52:55], a[76:79], v[164:167]
    ds_read_b64_tr_b16 a[36:37], v160 offset:17344
    buffer_load_dwordx4 a[112:115], v158, s[40:43], s62 offen offset:1024 sc1
    v_mfma_f32_16x16x32_bf16 v[168:171], a[52:55], a[80:83], v[168:171]
    ds_read_b64_tr_b16 a[38:39], v160 offset:19392
    v_mfma_f32_16x16x32_bf16 v[172:175], a[56:59], a[76:79], v[172:175]
    ds_read_b64_tr_b16 a[40:41], v160 offset:21472
    s_add_u32 m0, s51, 122048
    s_mov_b32 s52, 1261568
    v_mfma_f32_16x16x32_bf16 v[176:179], a[56:59], a[80:83], v[176:179]
    ds_read_b64_tr_b16 a[42:43], v160 offset:23520
    buffer_load_dwordx4 v21, s[16:19], s52 offen lds
    s_waitcnt vmcnt(14) lgkmcnt(8)
    v_mfma_f32_16x16x32_bf16 v[24:27], a[4:7], a[84:87], v[24:27]
    s_barrier
    ds_read_b64_tr_b16 a[44:45], v114 offset:35840
    v_mfma_f32_16x16x32_bf16 v[28:31], a[4:7], a[88:91], v[28:31]
    ds_read_b64_tr_b16 a[46:47], v114 offset:37888
    v_mfma_f32_16x16x32_bf16 v[32:35], a[8:11], a[84:87], v[32:35]
    ds_read_b64_tr_b16 a[48:49], v114 offset:39968
    v_mfma_f32_16x16x32_bf16 v[36:39], a[8:11], a[88:91], v[36:39]
    ds_read_b64_tr_b16 a[50:51], v114 offset:42016
    buffer_load_dwordx4 a[116:119], v158, s[40:43], s62 offen offset:2048 sc1
    v_mfma_f32_16x16x32_bf16 v[40:43], a[12:15], a[84:87], v[40:43]
    ds_read_b64_tr_b16 a[52:53], v160 offset:35840
    v_mfma_f32_16x16x32_bf16 v[44:47], a[12:15], a[88:91], v[44:47]
    ds_read_b64_tr_b16 a[54:55], v160 offset:37888
    s_add_u32 m0, s51, 126176
    s_nop 0
    buffer_load_dwordx4 v21, s[20:23], s52 offen lds
    v_mfma_f32_16x16x32_bf16 v[48:51], a[16:19], a[84:87], v[48:51]
    ds_read_b64_tr_b16 a[56:57], v160 offset:39968
    v_mfma_f32_16x16x32_bf16 v[52:55], a[16:19], a[88:91], v[52:55]
    ds_read_b64_tr_b16 a[58:59], v160 offset:42016
    s_waitcnt lgkmcnt(8)
    v_mfma_f32_16x16x32_bf16 v[56:59], a[28:31], a[84:87], v[56:59]
    ds_read_b64_tr_b16 a[4:5], v114 offset:36096
    v_mfma_f32_16x16x32_bf16 v[60:63], a[28:31], a[88:91], v[60:63]
    ds_read_b64_tr_b16 a[6:7], v114 offset:38144
    v_mfma_f32_16x16x32_bf16 v[64:67], a[32:35], a[84:87], v[64:67]
    ds_read_b64_tr_b16 a[8:9], v114 offset:40224
    v_mfma_f32_16x16x32_bf16 v[68:71], a[32:35], a[88:91], v[68:71]
    ds_read_b64_tr_b16 a[10:11], v114 offset:42272
    buffer_load_dwordx4 a[120:123], v158, s[40:43], s62 offen offset:3072 sc1
    v_mfma_f32_16x16x32_bf16 v[164:167], a[36:39], a[84:87], v[164:167]
    ds_read_b64_tr_b16 a[12:13], v160 offset:36096
    s_add_u32 m0, s51, 59712
    s_nop 0
    buffer_load_dwordx4 v14, s[16:19], 0 offen offset:128 lds
    v_mfma_f32_16x16x32_bf16 v[168:171], a[36:39], a[88:91], v[168:171]
    ds_read_b64_tr_b16 a[14:15], v160 offset:38144
    v_mfma_f32_16x16x32_bf16 v[172:175], a[40:43], a[84:87], v[172:175]
    ds_read_b64_tr_b16 a[16:17], v160 offset:40224
    v_mfma_f32_16x16x32_bf16 v[176:179], a[40:43], a[88:91], v[176:179]
    ds_read_b64_tr_b16 a[18:19], v160 offset:42272
    s_waitcnt vmcnt(13) lgkmcnt(8)
    v_mfma_f32_16x16x32_bf16 v[24:27], a[44:47], a[92:95], v[24:27]
    ds_read_b64_tr_b16 a[28:29], v113 offset:35072
    v_mfma_f32_16x16x32_bf16 v[28:31], a[44:47], a[96:99], v[28:31]
    ds_read_b64_tr_b16 a[30:31], v113 offset:37120
    v_mfma_f32_16x16x32_bf16 v[32:35], a[48:51], a[92:95], v[32:35]
    ds_read_b64_tr_b16 a[32:33], v113 offset:39200
    s_mov_b32 s62, 16384
    buffer_load_dwordx4 a[0:3], v19, s[40:43], s62 offen offset:0 sc1
    v_mfma_f32_16x16x32_bf16 v[36:39], a[48:51], a[96:99], v[36:39]
    ds_read_b64_tr_b16 a[34:35], v113 offset:41248
    s_add_u32 m0, s51, 63840
    s_nop 0
    buffer_load_dwordx4 v14, s[20:23], 0 offen offset:128 lds
    v_mfma_f32_16x16x32_bf16 v[40:43], a[52:55], a[92:95], v[40:43]
    ds_read_b64_tr_b16 a[36:37], v159 offset:35072
    v_mfma_f32_16x16x32_bf16 v[44:47], a[52:55], a[96:99], v[44:47]
    ds_read_b64_tr_b16 a[38:39], v159 offset:37120
    v_mfma_f32_16x16x32_bf16 v[48:51], a[56:59], a[92:95], v[48:51]
    ds_read_b64_tr_b16 a[40:41], v159 offset:39200
    v_mfma_f32_16x16x32_bf16 v[52:55], a[56:59], a[96:99], v[52:55]
    ds_read_b64_tr_b16 a[42:43], v159 offset:41248
    s_waitcnt lgkmcnt(8)
    v_mfma_f32_16x16x32_bf16 v[56:59], a[4:7], a[92:95], v[56:59]
    ds_read_b64_tr_b16 a[44:45], v113 offset:35328
    v_mfma_f32_16x16x32_bf16 v[60:63], a[4:7], a[96:99], v[60:63]
    ds_read_b64_tr_b16 a[46:47], v113 offset:37376
    s_add_u32 m0, s51, 67968
    s_mov_b32 s52, 114688
    v_mfma_f32_16x16x32_bf16 v[64:67], a[8:11], a[92:95], v[64:67]
    ds_read_b64_tr_b16 a[48:49], v113 offset:39456
    buffer_load_dwordx4 a[124:127], v19, s[40:43], s62 offen offset:1024 sc1
    buffer_load_dwordx4 v14, s[16:19], s52 offen offset:128 lds
    v_mfma_f32_16x16x32_bf16 v[68:71], a[8:11], a[96:99], v[68:71]
    ds_read_b64_tr_b16 a[50:51], v113 offset:41504
    v_mfma_f32_16x16x32_bf16 v[164:167], a[12:15], a[92:95], v[164:167]
    ds_read_b64_tr_b16 a[52:53], v159 offset:35328
    v_mfma_f32_16x16x32_bf16 v[168:171], a[12:15], a[96:99], v[168:171]
    ds_read_b64_tr_b16 a[54:55], v159 offset:37376
    v_mfma_f32_16x16x32_bf16 v[172:175], a[16:19], a[92:95], v[172:175]
    ds_read_b64_tr_b16 a[56:57], v159 offset:39456
    v_mfma_f32_16x16x32_bf16 v[176:179], a[16:19], a[96:99], v[176:179]
    ds_read_b64_tr_b16 a[58:59], v159 offset:41504
    s_add_u32 m0, s51, 72096
    s_waitcnt vmcnt(13) lgkmcnt(8)
    v_mfma_f32_16x16x32_bf16 v[24:27], a[28:31], a[100:103], v[24:27]
    s_barrier
    ds_read_b64_tr_b16 a[4:5], v113 offset:43328
    buffer_load_dwordx4 v14, s[20:23], s52 offen offset:128 lds
    v_mfma_f32_16x16x32_bf16 v[28:31], a[28:31], a[104:107], v[28:31]
    ds_read_b64_tr_b16 a[6:7], v113 offset:45376
    buffer_load_dwordx4 a[128:131], v19, s[40:43], s62 offen offset:2048 sc1
    v_mfma_f32_16x16x32_bf16 v[32:35], a[32:35], a[100:103], v[32:35]
    ds_read_b64_tr_b16 a[8:9], v113 offset:47456
    v_mfma_f32_16x16x32_bf16 v[36:39], a[32:35], a[104:107], v[36:39]
    ds_read_b64_tr_b16 a[10:11], v113 offset:49504
    v_mfma_f32_16x16x32_bf16 v[40:43], a[36:39], a[100:103], v[40:43]
    ds_read_b64_tr_b16 a[12:13], v159 offset:43328
    v_mfma_f32_16x16x32_bf16 v[44:47], a[36:39], a[104:107], v[44:47]
    ds_read_b64_tr_b16 a[14:15], v159 offset:45376
    v_mfma_f32_16x16x32_bf16 v[48:51], a[40:43], a[100:103], v[48:51]
    ds_read_b64_tr_b16 a[16:17], v159 offset:47456
    s_add_u32 m0, s51, 76224
    s_mov_b32 s52, 229376
    v_mfma_f32_16x16x32_bf16 v[52:55], a[40:43], a[104:107], v[52:55]
    ds_read_b64_tr_b16 a[18:19], v159 offset:49504
    buffer_load_dwordx4 v14, s[16:19], s52 offen offset:128 lds
    s_waitcnt lgkmcnt(8)
    v_mfma_f32_16x16x32_bf16 v[56:59], a[44:47], a[100:103], v[56:59]
    ds_read_b64_tr_b16 a[28:29], v113 offset:43584
    buffer_load_dwordx4 a[132:135], v19, s[40:43], s62 offen offset:3072 sc1
    v_mfma_f32_16x16x32_bf16 v[60:63], a[44:47], a[104:107], v[60:63]
    ds_read_b64_tr_b16 a[30:31], v113 offset:45632
    v_mfma_f32_16x16x32_bf16 v[64:67], a[48:51], a[100:103], v[64:67]
    ds_read_b64_tr_b16 a[32:33], v113 offset:47712
    v_mfma_f32_16x16x32_bf16 v[68:71], a[48:51], a[104:107], v[68:71]
    ds_read_b64_tr_b16 a[34:35], v113 offset:49760
    v_mfma_f32_16x16x32_bf16 v[164:167], a[52:55], a[100:103], v[164:167]
    ds_read_b64_tr_b16 a[36:37], v159 offset:43584
    v_mfma_f32_16x16x32_bf16 v[168:171], a[52:55], a[104:107], v[168:171]
    ds_read_b64_tr_b16 a[38:39], v159 offset:45632
    s_add_u32 m0, s51, 80352
    s_nop 0
    buffer_load_dwordx4 v14, s[20:23], s52 offen offset:128 lds
    v_mfma_f32_16x16x32_bf16 v[172:175], a[56:59], a[100:103], v[172:175]
    ds_read_b64_tr_b16 a[40:41], v159 offset:47712
    v_mfma_f32_16x16x32_bf16 v[176:179], a[56:59], a[104:107], v[176:179]
    ds_read_b64_tr_b16 a[42:43], v159 offset:49760
    s_waitcnt vmcnt(14) lgkmcnt(8)
    v_mfma_f32_16x16x32_bf16 v[24:27], a[4:7], a[108:111], v[24:27]
    ds_read_b64_tr_b16 a[44:45], v114 offset:25344
    s_mov_b32 s62, 20480
    buffer_load_dwordx4 a[136:139], v19, s[40:43], s62 offen offset:0 sc1
    v_mfma_f32_16x16x32_bf16 v[28:31], a[4:7], a[112:115], v[28:31]
    ds_read_b64_tr_b16 a[46:47], v114 offset:27392
    v_mfma_f32_16x16x32_bf16 v[32:35], a[8:11], a[108:111], v[32:35]
    ds_read_b64_tr_b16 a[48:49], v114 offset:29472
    v_mfma_f32_16x16x32_bf16 v[36:39], a[8:11], a[112:115], v[36:39]
    ds_read_b64_tr_b16 a[50:51], v114 offset:31520
    s_add_u32 m0, s51, 94912
    s_mov_b32 s52, 344064
    v_mfma_f32_16x16x32_bf16 v[40:43], a[12:15], a[108:111], v[40:43]
    ds_read_b64_tr_b16 a[52:53], v160 offset:25344
    buffer_load_dwordx4 v14, s[16:19], s52 offen offset:128 lds
    v_mfma_f32_16x16x32_bf16 v[44:47], a[12:15], a[112:115], v[44:47]
    ds_read_b64_tr_b16 a[54:55], v160 offset:27392
    v_mfma_f32_16x16x32_bf16 v[48:51], a[16:19], a[108:111], v[48:51]
    ds_read_b64_tr_b16 a[56:57], v160 offset:29472
    v_mfma_f32_16x16x32_bf16 v[52:55], a[16:19], a[112:115], v[52:55]
    ds_read_b64_tr_b16 a[58:59], v160 offset:31520
    buffer_load_dwordx4 a[140:143], v19, s[40:43], s62 offen offset:1024 sc1
    s_waitcnt lgkmcnt(8)
    v_mfma_f32_16x16x32_bf16 v[56:59], a[28:31], a[108:111], v[56:59]
    ds_read_b64_tr_b16 a[4:5], v114 offset:25600
    v_mfma_f32_16x16x32_bf16 v[60:63], a[28:31], a[112:115], v[60:63]
    ds_read_b64_tr_b16 a[6:7], v114 offset:27648
    v_mfma_f32_16x16x32_bf16 v[64:67], a[32:35], a[108:111], v[64:67]
    ds_read_b64_tr_b16 a[8:9], v114 offset:29728
    s_add_u32 m0, s51, 99040
    s_nop 0
    buffer_load_dwordx4 v14, s[20:23], s52 offen offset:128 lds
    v_mfma_f32_16x16x32_bf16 v[68:71], a[32:35], a[112:115], v[68:71]
    ds_read_b64_tr_b16 a[10:11], v114 offset:31776
    v_mfma_f32_16x16x32_bf16 v[164:167], a[36:39], a[108:111], v[164:167]
    ds_read_b64_tr_b16 a[12:13], v160 offset:25600
    v_mfma_f32_16x16x32_bf16 v[168:171], a[36:39], a[112:115], v[168:171]
    ds_read_b64_tr_b16 a[14:15], v160 offset:27648
    v_mfma_f32_16x16x32_bf16 v[172:175], a[40:43], a[108:111], v[172:175]
    ds_read_b64_tr_b16 a[16:17], v160 offset:29728
    v_mfma_f32_16x16x32_bf16 v[176:179], a[40:43], a[112:115], v[176:179]
    ds_read_b64_tr_b16 a[18:19], v160 offset:31776
    buffer_load_dwordx4 a[144:147], v19, s[40:43], s62 offen offset:2048 sc1
    s_waitcnt vmcnt(15) lgkmcnt(8)
    v_mfma_f32_16x16x32_bf16 v[24:27], a[44:47], a[116:119], v[24:27]
    s_barrier
    ds_read_b64_tr_b16 a[28:29], v113 offset:2048
    v_mfma_f32_16x16x32_bf16 v[28:31], a[44:47], a[120:123], v[28:31]
    ds_read_b64_tr_b16 a[30:31], v113 offset:4096
    s_add_u32 m0, s51, 34944
    s_nop 0
    buffer_load_dwordx4 v21, s[16:19], 0 offen offset:128 lds
    v_mfma_f32_16x16x32_bf16 v[32:35], a[48:51], a[116:119], v[32:35]
    ds_read_b64_tr_b16 a[32:33], v113 offset:6176
    v_mfma_f32_16x16x32_bf16 v[36:39], a[48:51], a[120:123], v[36:39]
    ds_read_b64_tr_b16 a[34:35], v113 offset:8224
    v_mfma_f32_16x16x32_bf16 v[40:43], a[52:55], a[116:119], v[40:43]
    ds_read_b64_tr_b16 a[36:37], v159 offset:2048
    v_mfma_f32_16x16x32_bf16 v[44:47], a[52:55], a[120:123], v[44:47]
    ds_read_b64_tr_b16 a[38:39], v159 offset:4096
    v_mfma_f32_16x16x32_bf16 v[48:51], a[56:59], a[116:119], v[48:51]
    ds_read_b64_tr_b16 a[40:41], v159 offset:6176
    buffer_load_dwordx4 a[148:151], v19, s[40:43], s62 offen offset:3072 sc1
    v_mfma_f32_16x16x32_bf16 v[52:55], a[56:59], a[120:123], v[52:55]
    ds_read_b64_tr_b16 a[42:43], v159 offset:8224
    s_add_u32 m0, s51, 39072
    s_waitcnt lgkmcnt(8)
    v_mfma_f32_16x16x32_bf16 v[56:59], a[4:7], a[116:119], v[56:59]
    ds_read_b64_tr_b16 a[44:45], v113 offset:2304
    buffer_load_dwordx4 v21, s[20:23], 0 offen offset:128 lds
    v_mfma_f32_16x16x32_bf16 v[60:63], a[4:7], a[120:123], v[60:63]
    ds_read_b64_tr_b16 a[46:47], v113 offset:4352
    v_mfma_f32_16x16x32_bf16 v[64:67], a[8:11], a[116:119], v[64:67]
    ds_read_b64_tr_b16 a[48:49], v113 offset:6432
    v_mfma_f32_16x16x32_bf16 v[68:71], a[8:11], a[120:123], v[68:71]
    ds_read_b64_tr_b16 a[50:51], v113 offset:8480
    v_mfma_f32_16x16x32_bf16 v[164:167], a[12:15], a[116:119], v[164:167]
    ds_read_b64_tr_b16 a[52:53], v159 offset:2304
    v_mfma_f32_16x16x32_bf16 v[168:171], a[12:15], a[120:123], v[168:171]
    ds_read_b64_tr_b16 a[54:55], v159 offset:4352
    s_mov_b32 s62, 24576
    buffer_load_dwordx4 a[152:155], v158, s[40:43], s62 offen offset:0 sc1
    v_mfma_f32_16x16x32_bf16 v[172:175], a[16:19], a[116:119], v[172:175]
    ds_read_b64_tr_b16 a[56:57], v159 offset:6432
    s_add_u32 m0, s51, 43200
    s_mov_b32 s52, 114688
    v_mfma_f32_16x16x32_bf16 v[176:179], a[16:19], a[120:123], v[176:179]
    ds_read_b64_tr_b16 a[58:59], v159 offset:8480
    buffer_load_dwordx4 v21, s[16:19], s52 offen offset:128 lds
    s_waitcnt vmcnt(16) lgkmcnt(8)
    v_mfma_f32_16x16x32_bf16 v[24:27], a[28:31], a[0:3], v[24:27]
    ds_read_b64_tr_b16 a[4:5], v113 offset:10304
    v_mfma_f32_16x16x32_bf16 v[28:31], a[28:31], a[124:127], v[28:31]
    ds_read_b64_tr_b16 a[6:7], v113 offset:12352
    v_mfma_f32_16x16x32_bf16 v[32:35], a[32:35], a[0:3], v[32:35]
    ds_read_b64_tr_b16 a[8:9], v113 offset:14432
    v_mfma_f32_16x16x32_bf16 v[36:39], a[32:35], a[124:127], v[36:39]
    ds_read_b64_tr_b16 a[10:11], v113 offset:16480
    v_mfma_f32_16x16x32_bf16 v[40:43], a[36:39], a[0:3], v[40:43]
    ds_read_b64_tr_b16 a[12:13], v159 offset:10304
    v_mfma_f32_16x16x32_bf16 v[44:47], a[36:39], a[124:127], v[44:47]
    ds_read_b64_tr_b16 a[14:15], v159 offset:12352
    buffer_load_dwordx4 a[156:159], v158, s[40:43], s62 offen offset:1024 sc1
    v_mfma_f32_16x16x32_bf16 v[48:51], a[40:43], a[0:3], v[48:51]
    ds_read_b64_tr_b16 a[16:17], v159 offset:14432
    s_add_u32 m0, s51, 47328
    s_nop 0
    buffer_load_dwordx4 v21, s[20:23], s52 offen offset:128 lds
    v_mfma_f32_16x16x32_bf16 v[52:55], a[40:43], a[124:127], v[52:55]
    ds_read_b64_tr_b16 a[18:19], v159 offset:16480
    s_waitcnt lgkmcnt(8)
    v_mfma_f32_16x16x32_bf16 v[56:59], a[44:47], a[0:3], v[56:59]
    ds_read_b64_tr_b16 a[28:29], v113 offset:10560
    v_mfma_f32_16x16x32_bf16 v[60:63], a[44:47], a[124:127], v[60:63]
    ds_read_b64_tr_b16 a[30:31], v113 offset:12608
    v_mfma_f32_16x16x32_bf16 v[64:67], a[48:51], a[0:3], v[64:67]
    ds_read_b64_tr_b16 a[32:33], v113 offset:14688
    v_mfma_f32_16x16x32_bf16 v[68:71], a[48:51], a[124:127], v[68:71]
    ds_read_b64_tr_b16 a[34:35], v113 offset:16736
    s_add_u32 m0, s51, 130176
    s_mov_b32 s52, 229376
    v_mfma_f32_16x16x32_bf16 v[164:167], a[52:55], a[0:3], v[164:167]
    ds_read_b64_tr_b16 a[36:37], v159 offset:10560
    buffer_load_dwordx4 a[160:163], v158, s[40:43], s62 offen offset:2048 sc1
    buffer_load_dwordx4 v21, s[16:19], s52 offen offset:128 lds
    v_mfma_f32_16x16x32_bf16 v[168:171], a[52:55], a[124:127], v[168:171]
    ds_read_b64_tr_b16 a[38:39], v159 offset:12608
    v_mfma_f32_16x16x32_bf16 v[172:175], a[56:59], a[0:3], v[172:175]
    ds_read_b64_tr_b16 a[40:41], v159 offset:14688
    v_mfma_f32_16x16x32_bf16 v[176:179], a[56:59], a[124:127], v[176:179]
    ds_read_b64_tr_b16 a[42:43], v159 offset:16736
    s_waitcnt vmcnt(15) lgkmcnt(8)
    v_mfma_f32_16x16x32_bf16 v[24:27], a[4:7], a[128:131], v[24:27]
    s_barrier
    ds_read_b64_tr_b16 a[44:45], v113 offset:18560
    v_mfma_f32_16x16x32_bf16 v[28:31], a[4:7], a[132:135], v[28:31]
    ds_read_b64_tr_b16 a[46:47], v113 offset:20608
    v_mfma_f32_16x16x32_bf16 v[32:35], a[8:11], a[128:131], v[32:35]
    ds_read_b64_tr_b16 a[48:49], v113 offset:22688
    s_add_u32 m0, s51, 134304
    s_nop 0
    buffer_load_dwordx4 v21, s[20:23], s52 offen offset:128 lds
    v_mfma_f32_16x16x32_bf16 v[36:39], a[8:11], a[132:135], v[36:39]
    ds_read_b64_tr_b16 a[50:51], v113 offset:24736
    v_mfma_f32_16x16x32_bf16 v[40:43], a[12:15], a[128:131], v[40:43]
    ds_read_b64_tr_b16 a[52:53], v159 offset:18560
    buffer_load_dwordx4 a[164:167], v158, s[40:43], s62 offen offset:3072 sc1
    v_mfma_f32_16x16x32_bf16 v[44:47], a[12:15], a[132:135], v[44:47]
    ds_read_b64_tr_b16 a[54:55], v159 offset:20608
    v_mfma_f32_16x16x32_bf16 v[48:51], a[16:19], a[128:131], v[48:51]
    ds_read_b64_tr_b16 a[56:57], v159 offset:22688
    v_mfma_f32_16x16x32_bf16 v[52:55], a[16:19], a[132:135], v[52:55]
    ds_read_b64_tr_b16 a[58:59], v159 offset:24736
    s_waitcnt lgkmcnt(8)
    v_mfma_f32_16x16x32_bf16 v[56:59], a[28:31], a[128:131], v[56:59]
    ds_read_b64_tr_b16 a[4:5], v113 offset:18816
    v_mfma_f32_16x16x32_bf16 v[60:63], a[28:31], a[132:135], v[60:63]
    ds_read_b64_tr_b16 a[6:7], v113 offset:20864
    s_add_u32 m0, s51, 1920
    s_mov_b32 s52, 344064
    v_mfma_f32_16x16x32_bf16 v[64:67], a[32:35], a[128:131], v[64:67]
    ds_read_b64_tr_b16 a[8:9], v113 offset:22944
    buffer_load_dwordx4 v21, s[16:19], s52 offen offset:128 lds
    v_mfma_f32_16x16x32_bf16 v[68:71], a[32:35], a[132:135], v[68:71]
    ds_read_b64_tr_b16 a[10:11], v113 offset:24992
    s_mov_b32 s62, 28672
    buffer_load_dwordx4 a[168:171], v158, s[40:43], s62 offen offset:0 sc1
    v_mfma_f32_16x16x32_bf16 v[164:167], a[36:39], a[128:131], v[164:167]
    ds_read_b64_tr_b16 a[12:13], v159 offset:18816
    v_mfma_f32_16x16x32_bf16 v[168:171], a[36:39], a[132:135], v[168:171]
    ds_read_b64_tr_b16 a[14:15], v159 offset:20864
    v_mfma_f32_16x16x32_bf16 v[172:175], a[40:43], a[128:131], v[172:175]
    ds_read_b64_tr_b16 a[16:17], v159 offset:22944
    v_mfma_f32_16x16x32_bf16 v[176:179], a[40:43], a[132:135], v[176:179]
    ds_read_b64_tr_b16 a[18:19], v159 offset:24992
    s_add_u32 m0, s51, 6048
    s_waitcnt vmcnt(15) lgkmcnt(8)
    v_mfma_f32_16x16x32_bf16 v[24:27], a[44:47], a[136:139], v[24:27]
    ds_read_b64_tr_b16 a[28:29], v113 offset:26816
    buffer_load_dwordx4 v21, s[20:23], s52 offen offset:128 lds
    v_mfma_f32_16x16x32_bf16 v[28:31], a[44:47], a[140:143], v[28:31]
    ds_read_b64_tr_b16 a[30:31], v113 offset:28864
    v_mfma_f32_16x16x32_bf16 v[32:35], a[48:51], a[136:139], v[32:35]
    ds_read_b64_tr_b16 a[32:33], v113 offset:30944
    buffer_load_dwordx4 a[172:175], v158, s[40:43], s62 offen offset:1024 sc1
    v_mfma_f32_16x16x32_bf16 v[36:39], a[48:51], a[140:143], v[36:39]
    ds_read_b64_tr_b16 a[34:35], v113 offset:32992
    v_mfma_f32_16x16x32_bf16 v[40:43], a[52:55], a[136:139], v[40:43]
    ds_read_b64_tr_b16 a[36:37], v159 offset:26816
    v_mfma_f32_16x16x32_bf16 v[44:47], a[52:55], a[140:143], v[44:47]
    ds_read_b64_tr_b16 a[38:39], v159 offset:28864
    v_mfma_f32_16x16x32_bf16 v[48:51], a[56:59], a[136:139], v[48:51]
    ds_read_b64_tr_b16 a[40:41], v159 offset:30944
    s_add_u32 m0, s51, 84480
    s_mov_b32 s52, 917504
    v_mfma_f32_16x16x32_bf16 v[52:55], a[56:59], a[140:143], v[52:55]
    ds_read_b64_tr_b16 a[42:43], v159 offset:32992
    buffer_load_dwordx4 v14, s[16:19], s52 offen offset:128 lds
    s_waitcnt lgkmcnt(8)
    v_mfma_f32_16x16x32_bf16 v[56:59], a[4:7], a[136:139], v[56:59]
    ds_read_b64_tr_b16 a[44:45], v113 offset:27072
    v_mfma_f32_16x16x32_bf16 v[60:63], a[4:7], a[140:143], v[60:63]
    ds_read_b64_tr_b16 a[46:47], v113 offset:29120
    v_mfma_f32_16x16x32_bf16 v[64:67], a[8:11], a[136:139], v[64:67]
    ds_read_b64_tr_b16 a[48:49], v113 offset:31200
    buffer_load_dwordx4 a[176:179], v158, s[40:43], s62 offen offset:2048 sc1
    v_mfma_f32_16x16x32_bf16 v[68:71], a[8:11], a[140:143], v[68:71]
    ds_read_b64_tr_b16 a[50:51], v113 offset:33248
    v_mfma_f32_16x16x32_bf16 v[164:167], a[12:15], a[136:139], v[164:167]
    ds_read_b64_tr_b16 a[52:53], v159 offset:27072
    v_mfma_f32_16x16x32_bf16 v[168:171], a[12:15], a[140:143], v[168:171]
    ds_read_b64_tr_b16 a[54:55], v159 offset:29120
    s_add_u32 m0, s51, 88608
    s_nop 0
    buffer_load_dwordx4 v14, s[20:23], s52 offen offset:128 lds
    v_mfma_f32_16x16x32_bf16 v[172:175], a[16:19], a[136:139], v[172:175]
    ds_read_b64_tr_b16 a[56:57], v159 offset:31200
    v_mfma_f32_16x16x32_bf16 v[176:179], a[16:19], a[140:143], v[176:179]
    ds_read_b64_tr_b16 a[58:59], v159 offset:33248
    s_waitcnt vmcnt(16) lgkmcnt(8)
    v_mfma_f32_16x16x32_bf16 v[24:27], a[28:31], a[144:147], v[24:27]
    s_barrier
    ds_read_b64_tr_b16 a[4:5], v114 offset:44096
    v_mfma_f32_16x16x32_bf16 v[28:31], a[28:31], a[148:151], v[28:31]
    ds_read_b64_tr_b16 a[6:7], v114 offset:46144
    buffer_load_dwordx4 a[180:183], v158, s[40:43], s62 offen offset:3072 sc1
    v_mfma_f32_16x16x32_bf16 v[32:35], a[32:35], a[144:147], v[32:35]
    ds_read_b64_tr_b16 a[8:9], v114 offset:48224
    v_mfma_f32_16x16x32_bf16 v[36:39], a[32:35], a[148:151], v[36:39]
    ds_read_b64_tr_b16 a[10:11], v114 offset:50272
    s_add_u32 m0, s51, 10176
    s_mov_b32 s52, 1032192
    v_mfma_f32_16x16x32_bf16 v[40:43], a[36:39], a[144:147], v[40:43]
    ds_read_b64_tr_b16 a[12:13], v160 offset:44096
    buffer_load_dwordx4 v14, s[16:19], s52 offen offset:128 lds
    v_mfma_f32_16x16x32_bf16 v[44:47], a[36:39], a[148:151], v[44:47]
    ds_read_b64_tr_b16 a[14:15], v160 offset:46144
    v_mfma_f32_16x16x32_bf16 v[48:51], a[40:43], a[144:147], v[48:51]
    ds_read_b64_tr_b16 a[16:17], v160 offset:48224
    v_mfma_f32_16x16x32_bf16 v[52:55], a[40:43], a[148:151], v[52:55]
    ds_read_b64_tr_b16 a[18:19], v160 offset:50272
    s_waitcnt lgkmcnt(8)
    v_mfma_f32_16x16x32_bf16 v[56:59], a[44:47], a[144:147], v[56:59]
    ds_read_b64_tr_b16 a[28:29], v114 offset:44352
    v_mfma_f32_16x16x32_bf16 v[60:63], a[44:47], a[148:151], v[60:63]
    ds_read_b64_tr_b16 a[30:31], v114 offset:46400
    s_add_u32 m0, s51, 14304
    s_nop 0
    buffer_load_dwordx4 v14, s[20:23], s52 offen offset:128 lds
    v_mfma_f32_16x16x32_bf16 v[64:67], a[48:51], a[144:147], v[64:67]
    ds_read_b64_tr_b16 a[32:33], v114 offset:48480
    v_mfma_f32_16x16x32_bf16 v[68:71], a[48:51], a[148:151], v[68:71]
    ds_read_b64_tr_b16 a[34:35], v114 offset:50528
    v_mfma_f32_16x16x32_bf16 v[164:167], a[52:55], a[144:147], v[164:167]
    ds_read_b64_tr_b16 a[36:37], v160 offset:44352
    v_mfma_f32_16x16x32_bf16 v[168:171], a[52:55], a[148:151], v[168:171]
    ds_read_b64_tr_b16 a[38:39], v160 offset:46400
    v_mfma_f32_16x16x32_bf16 v[172:175], a[56:59], a[144:147], v[172:175]
    ds_read_b64_tr_b16 a[40:41], v160 offset:48480
    v_mfma_f32_16x16x32_bf16 v[176:179], a[56:59], a[148:151], v[176:179]
    ds_read_b64_tr_b16 a[42:43], v160 offset:50528
    s_add_u32 m0, s51, 18432
    s_waitcnt vmcnt(15) lgkmcnt(8)
    v_mfma_f32_16x16x32_bf16 v[24:27], a[4:7], a[152:155], v[24:27]
    ds_read_b64_tr_b16 a[44:45], v113 offset:51584
    s_mov_b32 s52, 1146880
    buffer_load_dwordx4 v14, s[16:19], s52 offen offset:128 lds
    v_mfma_f32_16x16x32_bf16 v[28:31], a[4:7], a[156:159], v[28:31]
    ds_read_b64_tr_b16 a[46:47], v113 offset:53632
    v_mfma_f32_16x16x32_bf16 v[32:35], a[8:11], a[152:155], v[32:35]
    ds_read_b64_tr_b16 a[48:49], v113 offset:55712
    v_mfma_f32_16x16x32_bf16 v[36:39], a[8:11], a[156:159], v[36:39]
    ds_read_b64_tr_b16 a[50:51], v113 offset:57760
    v_mfma_f32_16x16x32_bf16 v[40:43], a[12:15], a[152:155], v[40:43]
    ds_read_b64_tr_b16 a[52:53], v159 offset:51584
    v_mfma_f32_16x16x32_bf16 v[44:47], a[12:15], a[156:159], v[44:47]
    ds_read_b64_tr_b16 a[54:55], v159 offset:53632
    s_add_u32 m0, s51, 22560
    s_nop 0
    buffer_load_dwordx4 v14, s[20:23], s52 offen offset:128 lds
    v_mfma_f32_16x16x32_bf16 v[48:51], a[16:19], a[152:155], v[48:51]
    ds_read_b64_tr_b16 a[56:57], v159 offset:55712
    v_mfma_f32_16x16x32_bf16 v[52:55], a[16:19], a[156:159], v[52:55]
    ds_read_b64_tr_b16 a[58:59], v159 offset:57760
    s_waitcnt lgkmcnt(8)
    v_mfma_f32_16x16x32_bf16 v[56:59], a[28:31], a[152:155], v[56:59]
    ds_read_b64_tr_b16 a[4:5], v113 offset:51840
    v_mfma_f32_16x16x32_bf16 v[60:63], a[28:31], a[156:159], v[60:63]
    ds_read_b64_tr_b16 a[6:7], v113 offset:53888
    v_mfma_f32_16x16x32_bf16 v[64:67], a[32:35], a[152:155], v[64:67]
    ds_read_b64_tr_b16 a[8:9], v113 offset:55968
    v_mfma_f32_16x16x32_bf16 v[68:71], a[32:35], a[156:159], v[68:71]
    ds_read_b64_tr_b16 a[10:11], v113 offset:58016
    s_add_u32 m0, s51, 138432
    s_mov_b32 s52, 1261568
    v_mfma_f32_16x16x32_bf16 v[164:167], a[36:39], a[152:155], v[164:167]
    ds_read_b64_tr_b16 a[12:13], v159 offset:51840
    buffer_load_dwordx4 v14, s[16:19], s52 offen offset:128 lds
    v_mfma_f32_16x16x32_bf16 v[168:171], a[36:39], a[156:159], v[168:171]
    ds_read_b64_tr_b16 a[14:15], v159 offset:53888
    v_mfma_f32_16x16x32_bf16 v[172:175], a[40:43], a[152:155], v[172:175]
    ds_read_b64_tr_b16 a[16:17], v159 offset:55968
    v_mfma_f32_16x16x32_bf16 v[176:179], a[40:43], a[156:159], v[176:179]
    ds_read_b64_tr_b16 a[18:19], v159 offset:58016
    s_waitcnt vmcnt(13) lgkmcnt(8)
    v_mfma_f32_16x16x32_bf16 v[24:27], a[44:47], a[160:163], v[24:27]
    s_barrier
    ds_read_b64_tr_b16 a[28:29], v114 offset:52352
    v_mfma_f32_16x16x32_bf16 v[28:31], a[44:47], a[164:167], v[28:31]
    ds_read_b64_tr_b16 a[30:31], v114 offset:54400
    s_add_u32 m0, s51, 142560
    s_nop 0
    buffer_load_dwordx4 v14, s[20:23], s52 offen offset:128 lds
    v_mfma_f32_16x16x32_bf16 v[32:35], a[48:51], a[160:163], v[32:35]
    ds_read_b64_tr_b16 a[32:33], v114 offset:56480
    v_mfma_f32_16x16x32_bf16 v[36:39], a[48:51], a[164:167], v[36:39]
    ds_read_b64_tr_b16 a[34:35], v114 offset:58528
    v_mfma_f32_16x16x32_bf16 v[40:43], a[52:55], a[160:163], v[40:43]
    ds_read_b64_tr_b16 a[36:37], v160 offset:52352
    v_mfma_f32_16x16x32_bf16 v[44:47], a[52:55], a[164:167], v[44:47]
    ds_read_b64_tr_b16 a[38:39], v160 offset:54400
    v_mfma_f32_16x16x32_bf16 v[48:51], a[56:59], a[160:163], v[48:51]
    ds_read_b64_tr_b16 a[40:41], v160 offset:56480
    v_mfma_f32_16x16x32_bf16 v[52:55], a[56:59], a[164:167], v[52:55]
    ds_read_b64_tr_b16 a[42:43], v160 offset:58528
    s_add_u32 m0, s51, 26688
    s_waitcnt lgkmcnt(8)
    v_mfma_f32_16x16x32_bf16 v[56:59], a[4:7], a[160:163], v[56:59]
    ds_read_b64_tr_b16 a[44:45], v114 offset:52608
    s_mov_b32 s52, 917504
    buffer_load_dwordx4 v21, s[16:19], s52 offen offset:128 lds
    v_mfma_f32_16x16x32_bf16 v[60:63], a[4:7], a[164:167], v[60:63]
    ds_read_b64_tr_b16 a[46:47], v114 offset:54656
    v_mfma_f32_16x16x32_bf16 v[64:67], a[8:11], a[160:163], v[64:67]
    ds_read_b64_tr_b16 a[48:49], v114 offset:56736
    v_mfma_f32_16x16x32_bf16 v[68:71], a[8:11], a[164:167], v[68:71]
    ds_read_b64_tr_b16 a[50:51], v114 offset:58784
    v_mfma_f32_16x16x32_bf16 v[164:167], a[12:15], a[160:163], v[164:167]
    ds_read_b64_tr_b16 a[52:53], v160 offset:52608
    s_add_u32 m0, s51, 30816
    s_nop 0
    buffer_load_dwordx4 v21, s[20:23], s52 offen offset:128 lds
    v_mfma_f32_16x16x32_bf16 v[168:171], a[12:15], a[164:167], v[168:171]
    ds_read_b64_tr_b16 a[54:55], v160 offset:54656
    v_mfma_f32_16x16x32_bf16 v[172:175], a[16:19], a[160:163], v[172:175]
    ds_read_b64_tr_b16 a[56:57], v160 offset:56736
    v_mfma_f32_16x16x32_bf16 v[176:179], a[16:19], a[164:167], v[176:179]
    ds_read_b64_tr_b16 a[58:59], v160 offset:58784
    s_waitcnt vmcnt(12) lgkmcnt(8)
    v_mfma_f32_16x16x32_bf16 v[24:27], a[28:31], a[168:171], v[24:27]
    ds_read_b64_tr_b16 a[4:5], v114 offset:60608
    v_mfma_f32_16x16x32_bf16 v[28:31], a[28:31], a[172:175], v[28:31]
    ds_read_b64_tr_b16 a[6:7], v115 offset:1216
    v_mfma_f32_16x16x32_bf16 v[32:35], a[32:35], a[168:171], v[32:35]
    ds_read_b64_tr_b16 a[8:9], v115 offset:3296
    s_add_u32 m0, s51, 103168
    s_mov_b32 s52, 1032192
    v_mfma_f32_16x16x32_bf16 v[36:39], a[32:35], a[172:175], v[36:39]
    ds_read_b64_tr_b16 a[10:11], v115 offset:5344
    buffer_load_dwordx4 v21, s[16:19], s52 offen offset:128 lds
    v_mfma_f32_16x16x32_bf16 v[40:43], a[36:39], a[168:171], v[40:43]
    ds_read_b64_tr_b16 a[12:13], v160 offset:60608
    v_mfma_f32_16x16x32_bf16 v[44:47], a[36:39], a[172:175], v[44:47]
    ds_read_b64_tr_b16 a[14:15], v161 offset:1216
    v_mfma_f32_16x16x32_bf16 v[48:51], a[40:43], a[168:171], v[48:51]
    ds_read_b64_tr_b16 a[16:17], v161 offset:3296
    v_mfma_f32_16x16x32_bf16 v[52:55], a[40:43], a[172:175], v[52:55]
    ds_read_b64_tr_b16 a[18:19], v161 offset:5344
    s_waitcnt lgkmcnt(8)
    v_mfma_f32_16x16x32_bf16 v[56:59], a[44:47], a[168:171], v[56:59]
    ds_read_b64_tr_b16 a[28:29], v114 offset:60864
    s_add_u32 m0, s51, 107296
    s_nop 0
    buffer_load_dwordx4 v21, s[20:23], s52 offen offset:128 lds
    v_mfma_f32_16x16x32_bf16 v[60:63], a[44:47], a[172:175], v[60:63]
    ds_read_b64_tr_b16 a[30:31], v115 offset:1472
    v_mfma_f32_16x16x32_bf16 v[64:67], a[48:51], a[168:171], v[64:67]
    ds_read_b64_tr_b16 a[32:33], v115 offset:3552
    v_mfma_f32_16x16x32_bf16 v[68:71], a[48:51], a[172:175], v[68:71]
    ds_read_b64_tr_b16 a[34:35], v115 offset:5600
    v_mfma_f32_16x16x32_bf16 v[164:167], a[52:55], a[168:171], v[164:167]
    ds_read_b64_tr_b16 a[36:37], v160 offset:60864
    v_mfma_f32_16x16x32_bf16 v[168:171], a[52:55], a[172:175], v[168:171]
    ds_read_b64_tr_b16 a[38:39], v161 offset:1472
    v_mfma_f32_16x16x32_bf16 v[172:175], a[56:59], a[168:171], v[172:175]
    ds_read_b64_tr_b16 a[40:41], v161 offset:3552
    s_add_u32 m0, s51, 146688
    s_mov_b32 s52, 1146880
    v_mfma_f32_16x16x32_bf16 v[176:179], a[56:59], a[172:175], v[176:179]
    ds_read_b64_tr_b16 a[42:43], v161 offset:5600
    buffer_load_dwordx4 v21, s[16:19], s52 offen offset:128 lds
    s_waitcnt vmcnt(11) lgkmcnt(8)
    v_mfma_f32_16x16x32_bf16 v[24:27], a[4:7], a[176:179], v[24:27]
    s_barrier
    ds_read_b64_tr_b16 a[44:45], v113 offset:59840
    v_mfma_f32_16x16x32_bf16 v[28:31], a[4:7], a[180:183], v[28:31]
    ds_read_b64_tr_b16 a[46:47], v114 offset:448
    v_mfma_f32_16x16x32_bf16 v[32:35], a[8:11], a[176:179], v[32:35]
    ds_read_b64_tr_b16 a[48:49], v114 offset:2528
    v_mfma_f32_16x16x32_bf16 v[36:39], a[8:11], a[180:183], v[36:39]
    ds_read_b64_tr_b16 a[50:51], v114 offset:4576
    v_mfma_f32_16x16x32_bf16 v[40:43], a[12:15], a[176:179], v[40:43]
    ds_read_b64_tr_b16 a[52:53], v159 offset:59840
    s_add_u32 m0, s51, 150816
    s_nop 0
    buffer_load_dwordx4 v21, s[20:23], s52 offen offset:128 lds
    v_mfma_f32_16x16x32_bf16 v[44:47], a[12:15], a[180:183], v[44:47]
    ds_read_b64_tr_b16 a[54:55], v160 offset:448
    v_mfma_f32_16x16x32_bf16 v[48:51], a[16:19], a[176:179], v[48:51]
    ds_read_b64_tr_b16 a[56:57], v160 offset:2528
    v_mfma_f32_16x16x32_bf16 v[52:55], a[16:19], a[180:183], v[52:55]
    ds_read_b64_tr_b16 a[58:59], v160 offset:4576
    s_waitcnt lgkmcnt(8)
    v_mfma_f32_16x16x32_bf16 v[56:59], a[28:31], a[176:179], v[56:59]
    ds_read_b64_tr_b16 a[4:5], v113 offset:60096
    v_mfma_f32_16x16x32_bf16 v[60:63], a[28:31], a[180:183], v[60:63]
    ds_read_b64_tr_b16 a[6:7], v114 offset:704
    v_mfma_f32_16x16x32_bf16 v[64:67], a[32:35], a[176:179], v[64:67]
    ds_read_b64_tr_b16 a[8:9], v114 offset:2784
    s_add_u32 m0, s51, 51456
    s_mov_b32 s52, 1261568
    v_mfma_f32_16x16x32_bf16 v[68:71], a[32:35], a[180:183], v[68:71]
    ds_read_b64_tr_b16 a[10:11], v114 offset:4832
    buffer_load_dwordx4 v21, s[16:19], s52 offen offset:128 lds
    v_mfma_f32_16x16x32_bf16 v[164:167], a[36:39], a[176:179], v[164:167]
    ds_read_b64_tr_b16 a[12:13], v159 offset:60096
    v_mfma_f32_16x16x32_bf16 v[168:171], a[36:39], a[180:183], v[168:171]
    ds_read_b64_tr_b16 a[14:15], v160 offset:704
    v_mfma_f32_16x16x32_bf16 v[172:175], a[40:43], a[176:179], v[172:175]
    ds_read_b64_tr_b16 a[16:17], v160 offset:2784
    v_mfma_f32_16x16x32_bf16 v[176:179], a[40:43], a[180:183], v[176:179]
    ds_read_b64_tr_b16 a[18:19], v160 offset:4832
    s_waitcnt lgkmcnt(8)
    v_mfma_f32_16x16x32_bf16 v[180:183], a[44:47], a[60:63], 0
    ds_read_b64_tr_b16 a[28:29], v114 offset:6656
    s_add_u32 m0, s51, 55584
    s_nop 0
    buffer_load_dwordx4 v21, s[20:23], s52 offen offset:128 lds
    v_mfma_f32_16x16x32_bf16 v[184:187], a[44:47], a[64:67], 0
    ds_read_b64_tr_b16 a[30:31], v114 offset:8704
    v_mfma_f32_16x16x32_bf16 v[188:191], a[48:51], a[60:63], 0
    ds_read_b64_tr_b16 a[32:33], v114 offset:10784
    v_mfma_f32_16x16x32_bf16 v[192:195], a[48:51], a[64:67], 0
    ds_read_b64_tr_b16 a[34:35], v114 offset:12832
    v_mfma_f32_16x16x32_bf16 v[196:199], a[52:55], a[60:63], 0
    ds_read_b64_tr_b16 a[36:37], v160 offset:6656
    v_mfma_f32_16x16x32_bf16 v[200:203], a[52:55], a[64:67], 0
    ds_read_b64_tr_b16 a[38:39], v160 offset:8704
    s_add_u32 m0, s51, 111552
    s_xor_b32 s52, s66, 0
    v_mfma_f32_16x16x32_bf16 v[204:207], a[56:59], a[60:63], 0
    ds_read_b64_tr_b16 a[40:41], v160 offset:10784
    buffer_load_dwordx4 v13, s[24:27], s52 offen lds
    v_mfma_f32_16x16x32_bf16 v[208:211], a[56:59], a[64:67], 0
    ds_read_b64_tr_b16 a[42:43], v160 offset:12832
    s_waitcnt lgkmcnt(8)
    v_mfma_f32_16x16x32_bf16 v[212:215], a[4:7], a[60:63], 0
    ds_read_b64_tr_b16 a[44:45], v114 offset:6912
    v_mul_f32 v24, v24, v32
    v_mfma_f32_16x16x32_bf16 v[216:219], a[4:7], a[64:67], 0
    ds_read_b64_tr_b16 a[46:47], v114 offset:8960
    v_mul_f32 v25, v25, v33
    v_mfma_f32_16x16x32_bf16 v[220:223], a[8:11], a[60:63], 0
    ds_read_b64_tr_b16 a[48:49], v114 offset:11040
    s_add_u32 m0, s51, 115648
    s_xor_b32 s52, s66, 16384
    v_mfma_f32_16x16x32_bf16 v[224:227], a[8:11], a[64:67], 0
    ds_read_b64_tr_b16 a[50:51], v114 offset:13088
    buffer_load_dwordx4 v13, s[24:27], s52 offen lds
    v_mfma_f32_16x16x32_bf16 v[228:231], a[12:15], a[60:63], 0
    ds_read_b64_tr_b16 a[52:53], v160 offset:6912
    v_mul_f32 v26, v26, v34
    v_mfma_f32_16x16x32_bf16 v[232:235], a[12:15], a[64:67], 0
    ds_read_b64_tr_b16 a[54:55], v160 offset:8960
    v_mul_f32 v27, v27, v35
    v_mfma_f32_16x16x32_bf16 v[236:239], a[16:19], a[60:63], 0
    ds_read_b64_tr_b16 a[56:57], v160 offset:11040
    v_mul_f32 v28, v28, v36
    v_mfma_f32_16x16x32_bf16 v[240:243], a[16:19], a[64:67], 0
    ds_read_b64_tr_b16 a[58:59], v160 offset:13088
    s_add_u32 m0, s51, 155072
    s_waitcnt lgkmcnt(8)
    v_mfma_f32_16x16x32_bf16 v[180:183], a[28:31], a[68:71], v[180:183]
    s_barrier
    ds_read_b64_tr_b16 a[4:5], v114 offset:14912
    s_xor_b32 s52, s66, 32768
    v_mfma_f32_16x16x32_bf16 v[184:187], a[28:31], a[72:75], v[184:187]
    ds_read_b64_tr_b16 a[6:7], v114 offset:16960
    buffer_load_dwordx4 v13, s[24:27], s52 offen lds
    v_mfma_f32_16x16x32_bf16 v[188:191], a[32:35], a[68:71], v[188:191]
    ds_read_b64_tr_b16 a[8:9], v114 offset:19040
    v_mul_f32 v29, v29, v37
    v_mfma_f32_16x16x32_bf16 v[192:195], a[32:35], a[72:75], v[192:195]
    ds_read_b64_tr_b16 a[10:11], v114 offset:21088
    v_mul_f32 v30, v30, v38
    v_mfma_f32_16x16x32_bf16 v[196:199], a[36:39], a[68:71], v[196:199]
    ds_read_b64_tr_b16 a[12:13], v160 offset:14912
    s_add_u32 m0, s51, 159168
    s_xor_b32 s52, s66, 49152
    v_mfma_f32_16x16x32_bf16 v[200:203], a[36:39], a[72:75], v[200:203]
    ds_read_b64_tr_b16 a[14:15], v160 offset:16960
    buffer_load_dwordx4 v13, s[24:27], s52 offen lds
    v_mfma_f32_16x16x32_bf16 v[204:207], a[40:43], a[68:71], v[204:207]
    ds_read_b64_tr_b16 a[16:17], v160 offset:19040
    v_mul_f32 v31, v31, v39
    v_mfma_f32_16x16x32_bf16 v[208:211], a[40:43], a[72:75], v[208:211]
    ds_read_b64_tr_b16 a[18:19], v160 offset:21088
    s_waitcnt lgkmcnt(8)
    v_mfma_f32_16x16x32_bf16 v[212:215], a[44:47], a[68:71], v[212:215]
    ds_read_b64_tr_b16 a[28:29], v114 offset:15168
    v_mul_f32 v40, v40, v48
    v_mfma_f32_16x16x32_bf16 v[216:219], a[44:47], a[72:75], v[216:219]
    ds_read_b64_tr_b16 a[30:31], v114 offset:17216
    s_add_u32 m0, s51, 59840
    s_xor_b32 s52, s66, 131072
    v_mfma_f32_16x16x32_bf16 v[220:223], a[48:51], a[68:71], v[220:223]
    ds_read_b64_tr_b16 a[32:33], v114 offset:19296
    buffer_load_dwordx4 v13, s[24:27], s52 offen lds
    v_mfma_f32_16x16x32_bf16 v[224:227], a[48:51], a[72:75], v[224:227]
    ds_read_b64_tr_b16 a[34:35], v114 offset:21344
    v_mul_f32 v41, v41, v49
    v_mfma_f32_16x16x32_bf16 v[228:231], a[52:55], a[68:71], v[228:231]
    ds_read_b64_tr_b16 a[36:37], v160 offset:15168
    v_mul_f32 v42, v42, v50
    v_mfma_f32_16x16x32_bf16 v[232:235], a[52:55], a[72:75], v[232:235]
    ds_read_b64_tr_b16 a[38:39], v160 offset:17216
    v_mul_f32 v43, v43, v51
    v_mfma_f32_16x16x32_bf16 v[236:239], a[56:59], a[68:71], v[236:239]
    ds_read_b64_tr_b16 a[40:41], v160 offset:19296
    s_add_u32 m0, s51, 63936
    s_xor_b32 s52, s66, 147456
    v_mfma_f32_16x16x32_bf16 v[240:243], a[56:59], a[72:75], v[240:243]
    ds_read_b64_tr_b16 a[42:43], v160 offset:21344
    buffer_load_dwordx4 v13, s[24:27], s52 offen lds
    s_waitcnt lgkmcnt(8)
    v_mfma_f32_16x16x32_bf16 v[180:183], a[4:7], a[76:79], v[180:183]
    ds_read_b64_tr_b16 a[44:45], v114 offset:33600
    v_mul_f32 v44, v44, v52
    v_mfma_f32_16x16x32_bf16 v[184:187], a[4:7], a[80:83], v[184:187]
    ds_read_b64_tr_b16 a[46:47], v114 offset:35648
    v_mul_f32 v45, v45, v53
    v_mfma_f32_16x16x32_bf16 v[188:191], a[8:11], a[76:79], v[188:191]
    ds_read_b64_tr_b16 a[48:49], v114 offset:37728
    v_mul_f32 v46, v46, v54
    v_mfma_f32_16x16x32_bf16 v[192:195], a[8:11], a[80:83], v[192:195]
    ds_read_b64_tr_b16 a[50:51], v114 offset:39776
    s_add_u32 m0, s51, 119744
    s_xor_b32 s52, s66, 163840
    v_mfma_f32_16x16x32_bf16 v[196:199], a[12:15], a[76:79], v[196:199]
    ds_read_b64_tr_b16 a[52:53], v160 offset:33600
    buffer_load_dwordx4 v13, s[24:27], s52 offen lds
    v_mfma_f32_16x16x32_bf16 v[200:203], a[12:15], a[80:83], v[200:203]
    ds_read_b64_tr_b16 a[54:55], v160 offset:35648
    v_mul_f32 v47, v47, v55
    v_mfma_f32_16x16x32_bf16 v[204:207], a[16:19], a[76:79], v[204:207]
    ds_read_b64_tr_b16 a[56:57], v160 offset:37728
    v_cvt_pk_bf16_f32 v32, v24, v25
    v_mfma_f32_16x16x32_bf16 v[208:211], a[16:19], a[80:83], v[208:211]
    ds_read_b64_tr_b16 a[58:59], v160 offset:39776
    s_waitcnt lgkmcnt(8)
    v_mfma_f32_16x16x32_bf16 v[212:215], a[28:31], a[76:79], v[212:215]
    ds_read_b64_tr_b16 a[4:5], v114 offset:33856
    s_add_u32 m0, s51, 123840
    s_xor_b32 s52, s66, 180224
    v_mfma_f32_16x16x32_bf16 v[216:219], a[28:31], a[80:83], v[216:219]
    ds_read_b64_tr_b16 a[6:7], v114 offset:35904
    buffer_load_dwordx4 v13, s[24:27], s52 offen lds
    v_mfma_f32_16x16x32_bf16 v[220:223], a[32:35], a[76:79], v[220:223]
    ds_read_b64_tr_b16 a[8:9], v114 offset:37984
    v_cvt_pk_bf16_f32 v33, v26, v27
    v_mfma_f32_16x16x32_bf16 v[224:227], a[32:35], a[80:83], v[224:227]
    ds_read_b64_tr_b16 a[10:11], v114 offset:40032
    v_cvt_pk_bf16_f32 v34, v40, v41
    v_mfma_f32_16x16x32_bf16 v[228:231], a[36:39], a[76:79], v[228:231]
    ds_read_b64_tr_b16 a[12:13], v160 offset:33856
    v_cvt_pk_bf16_f32 v35, v42, v43
    v_mfma_f32_16x16x32_bf16 v[232:235], a[36:39], a[80:83], v[232:235]
    ds_read_b64_tr_b16 a[14:15], v160 offset:35904
    buffer_store_dwordx4 v[32:35], v16, s[36:39], s65 offen offset:0 sc1
    v_mfma_f32_16x16x32_bf16 v[236:239], a[40:43], a[76:79], v[236:239]
    ds_read_b64_tr_b16 a[16:17], v160 offset:37984
    v_cvt_pk_bf16_f32 v36, v28, v29
    v_mfma_f32_16x16x32_bf16 v[240:243], a[40:43], a[80:83], v[240:243]
    ds_read_b64_tr_b16 a[18:19], v160 offset:40032
    s_waitcnt lgkmcnt(8)
    v_mfma_f32_16x16x32_bf16 v[180:183], a[44:47], a[84:87], v[180:183]
    s_barrier
    ds_read_b64_tr_b16 a[28:29], v113 offset:35072
    s_add_u32 m0, s51, 68032
    v_mfma_f32_16x16x32_bf16 v[184:187], a[44:47], a[88:91], v[184:187]
    ds_read_b64_tr_b16 a[30:31], v113 offset:37120
    s_xor_b32 s52, s66, 262144
    buffer_load_dwordx4 v13, s[24:27], s52 offen lds
    v_mfma_f32_16x16x32_bf16 v[188:191], a[48:51], a[84:87], v[188:191]
    ds_read_b64_tr_b16 a[32:33], v113 offset:39200
    s_add_u32 m0, s51, 72128
    s_xor_b32 s52, s66, 278528
    v_mfma_f32_16x16x32_bf16 v[192:195], a[48:51], a[88:91], v[192:195]
    ds_read_b64_tr_b16 a[34:35], v113 offset:41248
    buffer_load_dwordx4 v13, s[24:27], s52 offen lds
    v_mfma_f32_16x16x32_bf16 v[196:199], a[52:55], a[84:87], v[196:199]
    ds_read_b64_tr_b16 a[36:37], v159 offset:35072
    v_cvt_pk_bf16_f32 v37, v30, v31
    v_mfma_f32_16x16x32_bf16 v[200:203], a[52:55], a[88:91], v[200:203]
    ds_read_b64_tr_b16 a[38:39], v159 offset:37120
    v_cvt_pk_bf16_f32 v38, v44, v45
    v_mfma_f32_16x16x32_bf16 v[204:207], a[56:59], a[84:87], v[204:207]
    ds_read_b64_tr_b16 a[40:41], v159 offset:39200
    v_cvt_pk_bf16_f32 v39, v46, v47
    v_mfma_f32_16x16x32_bf16 v[208:211], a[56:59], a[88:91], v[208:211]
    ds_read_b64_tr_b16 a[42:43], v159 offset:41248
    s_add_u32 m0, s51, 76224
    s_waitcnt lgkmcnt(8)
    v_mfma_f32_16x16x32_bf16 v[212:215], a[4:7], a[84:87], v[212:215]
    ds_read_b64_tr_b16 a[44:45], v113 offset:35328
    s_xor_b32 s52, s66, 294912
    buffer_load_dwordx4 v13, s[24:27], s52 offen lds
    v_mfma_f32_16x16x32_bf16 v[216:219], a[4:7], a[88:91], v[216:219]
    ds_read_b64_tr_b16 a[46:47], v113 offset:37376
    buffer_store_dwordx4 v[36:39], v16, s[36:39], s65 offen offset:1024 sc1
    v_mfma_f32_16x16x32_bf16 v[220:223], a[8:11], a[84:87], v[220:223]
    ds_read_b64_tr_b16 a[48:49], v113 offset:39456
    v_mul_f32 v56, v56, v64
    v_mfma_f32_16x16x32_bf16 v[224:227], a[8:11], a[88:91], v[224:227]
    ds_read_b64_tr_b16 a[50:51], v113 offset:41504
    v_mul_f32 v57, v57, v65
    v_mfma_f32_16x16x32_bf16 v[228:231], a[12:15], a[84:87], v[228:231]
    ds_read_b64_tr_b16 a[52:53], v159 offset:35328
    s_add_u32 m0, s51, 80320
    s_xor_b32 s52, s66, 311296
    v_mfma_f32_16x16x32_bf16 v[232:235], a[12:15], a[88:91], v[232:235]
    ds_read_b64_tr_b16 a[54:55], v159 offset:37376
    buffer_load_dwordx4 v13, s[24:27], s52 offen lds
    v_mfma_f32_16x16x32_bf16 v[236:239], a[16:19], a[84:87], v[236:239]
    ds_read_b64_tr_b16 a[56:57], v159 offset:39456
    v_mul_f32 v58, v58, v66
    v_mfma_f32_16x16x32_bf16 v[240:243], a[16:19], a[88:91], v[240:243]
    ds_read_b64_tr_b16 a[58:59], v159 offset:41504
    s_waitcnt lgkmcnt(8)
    v_mfma_f32_16x16x32_bf16 v[180:183], a[28:31], a[92:95], v[180:183]
    ds_read_b64_tr_b16 a[4:5], v113 offset:43328
    v_mul_f32 v59, v59, v67
    v_mfma_f32_16x16x32_bf16 v[184:187], a[28:31], a[96:99], v[184:187]
    ds_read_b64_tr_b16 a[6:7], v113 offset:45376
    v_mul_f32 v60, v60, v68
    v_mfma_f32_16x16x32_bf16 v[188:191], a[32:35], a[92:95], v[188:191]
    ds_read_b64_tr_b16 a[8:9], v113 offset:47456
    v_mul_f32 v61, v61, v69
    v_mfma_f32_16x16x32_bf16 v[192:195], a[32:35], a[96:99], v[192:195]
    ds_read_b64_tr_b16 a[10:11], v113 offset:49504
    v_mul_f32 v62, v62, v70
    v_mfma_f32_16x16x32_bf16 v[196:199], a[36:39], a[92:95], v[196:199]
    ds_read_b64_tr_b16 a[12:13], v159 offset:43328
    v_mul_f32 v63, v63, v71
    v_mfma_f32_16x16x32_bf16 v[200:203], a[36:39], a[96:99], v[200:203]
    ds_read_b64_tr_b16 a[14:15], v159 offset:45376
    v_mul_f32 v164, v164, v172
    v_mfma_f32_16x16x32_bf16 v[204:207], a[40:43], a[92:95], v[204:207]
    ds_read_b64_tr_b16 a[16:17], v159 offset:47456
    v_mul_f32 v165, v165, v173
    v_mfma_f32_16x16x32_bf16 v[208:211], a[40:43], a[96:99], v[208:211]
    ds_read_b64_tr_b16 a[18:19], v159 offset:49504
    s_waitcnt lgkmcnt(8)
    v_mfma_f32_16x16x32_bf16 v[212:215], a[44:47], a[92:95], v[212:215]
    ds_read_b64_tr_b16 a[28:29], v113 offset:43584
    v_mul_f32 v166, v166, v174
    v_mfma_f32_16x16x32_bf16 v[216:219], a[44:47], a[96:99], v[216:219]
    ds_read_b64_tr_b16 a[30:31], v113 offset:45632
    v_mul_f32 v167, v167, v175
    v_mfma_f32_16x16x32_bf16 v[220:223], a[48:51], a[92:95], v[220:223]
    ds_read_b64_tr_b16 a[32:33], v113 offset:47712
    v_mul_f32 v168, v168, v176
    v_mfma_f32_16x16x32_bf16 v[224:227], a[48:51], a[96:99], v[224:227]
    ds_read_b64_tr_b16 a[34:35], v113 offset:49760
    v_mul_f32 v169, v169, v177
    v_mfma_f32_16x16x32_bf16 v[228:231], a[52:55], a[92:95], v[228:231]
    ds_read_b64_tr_b16 a[36:37], v159 offset:43584
    v_mul_f32 v170, v170, v178
    v_mfma_f32_16x16x32_bf16 v[232:235], a[52:55], a[96:99], v[232:235]
    ds_read_b64_tr_b16 a[38:39], v159 offset:45632
    v_mul_f32 v171, v171, v179
    v_mfma_f32_16x16x32_bf16 v[236:239], a[56:59], a[92:95], v[236:239]
    ds_read_b64_tr_b16 a[40:41], v159 offset:47712
    v_cvt_pk_bf16_f32 v64, v56, v57
    v_mfma_f32_16x16x32_bf16 v[240:243], a[56:59], a[96:99], v[240:243]
    ds_read_b64_tr_b16 a[42:43], v159 offset:49760
    s_waitcnt lgkmcnt(8)
    v_mfma_f32_16x16x32_bf16 v[180:183], a[4:7], a[100:103], v[180:183]
    s_barrier
    ds_read_b64_tr_b16 a[44:45], v115 offset:7424
    s_add_u32 m0, s51, 35072
    v_mfma_f32_16x16x32_bf16 v[184:187], a[4:7], a[104:107], v[184:187]
    ds_read_b64_tr_b16 a[46:47], v115 offset:9472
    s_xor_b32 s52, s66, 393216
    buffer_load_dwordx4 v13, s[24:27], s52 offen lds
    v_mfma_f32_16x16x32_bf16 v[188:191], a[8:11], a[100:103], v[188:191]
    ds_read_b64_tr_b16 a[48:49], v115 offset:11552
    s_add_u32 m0, s51, 39168
    s_xor_b32 s52, s66, 409600
    v_mfma_f32_16x16x32_bf16 v[192:195], a[8:11], a[104:107], v[192:195]
    ds_read_b64_tr_b16 a[50:51], v115 offset:13600
    buffer_load_dwordx4 v13, s[24:27], s52 offen lds
    v_mfma_f32_16x16x32_bf16 v[196:199], a[12:15], a[100:103], v[196:199]
    ds_read_b64_tr_b16 a[52:53], v161 offset:7424
    v_cvt_pk_bf16_f32 v65, v58, v59
    v_mfma_f32_16x16x32_bf16 v[200:203], a[12:15], a[104:107], v[200:203]
    ds_read_b64_tr_b16 a[54:55], v161 offset:9472
    v_cvt_pk_bf16_f32 v66, v164, v165
    v_mfma_f32_16x16x32_bf16 v[204:207], a[16:19], a[100:103], v[204:207]
    ds_read_b64_tr_b16 a[56:57], v161 offset:11552
    s_add_u32 m0, s51, 92864
    s_xor_b32 s52, s66, 425984
    v_mfma_f32_16x16x32_bf16 v[208:211], a[16:19], a[104:107], v[208:211]
    ds_read_b64_tr_b16 a[58:59], v161 offset:13600
    buffer_load_dwordx4 v13, s[24:27], s52 offen lds
    s_waitcnt lgkmcnt(8)
    v_mfma_f32_16x16x32_bf16 v[212:215], a[28:31], a[100:103], v[212:215]
    ds_read_b64_tr_b16 a[4:5], v115 offset:7680
    v_cvt_pk_bf16_f32 v67, v166, v167
    v_mfma_f32_16x16x32_bf16 v[216:219], a[28:31], a[104:107], v[216:219]
    ds_read_b64_tr_b16 a[6:7], v115 offset:9728
    buffer_store_dwordx4 v[64:67], v16, s[36:39], s65 offen offset:2048 sc1
    v_mfma_f32_16x16x32_bf16 v[220:223], a[32:35], a[100:103], v[220:223]
    ds_read_b64_tr_b16 a[8:9], v115 offset:11808
    v_cvt_pk_bf16_f32 v68, v60, v61
    v_mfma_f32_16x16x32_bf16 v[224:227], a[32:35], a[104:107], v[224:227]
    ds_read_b64_tr_b16 a[10:11], v115 offset:13856
    s_add_u32 m0, s51, 96960
    s_xor_b32 s52, s66, 442368
    v_mfma_f32_16x16x32_bf16 v[228:231], a[36:39], a[100:103], v[228:231]
    ds_read_b64_tr_b16 a[12:13], v161 offset:7680
    buffer_load_dwordx4 v13, s[24:27], s52 offen lds
    v_mfma_f32_16x16x32_bf16 v[232:235], a[36:39], a[104:107], v[232:235]
    ds_read_b64_tr_b16 a[14:15], v161 offset:9728
    v_cvt_pk_bf16_f32 v69, v62, v63
    v_mfma_f32_16x16x32_bf16 v[236:239], a[40:43], a[100:103], v[236:239]
    ds_read_b64_tr_b16 a[16:17], v161 offset:11808
    v_cvt_pk_bf16_f32 v70, v168, v169
    v_mfma_f32_16x16x32_bf16 v[240:243], a[40:43], a[104:107], v[240:243]
    ds_read_b64_tr_b16 a[18:19], v161 offset:13856
    s_waitcnt lgkmcnt(8)
    v_mfma_f32_16x16x32_bf16 v[180:183], a[44:47], a[108:111], v[180:183]
    ds_read_b64_tr_b16 a[28:29], v113 offset:2048
    v_cvt_pk_bf16_f32 v71, v170, v171
    v_mfma_f32_16x16x32_bf16 v[184:187], a[44:47], a[112:115], v[184:187]
    ds_read_b64_tr_b16 a[30:31], v113 offset:4096
    buffer_store_dwordx4 v[68:71], v16, s[36:39], s65 offen offset:3072 sc1
    v_mfma_f32_16x16x32_bf16 v[188:191], a[48:51], a[108:111], v[188:191]
    ds_read_b64_tr_b16 a[32:33], v113 offset:6176
    s_add_u32 s65, s65, 4096
    v_mfma_f32_16x16x32_bf16 v[192:195], a[48:51], a[112:115], v[192:195]
    ds_read_b64_tr_b16 a[34:35], v113 offset:8224
    v_mfma_f32_16x16x32_bf16 v[196:199], a[52:55], a[108:111], v[196:199]
    ds_read_b64_tr_b16 a[36:37], v159 offset:2048
    v_mfma_f32_16x16x32_bf16 v[200:203], a[52:55], a[112:115], v[200:203]
    ds_read_b64_tr_b16 a[38:39], v159 offset:4096
    v_mfma_f32_16x16x32_bf16 v[204:207], a[56:59], a[108:111], v[204:207]
    ds_read_b64_tr_b16 a[40:41], v159 offset:6176
    v_mfma_f32_16x16x32_bf16 v[208:211], a[56:59], a[112:115], v[208:211]
    ds_read_b64_tr_b16 a[42:43], v159 offset:8224
    s_waitcnt lgkmcnt(8)
    v_mfma_f32_16x16x32_bf16 v[212:215], a[4:7], a[108:111], v[212:215]
    ds_read_b64_tr_b16 a[44:45], v113 offset:2304
    v_mfma_f32_16x16x32_bf16 v[216:219], a[4:7], a[112:115], v[216:219]
    ds_read_b64_tr_b16 a[46:47], v113 offset:4352
    v_mfma_f32_16x16x32_bf16 v[220:223], a[8:11], a[108:111], v[220:223]
    ds_read_b64_tr_b16 a[48:49], v113 offset:6432
    v_mfma_f32_16x16x32_bf16 v[224:227], a[8:11], a[112:115], v[224:227]
    ds_read_b64_tr_b16 a[50:51], v113 offset:8480
    v_mfma_f32_16x16x32_bf16 v[228:231], a[12:15], a[108:111], v[228:231]
    ds_read_b64_tr_b16 a[52:53], v159 offset:2304
    v_mfma_f32_16x16x32_bf16 v[232:235], a[12:15], a[112:115], v[232:235]
    ds_read_b64_tr_b16 a[54:55], v159 offset:4352
    v_mfma_f32_16x16x32_bf16 v[236:239], a[16:19], a[108:111], v[236:239]
    ds_read_b64_tr_b16 a[56:57], v159 offset:6432
    v_mfma_f32_16x16x32_bf16 v[240:243], a[16:19], a[112:115], v[240:243]
    ds_read_b64_tr_b16 a[58:59], v159 offset:8480
    s_waitcnt lgkmcnt(8)
    v_mfma_f32_16x16x32_bf16 v[180:183], a[28:31], a[116:119], v[180:183]
    s_waitcnt vmcnt(32)
    s_barrier
    ds_read_b64_tr_b16 a[4:5], v114 offset:23168
    v_mfma_f32_16x16x32_bf16 v[184:187], a[28:31], a[120:123], v[184:187]
    ds_read_b64_tr_b16 a[6:7], v114 offset:25216
    s_add_u32 m0, s51, 43264
    s_xor_b32 s52, s66, 524288
    v_mfma_f32_16x16x32_bf16 v[188:191], a[32:35], a[116:119], v[188:191]
    ds_read_b64_tr_b16 a[8:9], v114 offset:27296
    buffer_load_dwordx4 v13, s[24:27], s52 offen lds
    v_mfma_f32_16x16x32_bf16 v[192:195], a[32:35], a[120:123], v[192:195]
    ds_read_b64_tr_b16 a[10:11], v114 offset:29344
    s_add_u32 m0, s51, 47360
    s_xor_b32 s52, s66, 540672
    v_mfma_f32_16x16x32_bf16 v[196:199], a[36:39], a[116:119], v[196:199]
    ds_read_b64_tr_b16 a[12:13], v160 offset:23168
    buffer_load_dwordx4 v13, s[24:27], s52 offen lds
    v_mfma_f32_16x16x32_bf16 v[200:203], a[36:39], a[120:123], v[200:203]
    ds_read_b64_tr_b16 a[14:15], v160 offset:25216
    v_mfma_f32_16x16x32_bf16 v[204:207], a[40:43], a[116:119], v[204:207]
    ds_read_b64_tr_b16 a[16:17], v160 offset:27296
    s_add_u32 m0, s51, 127936
    s_xor_b32 s52, s66, 557056
    v_mfma_f32_16x16x32_bf16 v[208:211], a[40:43], a[120:123], v[208:211]
    ds_read_b64_tr_b16 a[18:19], v160 offset:29344
    buffer_load_dwordx4 v13, s[24:27], s52 offen lds
    s_waitcnt vmcnt(3)
    s_mov_b64 exec, 1
    s_cmp_eq_u32 s55, 0
    s_cbranch_scc1 Lslow_25
    buffer_store_dword v6, v23, s[36:39], 0 offen offset:1024
    s_branch Ljoin_26
Lslow_25:
    buffer_store_dword v6, v23, s[36:39], 0 offen offset:1024 sc1
Ljoin_26:
    s_mov_b64 exec, -1
    s_waitcnt lgkmcnt(8)
    v_mfma_f32_16x16x32_bf16 v[212:215], a[44:47], a[116:119], v[212:215]
    ds_read_b64_tr_b16 a[28:29], v114 offset:23424
    v_mfma_f32_16x16x32_bf16 v[216:219], a[44:47], a[120:123], v[216:219]
    ds_read_b64_tr_b16 a[30:31], v114 offset:25472
    v_mfma_f32_16x16x32_bf16 v[220:223], a[48:51], a[116:119], v[220:223]
    ds_read_b64_tr_b16 a[32:33], v114 offset:27552
    v_mfma_f32_16x16x32_bf16 v[224:227], a[48:51], a[120:123], v[224:227]
    ds_read_b64_tr_b16 a[34:35], v114 offset:29600
    s_add_u32 m0, s51, 132032
    s_xor_b32 s52, s66, 573440
    v_mfma_f32_16x16x32_bf16 v[228:231], a[52:55], a[116:119], v[228:231]
    ds_read_b64_tr_b16 a[36:37], v160 offset:23424
    buffer_load_dwordx4 v13, s[24:27], s52 offen lds
    v_mfma_f32_16x16x32_bf16 v[232:235], a[52:55], a[120:123], v[232:235]
    ds_read_b64_tr_b16 a[38:39], v160 offset:25472
    v_mfma_f32_16x16x32_bf16 v[236:239], a[56:59], a[116:119], v[236:239]
    ds_read_b64_tr_b16 a[40:41], v160 offset:27552
    v_mfma_f32_16x16x32_bf16 v[240:243], a[56:59], a[120:123], v[240:243]
    ds_read_b64_tr_b16 a[42:43], v160 offset:29600
    s_waitcnt lgkmcnt(8)
    v_mfma_f32_16x16x32_bf16 v[180:183], a[4:7], a[0:3], v[180:183]
    ds_read_b64_tr_b16 a[44:45], v113 offset:10304
    v_mfma_f32_16x16x32_bf16 v[184:187], a[4:7], a[124:127], v[184:187]
    ds_read_b64_tr_b16 a[46:47], v113 offset:12352
    v_mfma_f32_16x16x32_bf16 v[188:191], a[8:11], a[0:3], v[188:191]
    ds_read_b64_tr_b16 a[48:49], v113 offset:14432
    v_mfma_f32_16x16x32_bf16 v[192:195], a[8:11], a[124:127], v[192:195]
    ds_read_b64_tr_b16 a[50:51], v113 offset:16480
    v_mfma_f32_16x16x32_bf16 v[196:199], a[12:15], a[0:3], v[196:199]
    ds_read_b64_tr_b16 a[52:53], v159 offset:10304
    v_mfma_f32_16x16x32_bf16 v[200:203], a[12:15], a[124:127], v[200:203]
    ds_read_b64_tr_b16 a[54:55], v159 offset:12352
    v_mfma_f32_16x16x32_bf16 v[204:207], a[16:19], a[0:3], v[204:207]
    ds_read_b64_tr_b16 a[56:57], v159 offset:14432
    v_mfma_f32_16x16x32_bf16 v[208:211], a[16:19], a[124:127], v[208:211]
    ds_read_b64_tr_b16 a[58:59], v159 offset:16480
    s_waitcnt lgkmcnt(8)
    v_mfma_f32_16x16x32_bf16 v[212:215], a[28:31], a[0:3], v[212:215]
    ds_read_b64_tr_b16 a[4:5], v113 offset:10560
    v_mfma_f32_16x16x32_bf16 v[216:219], a[28:31], a[124:127], v[216:219]
    ds_read_b64_tr_b16 a[6:7], v113 offset:12608
    v_mfma_f32_16x16x32_bf16 v[220:223], a[32:35], a[0:3], v[220:223]
    ds_read_b64_tr_b16 a[8:9], v113 offset:14688
    v_mfma_f32_16x16x32_bf16 v[224:227], a[32:35], a[124:127], v[224:227]
    ds_read_b64_tr_b16 a[10:11], v113 offset:16736
    v_mfma_f32_16x16x32_bf16 v[228:231], a[36:39], a[0:3], v[228:231]
    ds_read_b64_tr_b16 a[12:13], v159 offset:10560
    v_mfma_f32_16x16x32_bf16 v[232:235], a[36:39], a[124:127], v[232:235]
    ds_read_b64_tr_b16 a[14:15], v159 offset:12608
    v_mfma_f32_16x16x32_bf16 v[236:239], a[40:43], a[0:3], v[236:239]
    ds_read_b64_tr_b16 a[16:17], v159 offset:14688
    v_mfma_f32_16x16x32_bf16 v[240:243], a[40:43], a[124:127], v[240:243]
    ds_read_b64_tr_b16 a[18:19], v159 offset:16736
    buffer_load_dword v157, v18, s[36:39], 0 offen offset:1024 sc1
    s_waitcnt lgkmcnt(8)
    v_mfma_f32_16x16x32_bf16 v[180:183], a[44:47], a[128:131], v[180:183]
    s_barrier
    ds_read_b64_tr_b16 a[28:29], v113 offset:18560
    s_add_u32 m0, s51, 2048
    v_mfma_f32_16x16x32_bf16 v[184:187], a[44:47], a[132:135], v[184:187]
    ds_read_b64_tr_b16 a[30:31], v113 offset:20608
    s_xor_b32 s52, s66, 655360
    buffer_load_dwordx4 v13, s[24:27], s52 offen lds
    v_mfma_f32_16x16x32_bf16 v[188:191], a[48:51], a[128:131], v[188:191]
    ds_read_b64_tr_b16 a[32:33], v113 offset:22688
    s_add_u32 m0, s51, 6144
    s_xor_b32 s52, s66, 671744
    v_mfma_f32_16x16x32_bf16 v[192:195], a[48:51], a[132:135], v[192:195]
    ds_read_b64_tr_b16 a[34:35], v113 offset:24736
    buffer_load_dwordx4 v13, s[24:27], s52 offen lds
    v_mfma_f32_16x16x32_bf16 v[196:199], a[52:55], a[128:131], v[196:199]
    ds_read_b64_tr_b16 a[36:37], v159 offset:18560
    v_mfma_f32_16x16x32_bf16 v[200:203], a[52:55], a[132:135], v[200:203]
    ds_read_b64_tr_b16 a[38:39], v159 offset:20608
    v_mfma_f32_16x16x32_bf16 v[204:207], a[56:59], a[128:131], v[204:207]
    ds_read_b64_tr_b16 a[40:41], v159 offset:22688
    s_add_u32 m0, s51, 84416
    s_xor_b32 s52, s66, 688128
    v_mfma_f32_16x16x32_bf16 v[208:211], a[56:59], a[132:135], v[208:211]
    ds_read_b64_tr_b16 a[42:43], v159 offset:24736
    buffer_load_dwordx4 v13, s[24:27], s52 offen lds
    s_waitcnt lgkmcnt(8)
    v_mfma_f32_16x16x32_bf16 v[212:215], a[4:7], a[128:131], v[212:215]
    ds_read_b64_tr_b16 a[44:45], v113 offset:18816
    v_mfma_f32_16x16x32_bf16 v[216:219], a[4:7], a[132:135], v[216:219]
    ds_read_b64_tr_b16 a[46:47], v113 offset:20864
    v_mfma_f32_16x16x32_bf16 v[220:223], a[8:11], a[128:131], v[220:223]
    ds_read_b64_tr_b16 a[48:49], v113 offset:22944
    v_mfma_f32_16x16x32_bf16 v[224:227], a[8:11], a[132:135], v[224:227]
    ds_read_b64_tr_b16 a[50:51], v113 offset:24992
    s_add_u32 m0, s51, 88512
    s_xor_b32 s52, s66, 704512
    v_mfma_f32_16x16x32_bf16 v[228:231], a[12:15], a[128:131], v[228:231]
    ds_read_b64_tr_b16 a[52:53], v159 offset:18816
    buffer_load_dwordx4 v13, s[24:27], s52 offen lds
    v_mfma_f32_16x16x32_bf16 v[232:235], a[12:15], a[132:135], v[232:235]
    ds_read_b64_tr_b16 a[54:55], v159 offset:20864
    v_mfma_f32_16x16x32_bf16 v[236:239], a[16:19], a[128:131], v[236:239]
    ds_read_b64_tr_b16 a[56:57], v159 offset:22944
    v_mfma_f32_16x16x32_bf16 v[240:243], a[16:19], a[132:135], v[240:243]
    ds_read_b64_tr_b16 a[58:59], v159 offset:24992
    s_waitcnt lgkmcnt(8)
    v_mfma_f32_16x16x32_bf16 v[180:183], a[28:31], a[136:139], v[180:183]
    ds_read_b64_tr_b16 a[4:5], v115 offset:15680
    v_mfma_f32_16x16x32_bf16 v[184:187], a[28:31], a[140:143], v[184:187]
    ds_read_b64_tr_b16 a[6:7], v115 offset:17728
    v_mfma_f32_16x16x32_bf16 v[188:191], a[32:35], a[136:139], v[188:191]
    ds_read_b64_tr_b16 a[8:9], v115 offset:19808
    v_mfma_f32_16x16x32_bf16 v[192:195], a[32:35], a[140:143], v[192:195]
    ds_read_b64_tr_b16 a[10:11], v115 offset:21856
    v_mfma_f32_16x16x32_bf16 v[196:199], a[36:39], a[136:139], v[196:199]
    ds_read_b64_tr_b16 a[12:13], v161 offset:15680
    v_mfma_f32_16x16x32_bf16 v[200:203], a[36:39], a[140:143], v[200:203]
    ds_read_b64_tr_b16 a[14:15], v161 offset:17728
    v_mfma_f32_16x16x32_bf16 v[204:207], a[40:43], a[136:139], v[204:207]
    ds_read_b64_tr_b16 a[16:17], v161 offset:19808
    v_mfma_f32_16x16x32_bf16 v[208:211], a[40:43], a[140:143], v[208:211]
    ds_read_b64_tr_b16 a[18:19], v161 offset:21856
    s_waitcnt vmcnt(4)
    v_cmp_ne_u32 vcc, s54, v157
    s_cbranch_vccnz Lretry_27
Lback_28:
    s_waitcnt lgkmcnt(8)
    v_mfma_f32_16x16x32_bf16 v[212:215], a[44:47], a[136:139], v[212:215]
    ds_read_b64_tr_b16 a[28:29], v115 offset:15936
    v_mfma_f32_16x16x32_bf16 v[216:219], a[44:47], a[140:143], v[216:219]
    ds_read_b64_tr_b16 a[30:31], v115 offset:17984
    v_mfma_f32_16x16x32_bf16 v[220:223], a[48:51], a[136:139], v[220:223]
    ds_read_b64_tr_b16 a[32:33], v115 offset:20064
    v_mfma_f32_16x16x32_bf16 v[224:227], a[48:51], a[140:143], v[224:227]
    ds_read_b64_tr_b16 a[34:35], v115 offset:22112
    v_mfma_f32_16x16x32_bf16 v[228:231], a[52:55], a[136:139], v[228:231]
    ds_read_b64_tr_b16 a[36:37], v161 offset:15936
    v_mfma_f32_16x16x32_bf16 v[232:235], a[52:55], a[140:143], v[232:235]
    ds_read_b64_tr_b16 a[38:39], v161 offset:17984
    v_mfma_f32_16x16x32_bf16 v[236:239], a[56:59], a[136:139], v[236:239]
    ds_read_b64_tr_b16 a[40:41], v161 offset:20064
    s_xor_b32 s62, s68, 0
    buffer_load_dwordx4 a[184:187], v156, s[36:39], s62 offen offset:0 sc1
    v_mfma_f32_16x16x32_bf16 v[240:243], a[56:59], a[140:143], v[240:243]
    ds_read_b64_tr_b16 a[42:43], v161 offset:22112
    s_waitcnt lgkmcnt(8)
    v_mfma_f32_16x16x32_bf16 v[180:183], a[4:7], a[144:147], v[180:183]
    s_barrier
    ds_read_b64_tr_b16 a[44:45], v113 offset:26816
    s_add_u32 m0, s51, 10240
    v_mfma_f32_16x16x32_bf16 v[184:187], a[4:7], a[148:151], v[184:187]
    ds_read_b64_tr_b16 a[46:47], v113 offset:28864
    s_xor_b32 s52, s67, 786432
    buffer_load_dwordx4 v13, s[24:27], s52 offen lds
    v_mfma_f32_16x16x32_bf16 v[188:191], a[8:11], a[144:147], v[188:191]
    ds_read_b64_tr_b16 a[48:49], v113 offset:30944
    s_add_u32 m0, s51, 14336
    s_xor_b32 s52, s67, 802816
    v_mfma_f32_16x16x32_bf16 v[192:195], a[8:11], a[148:151], v[192:195]
    ds_read_b64_tr_b16 a[50:51], v113 offset:32992
    buffer_load_dwordx4 v13, s[24:27], s52 offen lds
    v_mfma_f32_16x16x32_bf16 v[196:199], a[12:15], a[144:147], v[196:199]
    ds_read_b64_tr_b16 a[52:53], v159 offset:26816
    v_mfma_f32_16x16x32_bf16 v[200:203], a[12:15], a[148:151], v[200:203]
    ds_read_b64_tr_b16 a[54:55], v159 offset:28864
    s_xor_b32 s62, s68, 1024
    buffer_load_dwordx4 a[188:191], v156, s[36:39], s62 offen offset:0 sc1
    v_mfma_f32_16x16x32_bf16 v[204:207], a[16:19], a[144:147], v[204:207]
    ds_read_b64_tr_b16 a[56:57], v159 offset:30944
    v_mfma_f32_16x16x32_bf16 v[208:211], a[16:19], a[148:151], v[208:211]
    ds_read_b64_tr_b16 a[58:59], v159 offset:32992
    s_waitcnt lgkmcnt(8)
    v_mfma_f32_16x16x32_bf16 v[212:215], a[28:31], a[144:147], v[212:215]
    ds_read_b64_tr_b16 a[4:5], v113 offset:27072
    v_mfma_f32_16x16x32_bf16 v[216:219], a[28:31], a[148:151], v[216:219]
    ds_read_b64_tr_b16 a[6:7], v113 offset:29120
    v_mfma_f32_16x16x32_bf16 v[220:223], a[32:35], a[144:147], v[220:223]
    ds_read_b64_tr_b16 a[8:9], v113 offset:31200
    v_mfma_f32_16x16x32_bf16 v[224:227], a[32:35], a[148:151], v[224:227]
    ds_read_b64_tr_b16 a[10:11], v113 offset:33248
    s_xor_b32 s62, s68, 2048
    buffer_load_dwordx4 a[192:195], v156, s[36:39], s62 offen offset:0 sc1
    v_mfma_f32_16x16x32_bf16 v[228:231], a[36:39], a[144:147], v[228:231]
    ds_read_b64_tr_b16 a[12:13], v159 offset:27072
    v_mfma_f32_16x16x32_bf16 v[232:235], a[36:39], a[148:151], v[232:235]
    ds_read_b64_tr_b16 a[14:15], v159 offset:29120
    v_mfma_f32_16x16x32_bf16 v[236:239], a[40:43], a[144:147], v[236:239]
    ds_read_b64_tr_b16 a[16:17], v159 offset:31200
    v_mfma_f32_16x16x32_bf16 v[240:243], a[40:43], a[148:151], v[240:243]
    ds_read_b64_tr_b16 a[18:19], v159 offset:33248
    s_add_u32 m0, s51, 18432
    s_waitcnt lgkmcnt(8)
    v_mfma_f32_16x16x32_bf16 v[180:183], a[44:47], a[152:155], v[180:183]
    ds_read_b64_tr_b16 a[28:29], v114 offset:41856
    s_xor_b32 s52, s67, 819200
    buffer_load_dwordx4 v13, s[24:27], s52 offen lds
    v_mfma_f32_16x16x32_bf16 v[184:187], a[44:47], a[156:159], v[184:187]
    ds_read_b64_tr_b16 a[30:31], v114 offset:43904
    v_mfma_f32_16x16x32_bf16 v[188:191], a[48:51], a[152:155], v[188:191]
    ds_read_b64_tr_b16 a[32:33], v114 offset:45984
    s_xor_b32 s62, s68, 3072
    buffer_load_dwordx4 a[196:199], v156, s[36:39], s62 offen offset:0 sc1
    v_mfma_f32_16x16x32_bf16 v[192:195], a[48:51], a[156:159], v[192:195]
    ds_read_b64_tr_b16 a[34:35], v114 offset:48032
    v_mfma_f32_16x16x32_bf16 v[196:199], a[52:55], a[152:155], v[196:199]
    ds_read_b64_tr_b16 a[36:37], v160 offset:41856
    v_mfma_f32_16x16x32_bf16 v[200:203], a[52:55], a[156:159], v[200:203]
    ds_read_b64_tr_b16 a[38:39], v160 offset:43904
    v_mfma_f32_16x16x32_bf16 v[204:207], a[56:59], a[152:155], v[204:207]
    ds_read_b64_tr_b16 a[40:41], v160 offset:45984
    v_mfma_f32_16x16x32_bf16 v[208:211], a[56:59], a[156:159], v[208:211]
    ds_read_b64_tr_b16 a[42:43], v160 offset:48032
    s_waitcnt lgkmcnt(8)
    v_mfma_f32_16x16x32_bf16 v[212:215], a[4:7], a[152:155], v[212:215]
    ds_read_b64_tr_b16 a[44:45], v114 offset:42112
    v_mfma_f32_16x16x32_bf16 v[216:219], a[4:7], a[156:159], v[216:219]
    ds_read_b64_tr_b16 a[46:47], v114 offset:44160
    s_xor_b32 s62, s68, 8192
    buffer_load_dwordx4 a[200:203], v156, s[36:39], s62 offen offset:0 sc1
    v_mfma_f32_16x16x32_bf16 v[220:223], a[8:11], a[152:155], v[220:223]
    ds_read_b64_tr_b16 a[48:49], v114 offset:46240
    v_mfma_f32_16x16x32_bf16 v[224:227], a[8:11], a[156:159], v[224:227]
    ds_read_b64_tr_b16 a[50:51], v114 offset:48288
    v_mfma_f32_16x16x32_bf16 v[228:231], a[12:15], a[152:155], v[228:231]
    ds_read_b64_tr_b16 a[52:53], v160 offset:42112
    s_add_u32 m0, s51, 22528
    s_xor_b32 s52, s67, 835584
    v_mfma_f32_16x16x32_bf16 v[232:235], a[12:15], a[156:159], v[232:235]
    ds_read_b64_tr_b16 a[54:55], v160 offset:44160
    buffer_load_dwordx4 v13, s[24:27], s52 offen lds
    v_mfma_f32_16x16x32_bf16 v[236:239], a[16:19], a[152:155], v[236:239]
    ds_read_b64_tr_b16 a[56:57], v160 offset:46240
    v_mfma_f32_16x16x32_bf16 v[240:243], a[16:19], a[156:159], v[240:243]
    ds_read_b64_tr_b16 a[58:59], v160 offset:48288
    s_xor_b32 s62, s68, 9216
    buffer_load_dwordx4 a[204:207], v156, s[36:39], s62 offen offset:0 sc1
    s_waitcnt lgkmcnt(8)
    v_mfma_f32_16x16x32_bf16 v[180:183], a[28:31], a[160:163], v[180:183]
    s_barrier
    ds_read_b64_tr_b16 a[4:5], v115 offset:23936
    v_mfma_f32_16x16x32_bf16 v[184:187], a[28:31], a[164:167], v[184:187]
    ds_read_b64_tr_b16 a[6:7], v115 offset:25984
    v_mfma_f32_16x16x32_bf16 v[188:191], a[32:35], a[160:163], v[188:191]
    ds_read_b64_tr_b16 a[8:9], v115 offset:28064
    v_mfma_f32_16x16x32_bf16 v[192:195], a[32:35], a[164:167], v[192:195]
    ds_read_b64_tr_b16 a[10:11], v115 offset:30112
    v_mfma_f32_16x16x32_bf16 v[196:199], a[36:39], a[160:163], v[196:199]
    ds_read_b64_tr_b16 a[12:13], v161 offset:23936
    v_mfma_f32_16x16x32_bf16 v[200:203], a[36:39], a[164:167], v[200:203]
    ds_read_b64_tr_b16 a[14:15], v161 offset:25984
    v_mfma_f32_16x16x32_bf16 v[204:207], a[40:43], a[160:163], v[204:207]
    ds_read_b64_tr_b16 a[16:17], v161 offset:28064
    s_xor_b32 s62, s68, 10240
    buffer_load_dwordx4 a[208:211], v156, s[36:39], s62 offen offset:0 sc1
    v_mfma_f32_16x16x32_bf16 v[208:211], a[40:43], a[164:167], v[208:211]
    ds_read_b64_tr_b16 a[18:19], v161 offset:30112
    s_waitcnt lgkmcnt(8)
    v_mfma_f32_16x16x32_bf16 v[212:215], a[44:47], a[160:163], v[212:215]
    ds_read_b64_tr_b16 a[28:29], v115 offset:24192
    v_mfma_f32_16x16x32_bf16 v[216:219], a[44:47], a[164:167], v[216:219]
    ds_read_b64_tr_b16 a[30:31], v115 offset:26240
    v_mfma_f32_16x16x32_bf16 v[220:223], a[48:51], a[160:163], v[220:223]
    ds_read_b64_tr_b16 a[32:33], v115 offset:28320
    s_add_u32 m0, s51, 26624
    s_xor_b32 s52, s66, 65536
    v_mfma_f32_16x16x32_bf16 v[224:227], a[48:51], a[164:167], v[224:227]
    ds_read_b64_tr_b16 a[34:35], v115 offset:30368
    buffer_load_dwordx4 v13, s[24:27], s52 offen lds
    v_mfma_f32_16x16x32_bf16 v[228:231], a[52:55], a[160:163], v[228:231]
    ds_read_b64_tr_b16 a[36:37], v161 offset:24192
    v_mfma_f32_16x16x32_bf16 v[232:235], a[52:55], a[164:167], v[232:235]
    ds_read_b64_tr_b16 a[38:39], v161 offset:26240
    s_xor_b32 s62, s68, 11264
    buffer_load_dwordx4 a[212:215], v156, s[36:39], s62 offen offset:0 sc1
    v_mfma_f32_16x16x32_bf16 v[236:239], a[56:59], a[160:163], v[236:239]
    ds_read_b64_tr_b16 a[40:41], v161 offset:28320
    v_mfma_f32_16x16x32_bf16 v[240:243], a[56:59], a[164:167], v[240:243]
    ds_read_b64_tr_b16 a[42:43], v161 offset:30368
    s_waitcnt lgkmcnt(8)
    v_mfma_f32_16x16x32_bf16 v[180:183], a[4:7], a[168:171], v[180:183]
    ds_read_b64_tr_b16 a[44:45], v113 offset:51584
    v_mfma_f32_16x16x32_bf16 v[184:187], a[4:7], a[172:175], v[184:187]
    ds_read_b64_tr_b16 a[46:47], v113 offset:53632
    v_mfma_f32_16x16x32_bf16 v[188:191], a[8:11], a[168:171], v[188:191]
    ds_read_b64_tr_b16 a[48:49], v113 offset:55712
    v_mfma_f32_16x16x32_bf16 v[192:195], a[8:11], a[172:175], v[192:195]
    ds_read_b64_tr_b16 a[50:51], v113 offset:57760
    s_xor_b32 s62, s68, 16384
    buffer_load_dwordx4 a[216:219], v156, s[36:39], s62 offen offset:0 sc1
    v_mfma_f32_16x16x32_bf16 v[196:199], a[12:15], a[168:171], v[196:199]
    ds_read_b64_tr_b16 a[52:53], v159 offset:51584
    v_mfma_f32_16x16x32_bf16 v[200:203], a[12:15], a[172:175], v[200:203]
    ds_read_b64_tr_b16 a[54:55], v159 offset:53632
    v_mfma_f32_16x16x32_bf16 v[204:207], a[16:19], a[168:171], v[204:207]
    ds_read_b64_tr_b16 a[56:57], v159 offset:55712
    v_mfma_f32_16x16x32_bf16 v[208:211], a[16:19], a[172:175], v[208:211]
    ds_read_b64_tr_b16 a[58:59], v159 offset:57760
    s_add_u32 m0, s51, 30720
    s_waitcnt lgkmcnt(8)
    v_mfma_f32_16x16x32_bf16 v[212:215], a[28:31], a[168:171], v[212:215]
    ds_read_b64_tr_b16 a[4:5], v113 offset:51840
    s_xor_b32 s52, s66, 81920
    buffer_load_dwordx4 v13, s[24:27], s52 offen lds
    v_mfma_f32_16x16x32_bf16 v[216:219], a[28:31], a[172:175], v[216:219]
    ds_read_b64_tr_b16 a[6:7], v113 offset:53888
    v_mfma_f32_16x16x32_bf16 v[220:223], a[32:35], a[168:171], v[220:223]
    ds_read_b64_tr_b16 a[8:9], v113 offset:55968
    s_xor_b32 s62, s68, 17408
    buffer_load_dwordx4 a[220:223], v156, s[36:39], s62 offen offset:0 sc1
    v_mfma_f32_16x16x32_bf16 v[224:227], a[32:35], a[172:175], v[224:227]
    ds_read_b64_tr_b16 a[10:11], v113 offset:58016
    v_mfma_f32_16x16x32_bf16 v[228:231], a[36:39], a[168:171], v[228:231]
    ds_read_b64_tr_b16 a[12:13], v159 offset:51840
    v_mfma_f32_16x16x32_bf16 v[232:235], a[36:39], a[172:175], v[232:235]
    ds_read_b64_tr_b16 a[14:15], v159 offset:53888
    v_mfma_f32_16x16x32_bf16 v[236:239], a[40:43], a[168:171], v[236:239]
    ds_read_b64_tr_b16 a[16:17], v159 offset:55968
    v_mfma_f32_16x16x32_bf16 v[240:243], a[40:43], a[172:175], v[240:243]
    ds_read_b64_tr_b16 a[18:19], v159 offset:58016
    s_waitcnt lgkmcnt(8)
    v_mfma_f32_16x16x32_bf16 v[180:183], a[44:47], a[176:179], v[180:183]
    s_barrier
    ds_read_b64_tr_b16 a[28:29], v105 offset:50112
    v_mfma_f32_16x16x32_bf16 v[184:187], a[44:47], a[180:183], v[184:187]
    ds_read_b64_tr_b16 a[30:31], v105 offset:54208
    s_xor_b32 s62, s68, 18432
    buffer_load_dwordx4 a[224:227], v156, s[36:39], s62 offen offset:0 sc1
    v_mfma_f32_16x16x32_bf16 v[188:191], a[48:51], a[176:179], v[188:191]
    ds_read_b64_tr_b16 a[32:33], v108 offset:50112
    v_mfma_f32_16x16x32_bf16 v[192:195], a[48:51], a[180:183], v[192:195]
    ds_read_b64_tr_b16 a[34:35], v108 offset:54208
    v_mfma_f32_16x16x32_bf16 v[196:199], a[52:55], a[176:179], v[196:199]
    ds_read_b64_tr_b16 a[36:37], v105 offset:50368
    s_add_u32 m0, s51, 101056
    s_xor_b32 s52, s66, 98304
    v_mfma_f32_16x16x32_bf16 v[200:203], a[52:55], a[180:183], v[200:203]
    ds_read_b64_tr_b16 a[38:39], v105 offset:54464
    buffer_load_dwordx4 v13, s[24:27], s52 offen lds
    v_mfma_f32_16x16x32_bf16 v[204:207], a[56:59], a[176:179], v[204:207]
    ds_read_b64_tr_b16 a[40:41], v108 offset:50368
    v_mfma_f32_16x16x32_bf16 v[208:211], a[56:59], a[180:183], v[208:211]
    ds_read_b64_tr_b16 a[42:43], v108 offset:54464
    s_xor_b32 s62, s68, 19456
    buffer_load_dwordx4 a[228:231], v156, s[36:39], s62 offen offset:0 sc1
    s_waitcnt lgkmcnt(8)
    v_mfma_f32_16x16x32_bf16 v[212:215], a[4:7], a[176:179], v[212:215]
    ds_read_b64_tr_b16 a[44:45], v106 offset:32192
    v_mfma_f32_16x16x32_bf16 v[216:219], a[4:7], a[180:183], v[216:219]
    ds_read_b64_tr_b16 a[46:47], v106 offset:36288
    v_mfma_f32_16x16x32_bf16 v[220:223], a[8:11], a[176:179], v[220:223]
    ds_read_b64_tr_b16 a[48:49], v109 offset:32192
    v_mfma_f32_16x16x32_bf16 v[224:227], a[8:11], a[180:183], v[224:227]
    ds_read_b64_tr_b16 a[50:51], v109 offset:36288
    v_mfma_f32_16x16x32_bf16 v[228:231], a[12:15], a[176:179], v[228:231]
    ds_read_b64_tr_b16 a[52:53], v106 offset:32448
    v_mfma_f32_16x16x32_bf16 v[232:235], a[12:15], a[180:183], v[232:235]
    ds_read_b64_tr_b16 a[54:55], v106 offset:36544
    v_mfma_f32_16x16x32_bf16 v[236:239], a[16:19], a[176:179], v[236:239]
    ds_read_b64_tr_b16 a[56:57], v109 offset:32448
    s_xor_b32 s62, s68, 24576
    buffer_load_dwordx4 v[24:27], v156, s[36:39], s62 offen offset:0 sc1
    v_mfma_f32_16x16x32_bf16 v[240:243], a[16:19], a[180:183], v[240:243]
    ds_read_b64_tr_b16 a[58:59], v109 offset:36544
Lp4_23:
    v_mul_f32 v180, v180, v188
    v_mul_f32 v181, v181, v189
    v_mul_f32 v182, v182, v190
    v_mul_f32 v183, v183, v191
    v_mul_f32 v184, v184, v192
    v_mul_f32 v185, v185, v193
    v_mul_f32 v186, v186, v194
    v_mul_f32 v187, v187, v195
    v_mul_f32 v196, v196, v204
    v_mul_f32 v197, v197, v205
    v_mul_f32 v198, v198, v206
    v_mul_f32 v199, v199, v207
    v_mul_f32 v200, v200, v208
    v_mul_f32 v201, v201, v209
    v_mul_f32 v202, v202, v210
    v_mul_f32 v203, v203, v211
    v_cvt_pk_bf16_f32 v188, v180, v181
    v_cvt_pk_bf16_f32 v189, v182, v183
    v_cvt_pk_bf16_f32 v190, v196, v197
    v_cvt_pk_bf16_f32 v191, v198, v199
    buffer_store_dwordx4 v[188:191], v16, s[36:39], s65 offen offset:0 sc1
    v_cvt_pk_bf16_f32 v192, v184, v185
    v_cvt_pk_bf16_f32 v193, v186, v187
    v_cvt_pk_bf16_f32 v194, v200, v201
    v_cvt_pk_bf16_f32 v195, v202, v203
    buffer_store_dwordx4 v[192:195], v16, s[36:39], s65 offen offset:1024 sc1
    v_mul_f32 v212, v212, v220
    v_mul_f32 v213, v213, v221
    v_mul_f32 v214, v214, v222
    v_mul_f32 v215, v215, v223
    v_mul_f32 v216, v216, v224
    v_mul_f32 v217, v217, v225
    v_mul_f32 v218, v218, v226
    v_mul_f32 v219, v219, v227
    v_mul_f32 v228, v228, v236
    v_mul_f32 v229, v229, v237
    v_mul_f32 v230, v230, v238
    v_mul_f32 v231, v231, v239
    v_mul_f32 v232, v232, v240
    v_mul_f32 v233, v233, v241
    v_mul_f32 v234, v234, v242
    v_mul_f32 v235, v235, v243
    v_cvt_pk_bf16_f32 v220, v212, v213
    v_cvt_pk_bf16_f32 v221, v214, v215
    v_cvt_pk_bf16_f32 v222, v228, v229
    v_cvt_pk_bf16_f32 v223, v230, v231
    buffer_store_dwordx4 v[220:223], v16, s[36:39], s65 offen offset:2048 sc1
    v_cvt_pk_bf16_f32 v224, v216, v217
    v_cvt_pk_bf16_f32 v225, v218, v219
    v_cvt_pk_bf16_f32 v226, v232, v233
    v_cvt_pk_bf16_f32 v227, v234, v235
    buffer_store_dwordx4 v[224:227], v16, s[36:39], s65 offen offset:3072 sc1
    s_waitcnt vmcnt(20) lgkmcnt(8)
    v_mfma_f32_16x16x32_bf16 v[132:135], a[28:31], a[188:191], 0
    ds_read_b64_tr_b16 a[4:5], v104 offset:59840
    v_mfma_f32_16x16x32_bf16 v[136:139], a[32:35], a[188:191], 0
    ds_read_b64_tr_b16 a[6:7], v105 offset:2496
    v_mfma_f32_16x16x32_bf16 v[140:143], a[36:39], a[188:191], 0
    ds_read_b64_tr_b16 a[8:9], v107 offset:59840
    v_mfma_f32_16x16x32_bf16 v[144:147], a[40:43], a[188:191], 0
    ds_read_b64_tr_b16 a[10:11], v108 offset:2496
    s_xor_b32 s62, s68, 25600
    buffer_load_dwordx4 v[28:31], v156, s[36:39], s62 offen offset:0 sc1
    v_mfma_f32_16x16x32_bf16 v[116:119], a[28:31], a[184:187], 0
    ds_read_b64_tr_b16 a[12:13], v104 offset:60096
    s_add_u32 m0, s51, 105152
    s_xor_b32 s52, s66, 114688
    v_mfma_f32_16x16x32_bf16 v[120:123], a[32:35], a[184:187], 0
    ds_read_b64_tr_b16 a[14:15], v105 offset:2752
    buffer_load_dwordx4 v13, s[24:27], s52 offen lds
    v_mfma_f32_16x16x32_bf16 v[124:127], a[36:39], a[184:187], 0
    ds_read_b64_tr_b16 a[16:17], v107 offset:60096
    v_mfma_f32_16x16x32_bf16 v[128:131], a[40:43], a[184:187], 0
    ds_read_b64_tr_b16 a[18:19], v108 offset:2752
    s_xor_b32 s62, s68, 26624
    buffer_load_dwordx4 v[32:35], v156, s[36:39], s62 offen offset:0 sc1
    s_waitcnt vmcnt(20) lgkmcnt(8)
    v_mfma_f32_16x16x32_bf16 v[132:135], a[44:47], a[196:199], v[132:135]
    ds_read_b64_tr_b16 a[28:29], v105 offset:58304
    s_add_u32 m0, s51, 136128
    s_xor_b32 s52, s66, 196608
    v_mfma_f32_16x16x32_bf16 v[136:139], a[48:51], a[196:199], v[136:139]
    ds_read_b64_tr_b16 a[30:31], v106 offset:960
    buffer_load_dwordx4 v13, s[24:27], s52 offen lds
    v_mfma_f32_16x16x32_bf16 v[140:143], a[52:55], a[196:199], v[140:143]
    ds_read_b64_tr_b16 a[32:33], v108 offset:58304
    v_mfma_f32_16x16x32_bf16 v[144:147], a[56:59], a[196:199], v[144:147]
    ds_read_b64_tr_b16 a[34:35], v109 offset:960
    s_xor_b32 s62, s68, 27648
    buffer_load_dwordx4 v[36:39], v156, s[36:39], s62 offen offset:0 sc1
    v_mfma_f32_16x16x32_bf16 v[116:119], a[44:47], a[192:195], v[116:119]
    ds_read_b64_tr_b16 a[36:37], v105 offset:58560
    s_add_u32 m0, s51, 140224
    s_xor_b32 s52, s66, 212992
    v_mfma_f32_16x16x32_bf16 v[120:123], a[48:51], a[192:195], v[120:123]
    ds_read_b64_tr_b16 a[38:39], v106 offset:1216
    buffer_load_dwordx4 v13, s[24:27], s52 offen lds
    v_mfma_f32_16x16x32_bf16 v[124:127], a[52:55], a[192:195], v[124:127]
    ds_read_b64_tr_b16 a[40:41], v108 offset:58560
    v_mfma_f32_16x16x32_bf16 v[128:131], a[56:59], a[192:195], v[128:131]
    ds_read_b64_tr_b16 a[42:43], v109 offset:1216
    s_xor_b32 s62, s68, 32768
    buffer_load_dwordx4 v[40:43], v156, s[36:39], s62 offen offset:0 sc1
    s_waitcnt vmcnt(21) lgkmcnt(8)
    v_mfma_f32_16x16x32_bf16 v[132:135], a[4:7], a[204:207], v[132:135]
    s_barrier
    ds_read_b64_tr_b16 a[44:45], v105 offset:6592
    s_add_u32 m0, s51, 51456
    v_mfma_f32_16x16x32_bf16 v[136:139], a[8:11], a[204:207], v[136:139]
    ds_read_b64_tr_b16 a[46:47], v105 offset:10688
    s_xor_b32 s52, s66, 229376
    buffer_load_dwordx4 v13, s[24:27], s52 offen lds
    v_mfma_f32_16x16x32_bf16 v[140:143], a[12:15], a[204:207], v[140:143]
    ds_read_b64_tr_b16 a[48:49], v108 offset:6592
    v_mfma_f32_16x16x32_bf16 v[144:147], a[16:19], a[204:207], v[144:147]
    ds_read_b64_tr_b16 a[50:51], v108 offset:10688
    s_xor_b32 s62, s68, 33792
    buffer_load_dwordx4 v[44:47], v156, s[36:39], s62 offen offset:0 sc1
    v_mfma_f32_16x16x32_bf16 v[116:119], a[4:7], a[200:203], v[116:119]
    ds_read_b64_tr_b16 a[52:53], v105 offset:6848
    s_add_u32 m0, s51, 55552
    s_xor_b32 s52, s66, 245760
    v_mfma_f32_16x16x32_bf16 v[120:123], a[8:11], a[200:203], v[120:123]
    ds_read_b64_tr_b16 a[54:55], v105 offset:10944
    buffer_load_dwordx4 v13, s[24:27], s52 offen lds
    v_mfma_f32_16x16x32_bf16 v[124:127], a[12:15], a[200:203], v[124:127]
    ds_read_b64_tr_b16 a[56:57], v108 offset:6848
    v_mfma_f32_16x16x32_bf16 v[128:131], a[16:19], a[200:203], v[128:131]
    ds_read_b64_tr_b16 a[58:59], v108 offset:10944
    s_xor_b32 s62, s68, 34816
    buffer_load_dwordx4 v[48:51], v156, s[36:39], s62 offen offset:0 sc1
    s_waitcnt vmcnt(22) lgkmcnt(8)
    v_mfma_f32_16x16x32_bf16 v[132:135], a[28:31], a[212:215], v[132:135]
    ds_read_b64_tr_b16 a[4:5], v105 offset:14784
    s_add_u32 m0, s51, 59648
    s_xor_b32 s52, s66, 327680
    v_mfma_f32_16x16x32_bf16 v[136:139], a[32:35], a[212:215], v[136:139]
    ds_read_b64_tr_b16 a[6:7], v105 offset:18880
    buffer_load_dwordx4 v13, s[24:27], s52 offen lds
    v_mfma_f32_16x16x32_bf16 v[140:143], a[36:39], a[212:215], v[140:143]
    ds_read_b64_tr_b16 a[8:9], v108 offset:14784
    v_mfma_f32_16x16x32_bf16 v[144:147], a[40:43], a[212:215], v[144:147]
    ds_read_b64_tr_b16 a[10:11], v108 offset:18880
    s_xor_b32 s62, s68, 35840
    buffer_load_dwordx4 v[52:55], v156, s[36:39], s62 offen offset:0 sc1
    v_mfma_f32_16x16x32_bf16 v[116:119], a[28:31], a[208:211], v[116:119]
    ds_read_b64_tr_b16 a[12:13], v105 offset:15040
    s_add_u32 m0, s51, 63744
    s_xor_b32 s52, s66, 344064
    v_mfma_f32_16x16x32_bf16 v[120:123], a[32:35], a[208:211], v[120:123]
    ds_read_b64_tr_b16 a[14:15], v105 offset:19136
    buffer_load_dwordx4 v13, s[24:27], s52 offen lds
    v_mfma_f32_16x16x32_bf16 v[124:127], a[36:39], a[208:211], v[124:127]
    ds_read_b64_tr_b16 a[16:17], v108 offset:15040
    v_mfma_f32_16x16x32_bf16 v[128:131], a[40:43], a[208:211], v[128:131]
    ds_read_b64_tr_b16 a[18:19], v108 offset:19136
    s_xor_b32 s62, s68, 40960
    buffer_load_dwordx4 v[56:59], v156, s[36:39], s62 offen offset:0 sc1
    s_waitcnt vmcnt(23) lgkmcnt(8)
    v_mfma_f32_16x16x32_bf16 v[132:135], a[44:47], a[220:223], v[132:135]
    ds_read_b64_tr_b16 a[28:29], v104 offset:35072
    s_add_u32 m0, s51, 109248
    s_xor_b32 s52, s66, 360448
    v_mfma_f32_16x16x32_bf16 v[136:139], a[48:51], a[220:223], v[136:139]
    ds_read_b64_tr_b16 a[30:31], v104 offset:39168
    buffer_load_dwordx4 v13, s[24:27], s52 offen lds
    v_mfma_f32_16x16x32_bf16 v[140:143], a[52:55], a[220:223], v[140:143]
    ds_read_b64_tr_b16 a[32:33], v107 offset:35072
    v_mfma_f32_16x16x32_bf16 v[144:147], a[56:59], a[220:223], v[144:147]
    ds_read_b64_tr_b16 a[34:35], v107 offset:39168
    s_xor_b32 s62, s68, 41984
    buffer_load_dwordx4 v[60:63], v156, s[36:39], s62 offen offset:0 sc1
    v_mfma_f32_16x16x32_bf16 v[116:119], a[44:47], a[216:219], v[116:119]
    ds_read_b64_tr_b16 a[36:37], v104 offset:35328
    s_add_u32 m0, s51, 113344
    s_xor_b32 s52, s66, 376832
    v_mfma_f32_16x16x32_bf16 v[120:123], a[48:51], a[216:219], v[120:123]
    ds_read_b64_tr_b16 a[38:39], v104 offset:39424
    buffer_load_dwordx4 v13, s[24:27], s52 offen lds
    v_mfma_f32_16x16x32_bf16 v[124:127], a[52:55], a[216:219], v[124:127]
    ds_read_b64_tr_b16 a[40:41], v107 offset:35328
    v_mfma_f32_16x16x32_bf16 v[128:131], a[56:59], a[216:219], v[128:131]
    ds_read_b64_tr_b16 a[42:43], v107 offset:39424
    s_xor_b32 s62, s68, 43008
    buffer_load_dwordx4 v[64:67], v156, s[36:39], s62 offen offset:0 sc1
    s_waitcnt vmcnt(24) lgkmcnt(8)
    v_mfma_f32_16x16x32_bf16 v[132:135], a[4:7], a[228:231], v[132:135]
    ds_read_b64_tr_b16 a[44:45], v105 offset:31424
    s_add_u32 m0, s51, 144320
    s_xor_b32 s52, s66, 458752
    v_mfma_f32_16x16x32_bf16 v[136:139], a[8:11], a[228:231], v[136:139]
    ds_read_b64_tr_b16 a[46:47], v105 offset:35520
    buffer_load_dwordx4 v13, s[24:27], s52 offen lds
    v_mfma_f32_16x16x32_bf16 v[140:143], a[12:15], a[228:231], v[140:143]
    ds_read_b64_tr_b16 a[48:49], v108 offset:31424
    v_mfma_f32_16x16x32_bf16 v[144:147], a[16:19], a[228:231], v[144:147]
    ds_read_b64_tr_b16 a[50:51], v108 offset:35520
    s_xor_b32 s62, s68, 44032
    buffer_load_dwordx4 v[68:71], v156, s[36:39], s62 offen offset:0 sc1
    v_mfma_f32_16x16x32_bf16 v[116:119], a[4:7], a[224:227], v[116:119]
    ds_read_b64_tr_b16 a[52:53], v105 offset:31680
    s_add_u32 m0, s51, 148416
    s_xor_b32 s52, s66, 475136
    v_mfma_f32_16x16x32_bf16 v[120:123], a[8:11], a[224:227], v[120:123]
    ds_read_b64_tr_b16 a[54:55], v105 offset:35776
    buffer_load_dwordx4 v13, s[24:27], s52 offen lds
    v_mfma_f32_16x16x32_bf16 v[124:127], a[12:15], a[224:227], v[124:127]
    ds_read_b64_tr_b16 a[56:57], v108 offset:31680
    v_mfma_f32_16x16x32_bf16 v[128:131], a[16:19], a[224:227], v[128:131]
    ds_read_b64_tr_b16 a[58:59], v108 offset:35776
    s_xor_b32 s62, s69, 49152
    buffer_load_dwordx4 v[164:167], v156, s[36:39], s62 offen offset:0 sc1
    s_waitcnt vmcnt(22) lgkmcnt(8)
    v_mfma_f32_16x16x32_bf16 v[132:135], a[28:31], v[28:31], v[132:135]
    s_barrier
    ds_read_b64_tr_b16 a[4:5], v104 offset:43264
    s_add_u32 m0, s51, 34816
    v_mfma_f32_16x16x32_bf16 v[136:139], a[32:35], v[28:31], v[136:139]
    ds_read_b64_tr_b16 a[6:7], v104 offset:47360
    s_xor_b32 s52, s66, 491520
    buffer_load_dwordx4 v13, s[24:27], s52 offen lds
    v_mfma_f32_16x16x32_bf16 v[140:143], a[36:39], v[28:31], v[140:143]
    ds_read_b64_tr_b16 a[8:9], v107 offset:43264
    v_mfma_f32_16x16x32_bf16 v[144:147], a[40:43], v[28:31], v[144:147]
    ds_read_b64_tr_b16 a[10:11], v107 offset:47360
    s_xor_b32 s62, s69, 50176
    buffer_load_dwordx4 v[168:171], v156, s[36:39], s62 offen offset:0 sc1
    v_mfma_f32_16x16x32_bf16 v[116:119], a[28:31], v[24:27], v[116:119]
    ds_read_b64_tr_b16 a[12:13], v104 offset:43520
    s_add_u32 m0, s51, 38912
    s_xor_b32 s52, s66, 507904
    v_mfma_f32_16x16x32_bf16 v[120:123], a[32:35], v[24:27], v[120:123]
    ds_read_b64_tr_b16 a[14:15], v104 offset:47616
    buffer_load_dwordx4 v13, s[24:27], s52 offen lds
    v_mfma_f32_16x16x32_bf16 v[124:127], a[36:39], v[24:27], v[124:127]
    ds_read_b64_tr_b16 a[16:17], v107 offset:43520
    v_mfma_f32_16x16x32_bf16 v[128:131], a[40:43], v[24:27], v[128:131]
    ds_read_b64_tr_b16 a[18:19], v107 offset:47616
    s_xor_b32 s62, s69, 51200
    buffer_load_dwordx4 v[172:175], v156, s[36:39], s62 offen offset:0 sc1
    s_waitcnt vmcnt(22) lgkmcnt(8)
    v_mfma_f32_16x16x32_bf16 v[132:135], a[44:47], v[36:39], v[132:135]
    ds_read_b64_tr_b16 a[28:29], v106 offset:5056
    s_add_u32 m0, s51, 67840
    s_xor_b32 s52, s66, 589824
    v_mfma_f32_16x16x32_bf16 v[136:139], a[48:51], v[36:39], v[136:139]
    ds_read_b64_tr_b16 a[30:31], v106 offset:9152
    buffer_load_dwordx4 v13, s[24:27], s52 offen lds
    v_mfma_f32_16x16x32_bf16 v[140:143], a[52:55], v[36:39], v[140:143]
    ds_read_b64_tr_b16 a[32:33], v109 offset:5056
    v_mfma_f32_16x16x32_bf16 v[144:147], a[56:59], v[36:39], v[144:147]
    ds_read_b64_tr_b16 a[34:35], v109 offset:9152
    s_xor_b32 s62, s69, 52224
    buffer_load_dwordx4 v[176:179], v156, s[36:39], s62 offen offset:0 sc1
    v_mfma_f32_16x16x32_bf16 v[116:119], a[44:47], v[32:35], v[116:119]
    ds_read_b64_tr_b16 a[36:37], v106 offset:5312
    s_add_u32 m0, s51, 71936
    s_xor_b32 s52, s66, 606208
    v_mfma_f32_16x16x32_bf16 v[120:123], a[48:51], v[32:35], v[120:123]
    ds_read_b64_tr_b16 a[38:39], v106 offset:9408
    buffer_load_dwordx4 v13, s[24:27], s52 offen lds
    v_mfma_f32_16x16x32_bf16 v[124:127], a[52:55], v[32:35], v[124:127]
    ds_read_b64_tr_b16 a[40:41], v109 offset:5312
    v_mfma_f32_16x16x32_bf16 v[128:131], a[56:59], v[32:35], v[128:131]
    ds_read_b64_tr_b16 a[42:43], v109 offset:9408
    s_add_u32 m0, s51, 76032
    s_waitcnt vmcnt(21) lgkmcnt(8)
    v_mfma_f32_16x16x32_bf16 v[132:135], a[4:7], v[44:47], v[132:135]
    ds_read_b64_tr_b16 a[44:45], v104 offset:2048
    s_xor_b32 s52, s66, 622592
    buffer_load_dwordx4 v13, s[24:27], s52 offen lds
    v_mfma_f32_16x16x32_bf16 v[136:139], a[8:11], v[44:47], v[136:139]
    ds_read_b64_tr_b16 a[46:47], v104 offset:6144
    v_mfma_f32_16x16x32_bf16 v[140:143], a[12:15], v[44:47], v[140:143]
    ds_read_b64_tr_b16 a[48:49], v107 offset:2048
    v_mfma_f32_16x16x32_bf16 v[144:147], a[16:19], v[44:47], v[144:147]
    ds_read_b64_tr_b16 a[50:51], v107 offset:6144
    s_add_u32 m0, s51, 80128
    s_xor_b32 s52, s66, 638976
    v_mfma_f32_16x16x32_bf16 v[116:119], a[4:7], v[40:43], v[116:119]
    ds_read_b64_tr_b16 a[52:53], v104 offset:2304
    buffer_load_dwordx4 v13, s[24:27], s52 offen lds
    v_mfma_f32_16x16x32_bf16 v[120:123], a[8:11], v[40:43], v[120:123]
    ds_read_b64_tr_b16 a[54:55], v104 offset:6400
    v_mfma_f32_16x16x32_bf16 v[124:127], a[12:15], v[40:43], v[124:127]
    ds_read_b64_tr_b16 a[56:57], v107 offset:2304
    v_mfma_f32_16x16x32_bf16 v[128:131], a[16:19], v[40:43], v[128:131]
    ds_read_b64_tr_b16 a[58:59], v107 offset:6400
    s_add_u32 m0, s51, 117440
    s_waitcnt vmcnt(19) lgkmcnt(8)
    v_mfma_f32_16x16x32_bf16 v[132:135], a[28:31], v[52:55], v[132:135]
    ds_read_b64_tr_b16 a[4:5], v105 offset:22976
    s_xor_b32 s52, s66, 720896
    buffer_load_dwordx4 v13, s[24:27], s52 offen lds
    v_mfma_f32_16x16x32_bf16 v[136:139], a[32:35], v[52:55], v[136:139]
    ds_read_b64_tr_b16 a[6:7], v105 offset:27072
    v_mfma_f32_16x16x32_bf16 v[140:143], a[36:39], v[52:55], v[140:143]
    ds_read_b64_tr_b16 a[8:9], v108 offset:22976
    v_mfma_f32_16x16x32_bf16 v[144:147], a[40:43], v[52:55], v[144:147]
    ds_read_b64_tr_b16 a[10:11], v108 offset:27072
    s_add_u32 m0, s51, 121536
    s_xor_b32 s52, s66, 737280
    v_mfma_f32_16x16x32_bf16 v[116:119], a[28:31], v[48:51], v[116:119]
    ds_read_b64_tr_b16 a[12:13], v105 offset:23232
    buffer_load_dwordx4 v13, s[24:27], s52 offen lds
    v_mfma_f32_16x16x32_bf16 v[120:123], a[32:35], v[48:51], v[120:123]
    ds_read_b64_tr_b16 a[14:15], v105 offset:27328
    v_mfma_f32_16x16x32_bf16 v[124:127], a[36:39], v[48:51], v[124:127]
    ds_read_b64_tr_b16 a[16:17], v108 offset:23232
    v_mfma_f32_16x16x32_bf16 v[128:131], a[40:43], v[48:51], v[128:131]
    ds_read_b64_tr_b16 a[18:19], v108 offset:27328
    s_add_u32 m0, s51, 152512
    s_mov_b64 exec, 1
    s_cmp_eq_u32 s55, 0
    s_cbranch_scc1 Lslow_29
    buffer_store_dword v6, v23, s[36:39], 0 offen offset:1536
    s_branch Ljoin_30
Lslow_29:
    buffer_store_dword v6, v23, s[36:39], 0 offen offset:1536 sc1
Ljoin_30:
    s_mov_b64 exec, -1
    s_waitcnt vmcnt(18) lgkmcnt(8)
    v_mfma_f32_16x16x32_bf16 v[132:135], a[44:47], v[60:63], v[132:135]
    s_barrier
    ds_read_b64_tr_b16 a[28:29], v104 offset:10240
    s_xor_b32 s52, s66, 753664
    v_mfma_f32_16x16x32_bf16 v[136:139], a[48:51], v[60:63], v[136:139]
    ds_read_b64_tr_b16 a[30:31], v104 offset:14336
    buffer_load_dwordx4 v13, s[24:27], s52 offen lds
    v_mfma_f32_16x16x32_bf16 v[140:143], a[52:55], v[60:63], v[140:143]
    ds_read_b64_tr_b16 a[32:33], v107 offset:10240
    v_mfma_f32_16x16x32_bf16 v[144:147], a[56:59], v[60:63], v[144:147]
    ds_read_b64_tr_b16 a[34:35], v107 offset:14336
    s_add_u32 m0, s51, 156608
    s_xor_b32 s52, s66, 770048
    v_mfma_f32_16x16x32_bf16 v[116:119], a[44:47], v[56:59], v[116:119]
    ds_read_b64_tr_b16 a[36:37], v104 offset:10496
    buffer_load_dwordx4 v13, s[24:27], s52 offen lds
    v_mfma_f32_16x16x32_bf16 v[120:123], a[48:51], v[56:59], v[120:123]
    ds_read_b64_tr_b16 a[38:39], v104 offset:14592
    v_mfma_f32_16x16x32_bf16 v[124:127], a[52:55], v[56:59], v[124:127]
    ds_read_b64_tr_b16 a[40:41], v107 offset:10496
    v_mfma_f32_16x16x32_bf16 v[128:131], a[56:59], v[56:59], v[128:131]
    ds_read_b64_tr_b16 a[42:43], v107 offset:14592
    s_add_u32 m0, s51, 2048
    s_waitcnt vmcnt(16) lgkmcnt(8)
    v_mfma_f32_16x16x32_bf16 v[132:135], a[4:7], v[68:71], v[132:135]
    ds_read_b64_tr_b16 a[44:45], v104 offset:18432
    s_xor_b32 s52, s67, 851968
    buffer_load_dwordx4 v13, s[24:27], s52 offen lds
    v_mfma_f32_16x16x32_bf16 v[136:139], a[8:11], v[68:71], v[136:139]
    ds_read_b64_tr_b16 a[46:47], v104 offset:22528
    v_mfma_f32_16x16x32_bf16 v[140:143], a[12:15], v[68:71], v[140:143]
    ds_read_b64_tr_b16 a[48:49], v107 offset:18432
    v_mfma_f32_16x16x32_bf16 v[144:147], a[16:19], v[68:71], v[144:147]
    ds_read_b64_tr_b16 a[50:51], v107 offset:22528
    s_add_u32 m0, s51, 6144
    s_xor_b32 s52, s67, 868352
    v_mfma_f32_16x16x32_bf16 v[116:119], a[4:7], v[64:67], v[116:119]
    ds_read_b64_tr_b16 a[52:53], v104 offset:18688
    buffer_load_dwordx4 v13, s[24:27], s52 offen lds
    v_mfma_f32_16x16x32_bf16 v[120:123], a[8:11], v[64:67], v[120:123]
    ds_read_b64_tr_b16 a[54:55], v104 offset:22784
    v_mfma_f32_16x16x32_bf16 v[124:127], a[12:15], v[64:67], v[124:127]
    ds_read_b64_tr_b16 a[56:57], v107 offset:18688
    v_mfma_f32_16x16x32_bf16 v[128:131], a[16:19], v[64:67], v[128:131]
    ds_read_b64_tr_b16 a[58:59], v107 offset:22784
    s_add_u32 m0, s51, 43008
    buffer_load_dword v157, v18, s[36:39], 0 offen offset:1536 sc1
    s_waitcnt vmcnt(15) lgkmcnt(8)
    v_mfma_f32_16x16x32_bf16 v[132:135], a[28:31], v[168:171], v[132:135]
    ds_read_b64_tr_b16 a[4:5], v104 offset:26624
    s_xor_b32 s52, s67, 884736
    buffer_load_dwordx4 v13, s[24:27], s52 offen lds
    v_mfma_f32_16x16x32_bf16 v[136:139], a[32:35], v[168:171], v[136:139]
    ds_read_b64_tr_b16 a[6:7], v104 offset:30720
    v_mfma_f32_16x16x32_bf16 v[140:143], a[36:39], v[168:171], v[140:143]
    ds_read_b64_tr_b16 a[8:9], v107 offset:26624
    v_mfma_f32_16x16x32_bf16 v[144:147], a[40:43], v[168:171], v[144:147]
    ds_read_b64_tr_b16 a[10:11], v107 offset:30720
    s_add_u32 m0, s51, 47104
    s_xor_b32 s52, s67, 901120
    v_mfma_f32_16x16x32_bf16 v[116:119], a[28:31], v[164:167], v[116:119]
    ds_read_b64_tr_b16 a[12:13], v104 offset:26880
    buffer_load_dwordx4 v13, s[24:27], s52 offen lds
    v_mfma_f32_16x16x32_bf16 v[120:123], a[32:35], v[164:167], v[120:123]
    ds_read_b64_tr_b16 a[14:15], v104 offset:30976
    v_mfma_f32_16x16x32_bf16 v[124:127], a[36:39], v[164:167], v[124:127]
    ds_read_b64_tr_b16 a[16:17], v107 offset:26880
    v_mfma_f32_16x16x32_bf16 v[128:131], a[40:43], v[164:167], v[128:131]
    ds_read_b64_tr_b16 a[18:19], v107 offset:30976
    s_waitcnt vmcnt(13) lgkmcnt(8)
    v_mfma_f32_16x16x32_bf16 v[132:135], a[44:47], v[176:179], v[132:135]
    ds_read_b64_tr_b16 a[28:29], v105 offset:39616
    v_mfma_f32_16x16x32_bf16 v[136:139], a[48:51], v[176:179], v[136:139]
    ds_read_b64_tr_b16 a[30:31], v105 offset:43712
    v_mfma_f32_16x16x32_bf16 v[140:143], a[52:55], v[176:179], v[140:143]
    ds_read_b64_tr_b16 a[32:33], v108 offset:39616
    v_mfma_f32_16x16x32_bf16 v[144:147], a[56:59], v[176:179], v[144:147]
    ds_read_b64_tr_b16 a[34:35], v108 offset:43712
    v_mfma_f32_16x16x32_bf16 v[116:119], a[44:47], v[172:175], v[116:119]
    ds_read_b64_tr_b16 a[36:37], v105 offset:39872
    v_mfma_f32_16x16x32_bf16 v[120:123], a[48:51], v[172:175], v[120:123]
    ds_read_b64_tr_b16 a[38:39], v105 offset:43968
    v_mfma_f32_16x16x32_bf16 v[124:127], a[52:55], v[172:175], v[124:127]
    ds_read_b64_tr_b16 a[40:41], v108 offset:39872
    v_mfma_f32_16x16x32_bf16 v[128:131], a[56:59], v[172:175], v[128:131]
    ds_read_b64_tr_b16 a[42:43], v108 offset:43968
    s_waitcnt vmcnt(2)
    v_cmp_ne_u32 vcc, s54, v157
    s_cbranch_vccnz Lretry_31
Lback_32:
    s_xor_b32 s62, s68, 4096
    buffer_load_dwordx4 a[60:63], v156, s[36:39], s62 offen offset:0 sc1
    s_xor_b32 s62, s68, 5120
    buffer_load_dwordx4 a[64:67], v156, s[36:39], s62 offen offset:0 sc1
    s_xor_b32 s62, s68, 6144
    buffer_load_dwordx4 a[68:71], v156, s[36:39], s62 offen offset:0 sc1
    s_xor_b32 s62, s68, 7168
    buffer_load_dwordx4 a[72:75], v156, s[36:39], s62 offen offset:0 sc1
    s_xor_b32 s62, s68, 12288
    buffer_load_dwordx4 a[76:79], v156, s[36:39], s62 offen offset:0 sc1
    s_xor_b32 s62, s68, 13312
    buffer_load_dwordx4 a[80:83], v156, s[36:39], s62 offen offset:0 sc1
    s_xor_b32 s62, s68, 14336
    buffer_load_dwordx4 a[84:87], v156, s[36:39], s62 offen offset:0 sc1
    s_xor_b32 s62, s68, 15360
    buffer_load_dwordx4 a[88:91], v156, s[36:39], s62 offen offset:0 sc1
    s_xor_b32 s62, s68, 20480
    buffer_load_dwordx4 a[92:95], v156, s[36:39], s62 offen offset:0 sc1
    s_xor_b32 s62, s68, 21504
    buffer_load_dwordx4 a[96:99], v156, s[36:39], s62 offen offset:0 sc1
    s_xor_b32 s62, s68, 22528
    buffer_load_dwordx4 a[100:103], v156, s[36:39], s62 offen offset:0 sc1
    s_xor_b32 s62, s68, 23552
    buffer_load_dwordx4 a[104:107], v156, s[36:39], s62 offen offset:0 sc1
    s_waitcnt vmcnt(10) lgkmcnt(8)
    v_mfma_f32_16x16x32_bf16 v[132:135], a[4:7], a[64:67], v[132:135]
    s_barrier
    ds_read_b64_tr_b16 a[44:45], v106 offset:13248
    v_mfma_f32_16x16x32_bf16 v[136:139], a[8:11], a[64:67], v[136:139]
    ds_read_b64_tr_b16 a[46:47], v106 offset:17344
    v_mfma_f32_16x16x32_bf16 v[140:143], a[12:15], a[64:67], v[140:143]
    ds_read_b64_tr_b16 a[48:49], v109 offset:13248
    v_mfma_f32_16x16x32_bf16 v[144:147], a[16:19], a[64:67], v[144:147]
    ds_read_b64_tr_b16 a[50:51], v109 offset:17344
    s_xor_b32 s62, s68, 28672
    buffer_load_dwordx4 a[108:111], v156, s[36:39], s62 offen offset:0 sc1
    v_mfma_f32_16x16x32_bf16 v[116:119], a[4:7], a[60:63], v[116:119]
    ds_read_b64_tr_b16 a[52:53], v106 offset:13504
    v_mfma_f32_16x16x32_bf16 v[120:123], a[8:11], a[60:63], v[120:123]
    ds_read_b64_tr_b16 a[54:55], v106 offset:17600
    v_mfma_f32_16x16x32_bf16 v[124:127], a[12:15], a[60:63], v[124:127]
    ds_read_b64_tr_b16 a[56:57], v109 offset:13504
    v_mfma_f32_16x16x32_bf16 v[128:131], a[16:19], a[60:63], v[128:131]
    ds_read_b64_tr_b16 a[58:59], v109 offset:17600
    s_xor_b32 s62, s68, 29696
    buffer_load_dwordx4 a[112:115], v156, s[36:39], s62 offen offset:0 sc1
    s_waitcnt vmcnt(10) lgkmcnt(8)
    v_mfma_f32_16x16x32_bf16 v[132:135], a[28:31], a[72:75], v[132:135]
    ds_read_b64_tr_b16 a[4:5], v104 offset:51456
    v_mfma_f32_16x16x32_bf16 v[136:139], a[32:35], a[72:75], v[136:139]
    ds_read_b64_tr_b16 a[6:7], v104 offset:55552
    v_mfma_f32_16x16x32_bf16 v[140:143], a[36:39], a[72:75], v[140:143]
    ds_read_b64_tr_b16 a[8:9], v107 offset:51456
    v_mfma_f32_16x16x32_bf16 v[144:147], a[40:43], a[72:75], v[144:147]
    ds_read_b64_tr_b16 a[10:11], v107 offset:55552
    s_xor_b32 s62, s68, 30720
    buffer_load_dwordx4 a[116:119], v156, s[36:39], s62 offen offset:0 sc1
    v_mfma_f32_16x16x32_bf16 v[116:119], a[28:31], a[68:71], v[116:119]
    ds_read_b64_tr_b16 a[12:13], v104 offset:51712
    v_mfma_f32_16x16x32_bf16 v[120:123], a[32:35], a[68:71], v[120:123]
    ds_read_b64_tr_b16 a[14:15], v104 offset:55808
    v_mfma_f32_16x16x32_bf16 v[124:127], a[36:39], a[68:71], v[124:127]
    ds_read_b64_tr_b16 a[16:17], v107 offset:51712
    v_mfma_f32_16x16x32_bf16 v[128:131], a[40:43], a[68:71], v[128:131]
    ds_read_b64_tr_b16 a[18:19], v107 offset:55808
    s_xor_b32 s62, s68, 31744
    buffer_load_dwordx4 a[120:123], v156, s[36:39], s62 offen offset:0 sc1
    s_waitcnt vmcnt(10) lgkmcnt(8)
    v_mfma_f32_16x16x32_bf16 v[132:135], a[44:47], a[80:83], v[132:135]
    ds_read_b64_tr_b16 a[28:29], v104 offset:59648
    v_mfma_f32_16x16x32_bf16 v[136:139], a[48:51], a[80:83], v[136:139]
    ds_read_b64_tr_b16 a[30:31], v105 offset:2304
    v_mfma_f32_16x16x32_bf16 v[140:143], a[52:55], a[80:83], v[140:143]
    ds_read_b64_tr_b16 a[32:33], v107 offset:59648
    v_mfma_f32_16x16x32_bf16 v[144:147], a[56:59], a[80:83], v[144:147]
    ds_read_b64_tr_b16 a[34:35], v108 offset:2304
    s_xor_b32 s62, s68, 36864
    buffer_load_dwordx4 a[0:3], v156, s[36:39], s62 offen offset:0 sc1
    v_mfma_f32_16x16x32_bf16 v[116:119], a[44:47], a[76:79], v[116:119]
    ds_read_b64_tr_b16 a[36:37], v104 offset:59904
    v_mfma_f32_16x16x32_bf16 v[120:123], a[48:51], a[76:79], v[120:123]
    ds_read_b64_tr_b16 a[38:39], v105 offset:2560
    v_mfma_f32_16x16x32_bf16 v[124:127], a[52:55], a[76:79], v[124:127]
    ds_read_b64_tr_b16 a[40:41], v107 offset:59904
    v_mfma_f32_16x16x32_bf16 v[128:131], a[56:59], a[76:79], v[128:131]
    ds_read_b64_tr_b16 a[42:43], v108 offset:2560
    s_xor_b32 s62, s68, 37888
    buffer_load_dwordx4 a[124:127], v156, s[36:39], s62 offen offset:0 sc1
    s_waitcnt vmcnt(10) lgkmcnt(8)
    v_mfma_f32_16x16x32_bf16 v[132:135], a[4:7], a[88:91], v[132:135]
    ds_read_b64_tr_b16 a[44:45], v105 offset:47808
    v_mfma_f32_16x16x32_bf16 v[136:139], a[8:11], a[88:91], v[136:139]
    ds_read_b64_tr_b16 a[46:47], v105 offset:51904
    v_mfma_f32_16x16x32_bf16 v[140:143], a[12:15], a[88:91], v[140:143]
    ds_read_b64_tr_b16 a[48:49], v108 offset:47808
    v_mfma_f32_16x16x32_bf16 v[144:147], a[16:19], a[88:91], v[144:147]
    ds_read_b64_tr_b16 a[50:51], v108 offset:51904
    s_xor_b32 s62, s68, 38912
    buffer_load_dwordx4 a[128:131], v156, s[36:39], s62 offen offset:0 sc1
    v_mfma_f32_16x16x32_bf16 v[116:119], a[4:7], a[84:87], v[116:119]
    ds_read_b64_tr_b16 a[52:53], v105 offset:48064
    v_mfma_f32_16x16x32_bf16 v[120:123], a[8:11], a[84:87], v[120:123]
    ds_read_b64_tr_b16 a[54:55], v105 offset:52160
    v_mfma_f32_16x16x32_bf16 v[124:127], a[12:15], a[84:87], v[124:127]
    ds_read_b64_tr_b16 a[56:57], v108 offset:48064
    v_mfma_f32_16x16x32_bf16 v[128:131], a[16:19], a[84:87], v[128:131]
    ds_read_b64_tr_b16 a[58:59], v108 offset:52160
    s_xor_b32 s62, s68, 39936
    buffer_load_dwordx4 a[132:135], v156, s[36:39], s62 offen offset:0 sc1
    s_waitcnt vmcnt(10) lgkmcnt(8)
    v_mfma_f32_16x16x32_bf16 v[132:135], a[28:31], a[96:99], v[132:135]
    s_barrier
    ds_read_b64_tr_b16 a[4:5], v106 offset:21440
    v_mfma_f32_16x16x32_bf16 v[136:139], a[32:35], a[96:99], v[136:139]
    ds_read_b64_tr_b16 a[6:7], v106 offset:25536
    v_mfma_f32_16x16x32_bf16 v[140:143], a[36:39], a[96:99], v[140:143]
    ds_read_b64_tr_b16 a[8:9], v109 offset:21440
    v_mfma_f32_16x16x32_bf16 v[144:147], a[40:43], a[96:99], v[144:147]
    ds_read_b64_tr_b16 a[10:11], v109 offset:25536
    s_xor_b32 s62, s68, 45056
    buffer_load_dwordx4 a[136:139], v156, s[36:39], s62 offen offset:0 sc1
    v_mfma_f32_16x16x32_bf16 v[116:119], a[28:31], a[92:95], v[116:119]
    ds_read_b64_tr_b16 a[12:13], v106 offset:21696
    v_mfma_f32_16x16x32_bf16 v[120:123], a[32:35], a[92:95], v[120:123]
    ds_read_b64_tr_b16 a[14:15], v106 offset:25792
    v_mfma_f32_16x16x32_bf16 v[124:127], a[36:39], a[92:95], v[124:127]
    ds_read_b64_tr_b16 a[16:17], v109 offset:21696
    v_mfma_f32_16x16x32_bf16 v[128:131], a[40:43], a[92:95], v[128:131]
    ds_read_b64_tr_b16 a[18:19], v109 offset:25792
    s_xor_b32 s62, s68, 46080
    buffer_load_dwordx4 a[140:143], v156, s[36:39], s62 offen offset:0 sc1
    s_waitcnt vmcnt(10) lgkmcnt(8)
    v_mfma_f32_16x16x32_bf16 v[132:135], a[44:47], a[104:107], v[132:135]
    ds_read_b64_tr_b16 a[28:29], v104 offset:34816
    v_mfma_f32_16x16x32_bf16 v[136:139], a[48:51], a[104:107], v[136:139]
    ds_read_b64_tr_b16 a[30:31], v104 offset:38912
    v_mfma_f32_16x16x32_bf16 v[140:143], a[52:55], a[104:107], v[140:143]
    ds_read_b64_tr_b16 a[32:33], v107 offset:34816
    v_mfma_f32_16x16x32_bf16 v[144:147], a[56:59], a[104:107], v[144:147]
    ds_read_b64_tr_b16 a[34:35], v107 offset:38912
    s_xor_b32 s62, s68, 47104
    buffer_load_dwordx4 a[144:147], v156, s[36:39], s62 offen offset:0 sc1
    v_mfma_f32_16x16x32_bf16 v[116:119], a[44:47], a[100:103], v[116:119]
    ds_read_b64_tr_b16 a[36:37], v104 offset:35072
    v_mfma_f32_16x16x32_bf16 v[120:123], a[48:51], a[100:103], v[120:123]
    ds_read_b64_tr_b16 a[38:39], v104 offset:39168
    v_mfma_f32_16x16x32_bf16 v[124:127], a[52:55], a[100:103], v[124:127]
    ds_read_b64_tr_b16 a[40:41], v107 offset:35072
    v_mfma_f32_16x16x32_bf16 v[128:131], a[56:59], a[100:103], v[128:131]
    ds_read_b64_tr_b16 a[42:43], v107 offset:39168
    s_xor_b32 s62, s68, 48128
    buffer_load_dwordx4 a[148:151], v156, s[36:39], s62 offen offset:0 sc1
    s_waitcnt vmcnt(10) lgkmcnt(8)
    v_mfma_f32_16x16x32_bf16 v[132:135], a[4:7], a[112:115], v[132:135]
    ds_read_b64_tr_b16 a[44:45], v105 offset:6400
    v_mfma_f32_16x16x32_bf16 v[136:139], a[8:11], a[112:115], v[136:139]
    ds_read_b64_tr_b16 a[46:47], v105 offset:10496
    v_mfma_f32_16x16x32_bf16 v[140:143], a[12:15], a[112:115], v[140:143]
    ds_read_b64_tr_b16 a[48:49], v108 offset:6400
    v_mfma_f32_16x16x32_bf16 v[144:147], a[16:19], a[112:115], v[144:147]
    ds_read_b64_tr_b16 a[50:51], v108 offset:10496
    s_xor_b32 s62, s69, 53248
    buffer_load_dwordx4 a[152:155], v156, s[36:39], s62 offen offset:0 sc1
    v_mfma_f32_16x16x32_bf16 v[116:119], a[4:7], a[108:111], v[116:119]
    ds_read_b64_tr_b16 a[52:53], v105 offset:6656
    v_mfma_f32_16x16x32_bf16 v[120:123], a[8:11], a[108:111], v[120:123]
    ds_read_b64_tr_b16 a[54:55], v105 offset:10752
    v_mfma_f32_16x16x32_bf16 v[124:127], a[12:15], a[108:111], v[124:127]
    ds_read_b64_tr_b16 a[56:57], v108 offset:6656
    v_mfma_f32_16x16x32_bf16 v[128:131], a[16:19], a[108:111], v[128:131]
    ds_read_b64_tr_b16 a[58:59], v108 offset:10752
    s_xor_b32 s62, s69, 54272
    buffer_load_dwordx4 a[156:159], v156, s[36:39], s62 offen offset:0 sc1
    s_waitcnt vmcnt(10) lgkmcnt(8)
    v_mfma_f32_16x16x32_bf16 v[132:135], a[28:31], a[120:123], v[132:135]
    ds_read_b64_tr_b16 a[4:5], v105 offset:14592
    v_mfma_f32_16x16x32_bf16 v[136:139], a[32:35], a[120:123], v[136:139]
    ds_read_b64_tr_b16 a[6:7], v105 offset:18688
    v_mfma_f32_16x16x32_bf16 v[140:143], a[36:39], a[120:123], v[140:143]
    ds_read_b64_tr_b16 a[8:9], v108 offset:14592
    v_mfma_f32_16x16x32_bf16 v[144:147], a[40:43], a[120:123], v[144:147]
    ds_read_b64_tr_b16 a[10:11], v108 offset:18688
    s_xor_b32 s62, s69, 55296
    buffer_load_dwordx4 a[160:163], v156, s[36:39], s62 offen offset:0 sc1
    v_mfma_f32_16x16x32_bf16 v[116:119], a[28:31], a[116:119], v[116:119]
    ds_read_b64_tr_b16 a[12:13], v105 offset:14848
    v_mfma_f32_16x16x32_bf16 v[120:123], a[32:35], a[116:119], v[120:123]
    ds_read_b64_tr_b16 a[14:15], v105 offset:18944
    v_mfma_f32_16x16x32_bf16 v[124:127], a[36:39], a[116:119], v[124:127]
    ds_read_b64_tr_b16 a[16:17], v108 offset:14848
    v_mfma_f32_16x16x32_bf16 v[128:131], a[40:43], a[116:119], v[128:131]
    ds_read_b64_tr_b16 a[18:19], v108 offset:18944
    s_xor_b32 s62, s69, 56320
    buffer_load_dwordx4 a[164:167], v156, s[36:39], s62 offen offset:0 sc1
    s_waitcnt vmcnt(10) lgkmcnt(8)
    v_mfma_f32_16x16x32_bf16 v[132:135], a[44:47], a[124:127], v[132:135]
    s_barrier
    ds_read_b64_tr_b16 a[28:29], v105 offset:56000
    v_mfma_f32_16x16x32_bf16 v[136:139], a[48:51], a[124:127], v[136:139]
    ds_read_b64_tr_b16 a[30:31], v105 offset:60096
    v_mfma_f32_16x16x32_bf16 v[140:143], a[52:55], a[124:127], v[140:143]
    ds_read_b64_tr_b16 a[32:33], v108 offset:56000
    v_mfma_f32_16x16x32_bf16 v[144:147], a[56:59], a[124:127], v[144:147]
    ds_read_b64_tr_b16 a[34:35], v108 offset:60096
    v_mfma_f32_16x16x32_bf16 v[116:119], a[44:47], a[0:3], v[116:119]
    ds_read_b64_tr_b16 a[36:37], v105 offset:56256
    v_mfma_f32_16x16x32_bf16 v[120:123], a[48:51], a[0:3], v[120:123]
    ds_read_b64_tr_b16 a[38:39], v105 offset:60352
    v_mfma_f32_16x16x32_bf16 v[124:127], a[52:55], a[0:3], v[124:127]
    ds_read_b64_tr_b16 a[40:41], v108 offset:56256
    v_mfma_f32_16x16x32_bf16 v[128:131], a[56:59], a[0:3], v[128:131]
    ds_read_b64_tr_b16 a[42:43], v108 offset:60352
    s_waitcnt vmcnt(8) lgkmcnt(8)
    v_mfma_f32_16x16x32_bf16 v[132:135], a[4:7], a[132:135], v[132:135]
    ds_read_b64_tr_b16 a[44:45], v106 offset:29632
    v_mfma_f32_16x16x32_bf16 v[136:139], a[8:11], a[132:135], v[136:139]
    ds_read_b64_tr_b16 a[46:47], v106 offset:33728
    v_mfma_f32_16x16x32_bf16 v[140:143], a[12:15], a[132:135], v[140:143]
    ds_read_b64_tr_b16 a[48:49], v109 offset:29632
    v_mfma_f32_16x16x32_bf16 v[144:147], a[16:19], a[132:135], v[144:147]
    ds_read_b64_tr_b16 a[50:51], v109 offset:33728
    v_mfma_f32_16x16x32_bf16 v[116:119], a[4:7], a[128:131], v[116:119]
    ds_read_b64_tr_b16 a[52:53], v106 offset:29888
    v_mfma_f32_16x16x32_bf16 v[120:123], a[8:11], a[128:131], v[120:123]
    ds_read_b64_tr_b16 a[54:55], v106 offset:33984
    v_mfma_f32_16x16x32_bf16 v[124:127], a[12:15], a[128:131], v[124:127]
    ds_read_b64_tr_b16 a[56:57], v109 offset:29888
    v_mfma_f32_16x16x32_bf16 v[128:131], a[16:19], a[128:131], v[128:131]
    ds_read_b64_tr_b16 a[58:59], v109 offset:33984
    s_waitcnt vmcnt(6) lgkmcnt(8)
    v_mfma_f32_16x16x32_bf16 v[132:135], a[28:31], a[140:143], v[132:135]
    ds_read_b64_tr_b16 a[4:5], v104 offset:2048
    v_mfma_f32_16x16x32_bf16 v[136:139], a[32:35], a[140:143], v[136:139]
    ds_read_b64_tr_b16 a[6:7], v104 offset:6144
    v_mfma_f32_16x16x32_bf16 v[140:143], a[36:39], a[140:143], v[140:143]
    ds_read_b64_tr_b16 a[8:9], v107 offset:2048
    v_mfma_f32_16x16x32_bf16 v[144:147], a[40:43], a[140:143], v[144:147]
    ds_read_b64_tr_b16 a[10:11], v107 offset:6144
    v_mfma_f32_16x16x32_bf16 v[116:119], a[28:31], a[136:139], v[116:119]
    ds_read_b64_tr_b16 a[12:13], v104 offset:2304
    v_mfma_f32_16x16x32_bf16 v[120:123], a[32:35], a[136:139], v[120:123]
    ds_read_b64_tr_b16 a[14:15], v104 offset:6400
    v_mfma_f32_16x16x32_bf16 v[124:127], a[36:39], a[136:139], v[124:127]
    ds_read_b64_tr_b16 a[16:17], v107 offset:2304
    v_mfma_f32_16x16x32_bf16 v[128:131], a[40:43], a[136:139], v[128:131]
    ds_read_b64_tr_b16 a[18:19], v107 offset:6400
    s_waitcnt vmcnt(4) lgkmcnt(8)
    v_mfma_f32_16x16x32_bf16 v[132:135], a[44:47], a[148:151], v[132:135]
    ds_read_b64_tr_b16 a[28:29], v104 offset:43008
    v_mfma_f32_16x16x32_bf16 v[136:139], a[48:51], a[148:151], v[136:139]
    ds_read_b64_tr_b16 a[30:31], v104 offset:47104
    v_mfma_f32_16x16x32_bf16 v[140:143], a[52:55], a[148:151], v[140:143]
    ds_read_b64_tr_b16 a[32:33], v107 offset:43008
    v_mfma_f32_16x16x32_bf16 v[144:147], a[56:59], a[148:151], v[144:147]
    ds_read_b64_tr_b16 a[34:35], v107 offset:47104
    v_mfma_f32_16x16x32_bf16 v[116:119], a[44:47], a[144:147], v[116:119]
    ds_read_b64_tr_b16 a[36:37], v104 offset:43264
    v_mfma_f32_16x16x32_bf16 v[120:123], a[48:51], a[144:147], v[120:123]
    ds_read_b64_tr_b16 a[38:39], v104 offset:47360
    v_mfma_f32_16x16x32_bf16 v[124:127], a[52:55], a[144:147], v[124:127]
    ds_read_b64_tr_b16 a[40:41], v107 offset:43264
    v_mfma_f32_16x16x32_bf16 v[128:131], a[56:59], a[144:147], v[128:131]
    ds_read_b64_tr_b16 a[42:43], v107 offset:47360
    s_waitcnt vmcnt(2) lgkmcnt(8)
    v_mfma_f32_16x16x32_bf16 v[132:135], a[4:7], a[156:159], v[132:135]
    v_mfma_f32_16x16x32_bf16 v[136:139], a[8:11], a[156:159], v[136:139]
    v_mfma_f32_16x16x32_bf16 v[140:143], a[12:15], a[156:159], v[140:143]
    v_mfma_f32_16x16x32_bf16 v[144:147], a[16:19], a[156:159], v[144:147]
    v_mfma_f32_16x16x32_bf16 v[116:119], a[4:7], a[152:155], v[116:119]
    v_mfma_f32_16x16x32_bf16 v[120:123], a[8:11], a[152:155], v[120:123]
    v_mfma_f32_16x16x32_bf16 v[124:127], a[12:15], a[152:155], v[124:127]
    v_mfma_f32_16x16x32_bf16 v[128:131], a[16:19], a[152:155], v[128:131]
    s_waitcnt vmcnt(0) lgkmcnt(0)
    v_mfma_f32_16x16x32_bf16 v[132:135], a[28:31], a[164:167], v[132:135]
    v_mfma_f32_16x16x32_bf16 v[136:139], a[32:35], a[164:167], v[136:139]
    v_mfma_f32_16x16x32_bf16 v[140:143], a[36:39], a[164:167], v[140:143]
    v_mfma_f32_16x16x32_bf16 v[144:147], a[40:43], a[164:167], v[144:147]
    v_mfma_f32_16x16x32_bf16 v[116:119], a[28:31], a[160:163], v[116:119]
    v_mfma_f32_16x16x32_bf16 v[120:123], a[32:35], a[160:163], v[120:123]
    v_mfma_f32_16x16x32_bf16 v[124:127], a[36:39], a[160:163], v[124:127]
    v_mfma_f32_16x16x32_bf16 v[128:131], a[40:43], a[160:163], v[128:131]
    s_barrier
    ds_write_b128 v20, v[132:135] offset:2048
    ds_write_b128 v20, v[136:139] offset:3072
    ds_write_b128 v20, v[140:143] offset:4096
    ds_write_b128 v20, v[144:147] offset:5120
    v_xor_b32 v7, 8192, v20
    v_accvgpr_read_b32 v8, a26
    s_waitcnt lgkmcnt(0)
    s_barrier
    ds_read_b128 v[132:135], v7 offset:2048
    ds_read_b128 v[136:139], v7 offset:3072
    ds_read_b128 v[140:143], v7 offset:4096
    ds_read_b128 v[144:147], v7 offset:5120
    s_waitcnt lgkmcnt(3)
    v_pk_add_f32 v[116:117], v[116:117], v[132:133]
    v_pk_add_f32 v[118:119], v[118:119], v[134:135]
    s_waitcnt lgkmcnt(2)
    v_pk_add_f32 v[120:121], v[120:121], v[136:137]
    v_pk_add_f32 v[122:123], v[122:123], v[138:139]
    s_waitcnt lgkmcnt(1)
    v_pk_add_f32 v[124:125], v[124:125], v[140:141]
    v_pk_add_f32 v[126:127], v[126:127], v[142:143]
    s_waitcnt lgkmcnt(0)
    v_pk_add_f32 v[128:129], v[128:129], v[144:145]
    v_pk_add_f32 v[130:131], v[130:131], v[146:147]
    v_pk_fma_f32 v[88:89], v[116:117], v[72:73], v[88:89]
    v_pk_fma_f32 v[90:91], v[118:119], v[74:75], v[90:91]
    v_pk_fma_f32 v[92:93], v[120:121], v[76:77], v[92:93]
    v_pk_fma_f32 v[94:95], v[122:123], v[78:79], v[94:95]
    v_pk_fma_f32 v[96:97], v[124:125], v[80:81], v[96:97]
    v_pk_fma_f32 v[98:99], v[126:127], v[82:83], v[98:99]
    v_pk_fma_f32 v[100:101], v[128:129], v[84:85], v[100:101]
    v_pk_fma_f32 v[102:103], v[130:131], v[86:87], v[102:103]
    v_cvt_pk_bf16_f32 v132, v88, v89
    v_cvt_pk_bf16_f32 v133, v90, v91
    v_cvt_pk_bf16_f32 v134, v92, v93
    v_cvt_pk_bf16_f32 v135, v94, v95
    v_cvt_pk_bf16_f32 v136, v96, v97
    v_cvt_pk_bf16_f32 v137, v98, v99
    v_cvt_pk_bf16_f32 v138, v100, v101
    v_cvt_pk_bf16_f32 v139, v102, v103
    v_permlane16_swap_b32 v132, v134
    v_permlane16_swap_b32 v133, v135
    v_permlane16_swap_b32 v136, v138
    v_permlane16_swap_b32 v137, v139
    buffer_store_dwordx4 v[132:135], v8, s[32:35], 0 offen
    buffer_store_dwordx4 v[136:139], v8, s[32:35], 0 offen offset:64
    s_or_b32 s57, s2, s44
    s_cmp_lg_u32 s57, 0
    s_cbranch_scc1 Lnobump_33
    s_mov_b32 s53, 0
Lpoll_34:
    s_add_u32 s53, s53, 1
    s_cmp_gt_u32 s53, 65536
    s_cbranch_scc1 Lexit
    buffer_load_dwordx4 v[116:119], v16, s[36:39], 0 offen offset:1024 sc1
    s_waitcnt vmcnt(0)
    v_and_b32 v116, -8, v116
    v_and_b32 v117, -8, v117
    v_and_b32 v118, -8, v118
    v_and_b32 v119, -8, v119
    v_xor_b32 v4, v116, v6
    v_xor_b32 v117, v117, v6
    v_xor_b32 v118, v118, v6
    v_xor_b32 v119, v119, v6
    v_or3_b32 v4, v4, v119, v118
    v_or_b32 v4, v4, v117
    v_cmp_ne_u32 vcc, 0, v4
    s_cbranch_vccnz Lpoll_34
    v_mov_b32 v7, 0
    s_mov_b64 exec, 1
    buffer_store_dword v6, v7, s[36:39], 0 offen offset:0 sc1
    s_mov_b64 exec, -1
Lnobump_33:
Lexit:
    s_endpgm
Lretry_5:
    s_mov_b32 s53, 0
Lretry_5_1:
    s_add_u32 s53, s53, 1
    s_cmp_gt_u32 s53, 65536
    s_cbranch_scc1 Lexit
    buffer_load_dwordx4 v[72:75], v35, s[36:39], 0 offen sc1
    buffer_load_dwordx4 v[76:79], v35, s[36:39], s3 offen sc1
    buffer_load_dwordx4 v[80:83], v35, s[36:39], s0 offen sc1
    buffer_load_dwordx4 v[84:87], v35, s[36:39], s1 offen sc1
    buffer_load_dword v36, v38, s[36:39], 0 offen offset:1024 sc1
    s_waitcnt vmcnt(0)
    v_xor_b32 v40, s73, v72
    v_xor_b32 v41, s74, v73
    v_bitop3_b32 v40, v74, s75, v40 bitop3:0xbe
    v_bitop3_b32 v41, v75, s76, v41 bitop3:0xbe
    v_bitop3_b32 v40, v76, s73, v40 bitop3:0xbe
    v_bitop3_b32 v41, v77, s74, v41 bitop3:0xbe
    v_bitop3_b32 v40, v78, s75, v40 bitop3:0xbe
    v_bitop3_b32 v41, v79, s76, v41 bitop3:0xbe
    v_bitop3_b32 v40, v80, s73, v40 bitop3:0xbe
    v_bitop3_b32 v41, v81, s74, v41 bitop3:0xbe
    v_bitop3_b32 v40, v82, s75, v40 bitop3:0xbe
    v_bitop3_b32 v41, v83, s76, v41 bitop3:0xbe
    v_bitop3_b32 v40, v84, s73, v40 bitop3:0xbe
    v_bitop3_b32 v41, v85, s74, v41 bitop3:0xbe
    v_bitop3_b32 v40, v86, s75, v40 bitop3:0xbe
    v_bitop3_b32 v41, v87, s76, v41 bitop3:0xbe
    v_or_b32 v40, v40, v41
    v_and_b32 v40, 0xff, v40
    v_and_b32 v37, -8, v36
    v_xor_b32 v37, v37, v6
    v_or_b32 v40, v40, v37
    v_cmp_ne_u32 vcc, 0, v40
    s_cbranch_vccnz Lretry_5_1
    s_branch Lback_6
Lretry_12:
    s_mov_b32 s53, 0
Lretry_12_1:
    s_add_u32 s53, s53, 1
    s_cmp_gt_u32 s53, 65536
    s_cbranch_scc1 Lexit
    buffer_load_dword v22, v18, s[36:39], 0 offen offset:0 sc1
    s_waitcnt vmcnt(0)
    v_cmp_ne_u32 vcc, s54, v22
    s_cbranch_vccnz Lretry_12_1
    s_branch Lback_13
Lretry_16:
    s_mov_b32 s53, 0
Lretry_16_1:
    s_add_u32 s53, s53, 1
    s_cmp_gt_u32 s53, 65536
    s_cbranch_scc1 Lexit
    buffer_load_dwordx4 v[148:151], v16, s[36:39], s71 offen sc1
    s_waitcnt vmcnt(0)
    v_max3_u32 v4, v148, v149, v150
    v_max_u32 v4, v4, v151
    v_cmp_eq_u32 vcc, -1, v4
    s_cbranch_vccnz Lretry_16_1
    s_branch Lback_17
Lretry_27:
    s_mov_b32 s53, 0
Lretry_27_1:
    s_add_u32 s53, s53, 1
    s_cmp_gt_u32 s53, 65536
    s_cbranch_scc1 Lexit
    buffer_load_dword v157, v18, s[36:39], 0 offen offset:1024 sc1
    s_waitcnt vmcnt(0)
    v_cmp_ne_u32 vcc, s54, v157
    s_cbranch_vccnz Lretry_27_1
    s_branch Lback_28
Lidle_22:
    s_waitcnt vmcnt(0) lgkmcnt(0)
    s_barrier
    s_mov_b32 s52, 917504
    s_mov_b32 s52, 1032192
    s_mov_b32 s52, 1146880
    s_mov_b32 s52, 1261568
    s_mov_b32 s52, 114688
    s_mov_b32 s52, 229376
    s_mov_b32 s52, 344064
    s_mov_b32 s52, 114688
    s_mov_b32 s52, 229376
    s_mov_b32 s52, 344064
    s_mov_b32 s52, 917504
    s_mov_b32 s52, 1032192
    s_mov_b32 s52, 1146880
    s_mov_b32 s52, 1261568
    s_mov_b32 s52, 917504
    s_mov_b32 s52, 1032192
    s_mov_b32 s52, 1146880
    s_mov_b32 s52, 1261568
    s_add_u32 m0, s51, 111552
    s_xor_b32 s52, s66, 0
    s_nop 0
    buffer_load_dwordx4 v13, s[24:27], s52 offen lds
    s_add_u32 m0, s51, 115648
    s_xor_b32 s52, s66, 16384
    s_nop 0
    buffer_load_dwordx4 v13, s[24:27], s52 offen lds
    s_add_u32 m0, s51, 155072
    s_xor_b32 s52, s66, 32768
    s_nop 0
    buffer_load_dwordx4 v13, s[24:27], s52 offen lds
    s_add_u32 m0, s51, 159168
    s_xor_b32 s52, s66, 49152
    s_nop 0
    buffer_load_dwordx4 v13, s[24:27], s52 offen lds
    s_add_u32 m0, s51, 59840
    s_xor_b32 s52, s66, 131072
    s_nop 0
    buffer_load_dwordx4 v13, s[24:27], s52 offen lds
    s_add_u32 m0, s51, 63936
    s_xor_b32 s52, s66, 147456
    s_nop 0
    buffer_load_dwordx4 v13, s[24:27], s52 offen lds
    s_add_u32 m0, s51, 119744
    s_xor_b32 s52, s66, 163840
    s_nop 0
    buffer_load_dwordx4 v13, s[24:27], s52 offen lds
    s_add_u32 m0, s51, 123840
    s_xor_b32 s52, s66, 180224
    s_nop 0
    buffer_load_dwordx4 v13, s[24:27], s52 offen lds
    s_add_u32 m0, s51, 68032
    s_xor_b32 s52, s66, 262144
    s_nop 0
    buffer_load_dwordx4 v13, s[24:27], s52 offen lds
    s_add_u32 m0, s51, 72128
    s_xor_b32 s52, s66, 278528
    s_nop 0
    buffer_load_dwordx4 v13, s[24:27], s52 offen lds
    s_add_u32 m0, s51, 76224
    s_xor_b32 s52, s66, 294912
    s_nop 0
    buffer_load_dwordx4 v13, s[24:27], s52 offen lds
    s_add_u32 m0, s51, 80320
    s_xor_b32 s52, s66, 311296
    s_nop 0
    buffer_load_dwordx4 v13, s[24:27], s52 offen lds
    s_add_u32 m0, s51, 35072
    s_xor_b32 s52, s66, 393216
    s_nop 0
    buffer_load_dwordx4 v13, s[24:27], s52 offen lds
    s_add_u32 m0, s51, 39168
    s_xor_b32 s52, s66, 409600
    s_nop 0
    buffer_load_dwordx4 v13, s[24:27], s52 offen lds
    s_add_u32 m0, s51, 92864
    s_xor_b32 s52, s66, 425984
    s_nop 0
    buffer_load_dwordx4 v13, s[24:27], s52 offen lds
    s_add_u32 m0, s51, 96960
    s_xor_b32 s52, s66, 442368
    s_nop 0
    buffer_load_dwordx4 v13, s[24:27], s52 offen lds
    s_add_u32 m0, s51, 43264
    s_xor_b32 s52, s66, 524288
    s_nop 0
    buffer_load_dwordx4 v13, s[24:27], s52 offen lds
    s_add_u32 m0, s51, 47360
    s_xor_b32 s52, s66, 540672
    s_nop 0
    buffer_load_dwordx4 v13, s[24:27], s52 offen lds
    s_add_u32 m0, s51, 127936
    s_xor_b32 s52, s66, 557056
    s_nop 0
    buffer_load_dwordx4 v13, s[24:27], s52 offen lds
    s_add_u32 m0, s51, 132032
    s_xor_b32 s52, s66, 573440
    s_nop 0
    buffer_load_dwordx4 v13, s[24:27], s52 offen lds
    s_add_u32 m0, s51, 2048
    s_xor_b32 s52, s66, 655360
    s_nop 0
    buffer_load_dwordx4 v13, s[24:27], s52 offen lds
    s_add_u32 m0, s51, 6144
    s_xor_b32 s52, s66, 671744
    s_nop 0
    buffer_load_dwordx4 v13, s[24:27], s52 offen lds
    s_add_u32 m0, s51, 84416
    s_xor_b32 s52, s66, 688128
    s_nop 0
    buffer_load_dwordx4 v13, s[24:27], s52 offen lds
    s_add_u32 m0, s51, 88512
    s_xor_b32 s52, s66, 704512
    s_nop 0
    buffer_load_dwordx4 v13, s[24:27], s52 offen lds
    s_add_u32 m0, s51, 10240
    s_xor_b32 s52, s67, 786432
    s_nop 0
    buffer_load_dwordx4 v13, s[24:27], s52 offen lds
    s_add_u32 m0, s51, 14336
    s_xor_b32 s52, s67, 802816
    s_nop 0
    buffer_load_dwordx4 v13, s[24:27], s52 offen lds
    s_add_u32 m0, s51, 18432
    s_xor_b32 s52, s67, 819200
    s_nop 0
    buffer_load_dwordx4 v13, s[24:27], s52 offen lds
    s_add_u32 m0, s51, 22528
    s_xor_b32 s52, s67, 835584
    s_nop 0
    buffer_load_dwordx4 v13, s[24:27], s52 offen lds
    s_add_u32 m0, s51, 26624
    s_xor_b32 s52, s66, 65536
    s_nop 0
    buffer_load_dwordx4 v13, s[24:27], s52 offen lds
    s_add_u32 m0, s51, 30720
    s_xor_b32 s52, s66, 81920
    s_nop 0
    buffer_load_dwordx4 v13, s[24:27], s52 offen lds
    s_add_u32 m0, s51, 101056
    s_xor_b32 s52, s66, 98304
    s_nop 0
    buffer_load_dwordx4 v13, s[24:27], s52 offen lds
    s_mov_b32 s53, 0
Lidle_22_w:
    s_sleep 8
    s_add_u32 s53, s53, 1
    s_cmp_gt_u32 s53, 65536
    s_cbranch_scc1 Lexit
    buffer_load_dword v157, v18, s[36:39], 0 offen offset:1024 sc1
    s_waitcnt vmcnt(0)
    v_cmp_ne_u32 vcc, s54, v157
    s_cbranch_vccnz Lidle_22_w
    s_xor_b32 s62, s68, 0
    buffer_load_dwordx4 a[184:187], v156, s[36:39], s62 offen offset:0 sc1
    s_xor_b32 s62, s68, 1024
    buffer_load_dwordx4 a[188:191], v156, s[36:39], s62 offen offset:0 sc1
    s_xor_b32 s62, s68, 2048
    buffer_load_dwordx4 a[192:195], v156, s[36:39], s62 offen offset:0 sc1
    s_xor_b32 s62, s68, 3072
    buffer_load_dwordx4 a[196:199], v156, s[36:39], s62 offen offset:0 sc1
    s_xor_b32 s62, s68, 8192
    buffer_load_dwordx4 a[200:203], v156, s[36:39], s62 offen offset:0 sc1
    s_xor_b32 s62, s68, 9216
    buffer_load_dwordx4 a[204:207], v156, s[36:39], s62 offen offset:0 sc1
    s_xor_b32 s62, s68, 10240
    buffer_load_dwordx4 a[208:211], v156, s[36:39], s62 offen offset:0 sc1
    s_xor_b32 s62, s68, 11264
    buffer_load_dwordx4 a[212:215], v156, s[36:39], s62 offen offset:0 sc1
    s_xor_b32 s62, s68, 16384
    buffer_load_dwordx4 a[216:219], v156, s[36:39], s62 offen offset:0 sc1
    s_xor_b32 s62, s68, 17408
    buffer_load_dwordx4 a[220:223], v156, s[36:39], s62 offen offset:0 sc1
    s_xor_b32 s62, s68, 18432
    buffer_load_dwordx4 a[224:227], v156, s[36:39], s62 offen offset:0 sc1
    s_xor_b32 s62, s68, 19456
    buffer_load_dwordx4 a[228:231], v156, s[36:39], s62 offen offset:0 sc1
    s_xor_b32 s62, s68, 24576
    buffer_load_dwordx4 v[24:27], v156, s[36:39], s62 offen offset:0 sc1
    s_barrier
    ds_read_b64_tr_b16 a[28:29], v105 offset:50112
    ds_read_b64_tr_b16 a[30:31], v105 offset:54208
    ds_read_b64_tr_b16 a[32:33], v108 offset:50112
    ds_read_b64_tr_b16 a[34:35], v108 offset:54208
    ds_read_b64_tr_b16 a[36:37], v105 offset:50368
    ds_read_b64_tr_b16 a[38:39], v105 offset:54464
    ds_read_b64_tr_b16 a[40:41], v108 offset:50368
    ds_read_b64_tr_b16 a[42:43], v108 offset:54464
    ds_read_b64_tr_b16 a[44:45], v106 offset:32192
    ds_read_b64_tr_b16 a[46:47], v106 offset:36288
    ds_read_b64_tr_b16 a[48:49], v109 offset:32192
    ds_read_b64_tr_b16 a[50:51], v109 offset:36288
    ds_read_b64_tr_b16 a[52:53], v106 offset:32448
    ds_read_b64_tr_b16 a[54:55], v106 offset:36544
    ds_read_b64_tr_b16 a[56:57], v109 offset:32448
    ds_read_b64_tr_b16 a[58:59], v109 offset:36544
    s_waitcnt vmcnt(0) lgkmcnt(0)
    s_branch Lp4_23
Lretry_31:
    s_mov_b32 s53, 0
Lretry_31_1:
    s_add_u32 s53, s53, 1
    s_cmp_gt_u32 s53, 65536
    s_cbranch_scc1 Lexit
    buffer_load_dword v157, v18, s[36:39], 0 offen offset:1536 sc1
    s_waitcnt vmcnt(0)
    v_cmp_ne_u32 vcc, s54, v157
    s_cbranch_vccnz Lretry_31_1
    s_branch Lback_32
Lcode_end:
.section .rodata,"a"
.p2align 6
.amdhsa_kernel adaLN_cond__sliding_local_dilated__glu_gated_bilinear__prompt_kernel
  .amdhsa_next_free_vgpr 512
  .amdhsa_next_free_sgpr 102
  .amdhsa_accum_offset 256
  .amdhsa_group_segment_fixed_size 0
  .amdhsa_kernarg_size 96
  .amdhsa_user_sgpr_count 2
  .amdhsa_user_sgpr_kernarg_segment_ptr 1
  .amdhsa_system_sgpr_workgroup_id_x 1
.end_amdhsa_kernel
```
